```python
import torch

def _softmax(x, axis=-1):
    return torch.softmax(x, dim=axis)

def _gelu(x):
    return torch.nn.functional.gelu(x, approximate='tanh')

def _silu(x):
    return torch.nn.functional.silu(x)

def _sigmoid(x):
    return torch.sigmoid(x)

def _layernorm(x, axis=-1, eps=1e-05):
    m = x.mean(dim=axis, keepdim=True)
    v = x.var(dim=axis, keepdim=True, unbiased=False)
    return (x - m) / torch.sqrt(v + eps)

def _scatter_add(tgt, idx, src, axis=0):
    return tgt.clone().index_add_(axis, idx, src)

def _segment_sum(src, seg, n):
    out = torch.zeros((n,) + src.shape[1:], dtype=src.dtype)
    return out.index_add_(0, seg, src)

def _pad(x, pw):
    flat = tuple((v for pair in reversed(pw) for v in pair))
    return torch.nn.functional.pad(x, flat)
kernel_name = 'adaLN_cond__sliding_local_dilated__mixer_channel_mlp__prompt'

def setup_inputs():

    _w = lambda a: (lambda t: t.to(torch.bfloat16) if t.is_floating_point() else t)(torch.as_tensor(a))

    def _A_setup():
        B, S, D = (1, 2048, 448)
        return {'x': _w((lambda *s: torch.randn(*s, dtype=torch.bfloat16) * 0.05)(B, S, D)), 'wqkv': _w((lambda *s: torch.randn(*s, dtype=torch.bfloat16) * 0.05)(D, 3 * D)), 'wo': _w((lambda *s: torch.randn(*s, dtype=torch.bfloat16) * 0.05)(D, D))}
    _A_in = _A_setup()

    def _B_setup():
        B, S, D, F = (1, 2048, 448, 1792)
        return {'x': _w((lambda *s: torch.randn(*s, dtype=torch.bfloat16) * 0.05)(B, S, D)), 'w1': _w((lambda *s: torch.randn(*s, dtype=torch.bfloat16) * 3.2)(D, F) * D ** (-0.5)), 'b1': _w((lambda *s: torch.randn(*s, dtype=torch.bfloat16) * 1.6)(F)), 'w2': _w((lambda *s: torch.randn(*s, dtype=torch.bfloat16) * 0.2)(F, D) * F ** (-0.5)), 'b2': _w((lambda *s: torch.randn(*s, dtype=torch.bfloat16) * 0.4)(D))}
    _B_in = _B_setup()
    return {'A_x': _A_in['x'], 'A_wqkv': _A_in['wqkv'], 'A_wo': _A_in['wo'], 'B_x': _B_in['x'], 'B_w1': _B_in['w1'], 'B_b1': _B_in['b1'], 'B_w2': _B_in['w2'], 'B_b2': _B_in['b2'], 'c': _w((lambda *s: torch.randn(*s, dtype=torch.bfloat16) * 0.1)(1, 448) * 8.0), 'w_mod': _w((lambda *s: torch.randn(*s, dtype=torch.bfloat16) * 0.1)(448, 6 * 448) * 448 ** (-0.5) * 8.0)}

def reference(A_x, A_wqkv, A_wo, B_x, B_w1, B_b1, B_w2, B_b2, c, w_mod):

    def _A_ref(x, wqkv, wo):
        B, S, D = x.shape
        H = 16
        Dh = D // H
        W, dil = (8, 2)
        qkv = (lambda x, *d: x.permute(*d))((x @ wqkv).reshape(B, S, 3, H, Dh), 2, 0, 3, 1, 4)
        q, k, v = (qkv[0], qkv[1], qkv[2])
        scale = Dh ** (-0.5)
        pos = torch.arange(S)
        off = torch.arange(W) * dil
        idx = pos[:, None] - off[None, :]
        mask = idx >= 0
        idx_c = torch.where(mask, idx, 0).reshape(-1)
        kg = k[:, :, idx_c, :].reshape(B, H, S, W, Dh)
        vg = v[:, :, idx_c, :].reshape(B, H, S, W, Dh)
        logits = torch.einsum('bhsd,bhswd->bhsw', q, kg) * scale
        logits = torch.where(mask[None, None, :, :], logits, -1000000000.0)
        attn = _softmax(logits, axis=-1)
        o = torch.einsum('bhsw,bhswd->bhsd', attn, vg)
        return (lambda x, *d: x.permute(*d))(o, 0, 2, 1, 3).reshape(B, S, D) @ wo

    def _B_ref(x, w1, b1, w2, b2):
        y = _layernorm(x, axis=-1)
        h = _gelu(torch.einsum('bsd,df->bsf', y, w1) + b1)
        return torch.einsum('bsf,fd->bsd', h, w2) + b2
    x = A_x
    mod = (_silu(c) @ w_mod).reshape(c.shape[0], 6, 1, -1)
    sa, ca, ga, sb, cb, gb = (mod[:, 0].clone(), mod[:, 1].clone(), mod[:, 2].clone(), mod[:, 3].clone(), mod[:, 4].clone(), mod[:, 5].clone())
    h = _layernorm(x, axis=-1) * (1 + ca) + sa
    x = x + ga * _A_ref(h, A_wqkv, A_wo)
    h = _layernorm(x, axis=-1) * (1 + cb) + sb
    x = x + gb * _B_ref(h, B_w1, B_b1, B_w2, B_b2)
    return x
```

```asm
; @launch grid=(256,1,1) block=(512,1,1) lds=163840
.amdgcn_target "amdgcn-amd-amdhsa--gfx950"
.text
.globl adaLN_cond__sliding_local_dilated__mixer_channel_mlp__prompt_kernel
.p2align 8
.type adaLN_cond__sliding_local_dilated__mixer_channel_mlp__prompt_kernel,@function
adaLN_cond__sliding_local_dilated__mixer_channel_mlp__prompt_kernel:
    s_load_dwordx16 s[8:23], s[0:1], 0
    s_getpc_b64 s[92:93]
L_pc0:
    s_lshr_b32 s98, s2, 3
    v_lshrrev_b32 v1, 5, v0
    v_lshl_add_u32 v3, v1, 5, s98
    v_lshlrev_b32 v3, 7, v3
    v_min_u32 v3, L_code_end-L_pc0, v3
    global_load_dword v250, v3, s[92:93]
    s_load_dwordx8 s[24:31], s[0:1], 64
    s_load_dwordx2 s[32:33], s[0:1], 96
    v_lshrrev_b32 v1, 6, v0
    s_cmp_ge_u32 s2, 256
    s_cbranch_scc1 L_code_end
    v_readfirstlane_b32 s3, v1
    v_and_b32 v0, 63, v0
    s_lshr_b32 s91, s2, 6
    s_and_b32 s92, s2, 7
    s_lshl2_add_u32 s5, s92, s91
    s_mov_b32 s39, 0x20000
    s_and_b32 s4, s98, 7
    s_cbranch_scc0 L_Hq
    s_sub_u32 s4, s4, 1
    s_mul_i32 s68, s5, 57344
    s_mov_b32 s38, 1835008
    s_cmp_lt_u32 s3, 4
    s_cbranch_scc1 L_A
    s_setprio 2
    s_sub_u32 s69, s3, 4
    v_lshlrev_b32 v15, 4, v0
    v_mov_b32 v2, 0x80000000
    v_cmp_gt_u32 vcc, 56, v0
    s_mul_i32 s88, s69, 3584
    s_add_u32 s72, s68, s88
    v_cndmask_b32 v1, v2, v15, vcc
    s_waitcnt lgkmcnt(0)
    s_mov_b64 s[36:37], s[8:9]
    buffer_load_dwordx4 v[68:71], v1, s[36:39], s72 offen offset:0
    buffer_load_dwordx4 v[76:79], v1, s[36:39], s72 offen offset:896
    buffer_load_dwordx4 v[84:87], v1, s[36:39], s72 offen offset:1792
    buffer_load_dwordx4 v[92:95], v1, s[36:39], s72 offen offset:2688
    s_add_u32 s72, s72, 14336
    buffer_load_dwordx4 v[100:103], v1, s[36:39], s72 offen offset:0
    buffer_load_dwordx4 v[108:111], v1, s[36:39], s72 offen offset:896
    s_branch L_B
L_Hq:
    s_mov_b32 s38, 2408448
    s_lshl3_add_u32 s67, s91, s92
    s_cmp_ge_u32 s67, 14
    s_cselect_b32 s83, 1, 0
    s_mul_i32 s90, s83, 14
    s_sub_u32 s76, s67, s90
    s_cmp_lt_u32 s3, 4
    s_cbranch_scc0 L_Hq4
    v_min_u32 v3, 55, v0
    v_lshlrev_b32 v203, 4, v3
    s_waitcnt lgkmcnt(0)
    global_load_dwordx4 v[8:11], v203, s[24:25]
    s_branch L_H
L_Hq4:
    s_and_b32 s73, s3, 3
    v_lshrrev_b32 v3, 3, v0
    v_and_b32 v5, 4, v3
    v_add_u32 v3, v3, v5
    v_mul_u32_u24 v200, 5376, v3
    v_bfe_u32 v3, v0, 4, 2
    v_lshlrev_b32 v3, 1, v3
    v_and_b32 v5, 7, v0
    v_xor_b32 v3, v3, v5
    v_lshl_add_u32 v200, v3, 4, v200
    s_and_b32 s90, s3, 1
    s_lshr_b32 s91, s73, 1
    s_lshl2_add_u32 s72, s90, s91
    s_lshl_b32 s75, s73, 10
    s_mul_i32 s90, s83, 56
    s_add_u32 s90, s90, s72
    s_mul_i32 s74, s90, 21504
    s_lshl_b32 s90, s76, 7
    s_add_u32 s74, s74, s90
    s_waitcnt lgkmcnt(0)
    s_mov_b64 s[36:37], s[26:27]
    s_cmp_ge_u32 s67, 28
    s_cbranch_scc1 L_HW
    s_add_u32 m0, s75, 0
    s_nop 0
    buffer_load_dwordx4 v200, s[36:39], s74 offen  lds
    s_add_u32 m0, s75, 4096
    s_add_u32 s74, s74, 172032
    buffer_load_dwordx4 v200, s[36:39], s74 offen  lds
    s_add_u32 m0, s75, 8192
    s_add_u32 s74, s74, 172032
    buffer_load_dwordx4 v200, s[36:39], s74 offen  lds
    s_add_u32 m0, s75, 12288
    s_add_u32 s74, s74, 172032
    buffer_load_dwordx4 v200, s[36:39], s74 offen  lds
    s_add_u32 m0, s75, 16384
    s_add_u32 s74, s74, 172032
    buffer_load_dwordx4 v200, s[36:39], s74 offen  lds
    s_add_u32 m0, s75, 20480
    s_add_u32 s74, s74, 172032
    buffer_load_dwordx4 v200, s[36:39], s74 offen  lds
    s_add_u32 m0, s75, 24576
    s_add_u32 s74, s74, 172032
    buffer_load_dwordx4 v200, s[36:39], s74 offen  lds
    s_branch L_HD
L_A:
    s_setprio 3
    v_lshlrev_b32 v2, 7, v0
    s_mul_i32 s67, s5, 7
    s_add_u32 s67, s67, s4
    s_cmp_eq_u32 s3, 3
    s_cbranch_scc0 L_1
    s_mul_i32 s90, s67, 1792
    v_min_u32 v3, 1664, v2
    v_add_u32 v3, s90, v3
    s_waitcnt lgkmcnt(0)
    global_load_dword v4, v3, s[12:13]
    s_branch L_3
L_1:
    s_cmp_eq_u32 s3, 0
    s_cbranch_scc0 L_2
    s_mul_i32 s90, s67, 5376
    v_min_u32 v3, 5248, v2
    v_add_u32 v3, s90, v3
    s_waitcnt lgkmcnt(0)
    global_load_dword v4, v3, s[10:11]
    s_branch L_3
L_2:
    s_lshl1_add_u32 s90, s4, s3
    s_mul_i32 s90, s90, 5120
    s_add_u32 s90, s90, s68
    s_sub_u32 s90, s90, 19456
    s_max_i32 s90, s90, 0
    v_min_u32 v3, 4992, v2
    v_add_u32 v3, s90, v3
    s_waitcnt lgkmcnt(0)
    global_load_dword v4, v3, s[8:9]
L_3:
    s_setprio 3
    v_and_b32 v232, 0x13, v0
    v_bfe_u32 v233, v0, 2, 1
    v_lshl_add_u32 v232, v233, 3, v232
    v_bfe_u32 v233, v0, 3, 1
    v_lshl_add_u32 v232, v233, 2, v232
    s_lshl3_add_u32 s90, s4, s3
    s_lshl_b32 s90, s90, 5
    v_add_u32 v232, s90, v232
    v_lshlrev_b32 v233, 1, v232
    v_lshlrev_b32 v232, 4, v232
    v_add_u32 v232, 20480, v232
    s_load_dword s99, s[32:33], 0
    s_mov_b64 s[36:37], s[8:9]
    s_mov_b32 s38, 1835008
    s_mov_b32 s39, 0x20000
    s_mov_b64 s[40:41], s[10:11]
    s_mov_b32 s42, 1204224
    s_mov_b32 s43, 0x20000
    s_mov_b64 s[44:45], s[12:13]
    s_mov_b32 s46, 401408
    s_mov_b32 s47, 0x20000
    s_mov_b64 s[48:49], s[16:17]
    s_mov_b32 s50, 1605632
    s_mov_b32 s51, 0x20000
    s_mov_b64 s[52:53], s[20:21]
    s_mov_b32 s54, 1605632
    s_mov_b32 s55, 0x20000
    s_mov_b64 s[56:57], s[32:33]
    s_mov_b32 s58, 268435456
    s_mov_b32 s59, 0x20000
    s_mov_b64 s[60:61], s[28:29]
    s_mov_b32 s62, 1835008
    s_mov_b32 s63, 0x20000
    v_lshrrev_b32 v3, 2, v0
    v_mul_u32_u24 v130, 2688, v3
    v_and_b32 v3, 3, v0
    v_lshl_add_u32 v130, v3, 4, v130
    v_lshrrev_b32 v254, 4, v0
    s_mul_i32 s72, s3, 7168
    s_mul_i32 s75, s3, 14336
    s_add_u32 s75, s75, 100352
    v_lshrrev_b32 v3, 5, v0
    v_lshlrev_b32 v5, 9, v3
    v_bfe_u32 v3, v0, 2, 2
    v_lshl_add_u32 v5, v3, 6, v5
    v_and_b32 v3, 1, v254
    v_lshl_add_u32 v5, v3, 5, v5
    v_and_b32 v3, 3, v0
    v_lshl_add_u32 v5, v3, 3, v5
    v_add_u32 v14, s75, v5
    v_add_u32 v15, s72, v5
    s_lshl_b32 s73, s4, 7
    s_and_b32 s90, s3, 1
    s_lshl_b32 s91, s90, 6
    s_add_u32 s74, s73, 1792
    s_add_u32 s73, s73, s91
    s_cmp_lt_u32 s3, 2
    s_cselect_b32 s91, 896, 0
    s_add_u32 s73, s73, s91
    s_mul_i32 s90, s3, 301056
    s_add_u32 s74, s74, s90
    v_lshlrev_b32 v216, 4, v0
    v_lshrrev_b32 v2, 3, v0
    v_mul_u32_u24 v180, 2688, v2
    v_bfe_u32 v2, v0, 4, 1
    v_lshlrev_b32 v2, 2, v2
    v_and_b32 v3, 7, v0
    v_xor_b32 v2, v2, v3
    v_lshl_add_u32 v180, v2, 4, v180
    s_lshl_b32 s90, s4, 2
    s_lshr_b32 s84, 0x2461350, s90
    s_and_b32 s84, s84, 15
    s_mov_b32 s76, 0
    s_mov_b32 s77, s84
    s_mov_b32 s85, 7
    s_add_u32 s78, s84, 7
    s_cmp_le_u32 s84, 2
    s_cselect_b32 s86, 7, 0
    s_add_u32 s79, s78, s86
    s_sub_u32 s87, 16, s79
    v_and_b32 v2, 15, v0
    v_lshlrev_b32 v5, 3, v0
    s_lshl_b32 s90, s3, 11
    v_add_u32 v5, s90, v5
    v_mov_b32 v6, 157696
    v_add_u32 v7, 4, v254
    s_lshl_b32 s90, s76, 7
    v_cmp_gt_u32 vcc, s84, v254
    v_cmp_gt_u32 s[92:93], s84, v7
    v_add_u32 v181, s90, v5
    v_add_u32 v8, 10240, v181
    v_add_u32 v9, 10752, v181
    v_cndmask_b32 v185, v6, v8, vcc
    v_cndmask_b32 v186, v6, v9, s[92:93]
    s_lshl_b32 s90, s77, 7
    v_cmp_gt_u32 vcc, s85, v254
    v_cmp_gt_u32 s[92:93], s85, v7
    v_add_u32 v182, s90, v5
    v_add_u32 v8, 10240, v182
    v_add_u32 v9, 10752, v182
    v_cndmask_b32 v187, v6, v8, vcc
    v_cndmask_b32 v188, v6, v9, s[92:93]
    s_lshl_b32 s90, s78, 7
    v_cmp_gt_u32 vcc, s86, v254
    v_cmp_gt_u32 s[92:93], s86, v7
    v_add_u32 v183, s90, v5
    v_add_u32 v8, 10240, v183
    v_add_u32 v9, 10752, v183
    v_cndmask_b32 v189, v6, v8, vcc
    v_cndmask_b32 v190, v6, v9, s[92:93]
    s_lshl_b32 s90, s79, 7
    v_cmp_gt_u32 vcc, s87, v254
    v_cmp_gt_u32 s[92:93], s87, v7
    v_add_u32 v184, s90, v5
    v_add_u32 v8, 10240, v184
    v_add_u32 v9, 10752, v184
    v_cndmask_b32 v191, v6, v8, vcc
    v_cndmask_b32 v192, v6, v9, s[92:93]
    s_waitcnt lgkmcnt(0)
    s_add_u32 s6, s99, 0x9e3779b9
    v_mov_b32 v217, s6
    v_not_b32 v8, v217
    v_lshlrev_b32 v9, 2, v0
    v_add_u32 v9, 157760, v9
    ds_write_b32 v9, v8
    v_lshlrev_b32 v5, 3, v0
    s_lshl_b32 s90, s3, 9
    s_add_u32 s90, s90, 18432
    v_add_u32 v5, s90, v5
    v_lshrrev_b32 v7, 2, v2
    s_sub_u32 s90, 0, s77
    v_add_u32 v8, s90, v7
    v_cmp_gt_u32 vcc, s85, v8
    v_add_u32 v9, 0, v5
    s_nop 0
    v_cndmask_b32 v193, v6, v9, vcc
    s_sub_u32 s90, 4, s77
    v_add_u32 v8, s90, v7
    v_cmp_gt_u32 vcc, s85, v8
    v_add_u32 v9, 2560, v5
    s_nop 0
    v_cndmask_b32 v194, v6, v9, vcc
    s_sub_u32 s90, 8, s77
    v_add_u32 v8, s90, v7
    v_cmp_gt_u32 vcc, s85, v8
    v_add_u32 v9, 5120, v5
    s_nop 0
    v_cndmask_b32 v195, v6, v9, vcc
    s_sub_u32 s90, 12, s77
    v_add_u32 v8, s90, v7
    v_cmp_gt_u32 vcc, s85, v8
    v_add_u32 v9, 7680, v5
    s_nop 0
    v_cndmask_b32 v196, v6, v9, vcc
    s_sub_u32 s90, 4, s78
    v_add_u32 v8, s90, v7
    v_cmp_gt_u32 vcc, s86, v8
    v_add_u32 v9, 2560, v5
    s_nop 0
    v_cndmask_b32 v197, v6, v9, vcc
    s_sub_u32 s90, 8, s78
    v_add_u32 v8, s90, v7
    v_cmp_gt_u32 vcc, s86, v8
    v_add_u32 v9, 5120, v5
    s_nop 0
    v_cndmask_b32 v198, v6, v9, vcc
    s_sub_u32 s90, 12, s78
    v_add_u32 v8, s90, v7
    v_cmp_gt_u32 vcc, s86, v8
    v_add_u32 v9, 7680, v5
    s_nop 0
    v_cndmask_b32 v199, v6, v9, vcc
    s_sub_u32 s90, 0, s76
    v_add_u32 v8, s90, v7
    v_cmp_gt_u32 vcc, s84, v8
    v_add_u32 v9, 0, v5
    s_nop 0
    v_cndmask_b32 v200, v6, v9, vcc
    s_sub_u32 s90, 4, s76
    v_add_u32 v8, s90, v7
    v_cmp_gt_u32 vcc, s84, v8
    v_add_u32 v9, 2560, v5
    s_nop 0
    v_cndmask_b32 v201, v6, v9, vcc
    s_sub_u32 s90, 8, s79
    v_add_u32 v8, s90, v7
    v_cmp_gt_u32 vcc, s87, v8
    v_add_u32 v9, 5120, v5
    s_nop 0
    v_cndmask_b32 v202, v6, v9, vcc
    s_sub_u32 s90, 12, s79
    v_add_u32 v8, s90, v7
    v_cmp_gt_u32 vcc, s87, v8
    v_add_u32 v9, 7680, v5
    s_nop 0
    v_cndmask_b32 v203, v6, v9, vcc
    s_waitcnt lgkmcnt(0)
    s_barrier
    v_lshlrev_b32 v7, 2, v254
    v_sub_u32 v7, v2, v7
    s_or_b32 s90, s5, s3
    s_cmp_eq_u32 s90, 0
    s_cselect_b32 s90, 64, 16
    v_mov_b32 v9, 0xf149f2ca
    v_subrev_u32 v8, 0, v7
    v_add_u32 v10, s90, v8
    v_and_b32 v8, -15, v8
    v_and_b32 v10, -15, v10
    v_cmp_ne_u32 vcc, 0, v8
    v_cmp_ne_u32 s[92:93], 0, v10
    s_nop 0
    v_cndmask_b32 v208, 0, v9, vcc
    v_cndmask_b32 v204, 0, v9, s[92:93]
    v_subrev_u32 v8, 1, v7
    v_add_u32 v10, s90, v8
    v_and_b32 v8, -15, v8
    v_and_b32 v10, -15, v10
    v_cmp_ne_u32 vcc, 0, v8
    v_cmp_ne_u32 s[92:93], 0, v10
    s_nop 0
    v_cndmask_b32 v209, 0, v9, vcc
    v_cndmask_b32 v205, 0, v9, s[92:93]
    v_subrev_u32 v8, 2, v7
    v_add_u32 v10, s90, v8
    v_and_b32 v8, -15, v8
    v_and_b32 v10, -15, v10
    v_cmp_ne_u32 vcc, 0, v8
    v_cmp_ne_u32 s[92:93], 0, v10
    s_nop 0
    v_cndmask_b32 v210, 0, v9, vcc
    v_cndmask_b32 v206, 0, v9, s[92:93]
    v_subrev_u32 v8, 3, v7
    v_add_u32 v10, s90, v8
    v_and_b32 v8, -15, v8
    v_and_b32 v10, -15, v10
    v_cmp_ne_u32 vcc, 0, v8
    v_cmp_ne_u32 s[92:93], 0, v10
    s_nop 0
    v_cndmask_b32 v211, 0, v9, vcc
    v_cndmask_b32 v207, 0, v9, s[92:93]
    s_and_b32 s88, s3, 1
    s_lshr_b32 s89, s3, 1
    s_lshl_b32 s90, s88, 10
    s_cmp_lt_u32 s3, 2
    s_cselect_b32 s91, 0, 8192
    s_add_u32 s90, s90, s91
    v_lshl_add_u32 v214, v2, 3, s90
    v_and_b32 v8, 1, v254
    v_lshl_add_u32 v214, v8, 11, v214
    v_lshrrev_b32 v8, 5, v0
    v_lshl_add_u32 v214, v8, 7, v214
    s_mov_b32 s70, 0xaaaaaaaa
    s_mov_b32 s71, 0xaaaaaaaa
    v_mov_b32 v8, 0
    v_mov_b32 v9, 0
    ds_write_b64 v6, v[8:9]
    ds_write_b64 v6, v[8:9] offset:512
    v_mov_b32 v8, 0x0c0c0100
    v_mov_b32 v9, 0x01000c0c
    v_mov_b32 v10, 0x0c0c0302
    v_mov_b32 v11, 0x03020c0c
    v_cndmask_b32 v212, v8, v9, s[70:71]
    v_cndmask_b32 v213, v10, v11, s[70:71]
    v_and_b32 v131, 7, v0
    v_max_u32 v131, 1, v131
    s_lshl_b32 s90, s5, 7
    s_add_u32 s90, s90, 4096
    v_lshl_add_u32 v131, v131, 2, s90
    v_mul_u32_u24 v218, 896, v2
    v_lshl_add_u32 v218, v254, 3, v218
    s_mul_i32 s90, s3, 14336
    s_add_u32 s90, s90, s68
    s_lshl_b32 s91, s4, 7
    s_add_u32 s90, s90, s91
    v_add_u32 v218, s90, v218
    v_lshlrev_b32 v3, 4, v2
    s_setprio 0
    global_load_ushort v233, v233, s[18:19]
    s_add_u32 m0, s75, 0
    s_nop 0
    buffer_load_dwordx4 v130, s[40:43], s73 offen  lds
    v_lshrrev_b32 v7, 2, v0
    v_lshlrev_b32 v5, 7, v7
    v_and_b32 v7, 1, v0
    v_lshl_add_u32 v5, v7, 3, v5
    v_bfe_u32 v7, v0, 1, 1
    v_lshl_add_u32 v7, 0, 1, v7
    v_bfe_u32 v8, v0, 3, 2
    v_lshlrev_b32 v8, 1, v8
    s_add_u32 m0, s75, 1024
    s_add_u32 s73, s73, 43008
    buffer_load_dwordx4 v130, s[40:43], s73 offen  lds
    v_xor_b32 v7, v7, v8
    v_lshl_add_u32 v5, v7, 4, v5
    s_mul_i32 s90, s88, 28672
    s_add_u32 s90, s90, 100352
    v_add_u32 v219, s90, v5
    v_add_u32 v221, s72, v216
    s_xor_b32 s90, s3, 1
    s_mul_i32 s90, s90, 7168
    s_add_u32 m0, s75, 2048
    s_add_u32 s73, s73, 43008
    buffer_load_dwordx4 v130, s[40:43], s73 offen  lds
    v_add_u32 v222, s90, v216
    v_lshlrev_b32 v223, 4, v254
    v_add_u32 v223, 158720, v223
    v_lshl_add_u32 v5, v254, 9, v3
    s_lshl_b32 s91, s88, 8
    v_add_u32 v5, s91, v5
    s_mul_i32 s90, s89, 28
    s_lshl2_add_u32 s90, s4, s90
    s_add_u32 m0, s75, 3072
    s_add_u32 s73, s73, 43008
    buffer_load_dwordx4 v130, s[40:43], s73 offen  lds
    s_lshl_b32 s90, s90, 10
    s_add_u32 s90, s90, 2048
    v_add_u32 v224, s90, v5
    s_lshl_b32 s90, s89, 14
    s_add_u32 s90, s90, 28672
    v_add_u32 v243, s90, v216
    v_lshl_add_u32 v5, v254, 10, v3
    s_lshl_b32 s90, s3, 8
    s_add_u32 m0, s75, 4096
    s_add_u32 s73, s73, 43008
    buffer_load_dwordx4 v130, s[40:43], s73 offen  lds
    s_add_u32 s90, s90, 116736
    v_add_u32 v225, s90, v5
    v_min_u32 v5, 27, v0
    v_lshlrev_b32 v227, 2, v5
    v_bfe_u32 v5, v0, 1, 1
    v_bfe_u32 v7, v0, 2, 1
    v_lshl_add_u32 v5, v5, 1, v7
    v_bfe_u32 v7, v0, 3, 1
    s_add_u32 m0, s75, 5120
    s_add_u32 s73, s73, 43008
    buffer_load_dwordx4 v130, s[40:43], s73 offen  lds
    v_lshl_add_u32 v5, v7, 2, v5
    v_lshrrev_b32 v7, 5, v0
    v_xor_b32 v5, v5, v7
    v_and_b32 v7, 31, v0
    v_mul_u32_u24 v7, 896, v7
    v_lshl_add_u32 v7, v5, 4, v7
    v_add_u32 v10, 28672, v7
    v_xor_b32 v11, 32, v10
    s_add_u32 m0, s75, 6144
    s_add_u32 s73, s73, 43008
    buffer_load_dwordx4 v130, s[40:43], s73 offen  lds
    v_xor_b32 v12, 64, v10
    v_xor_b32 v13, 0x60, v10
    v_and_b32 v5, 3, v0
    v_lshlrev_b32 v5, 2, v5
    v_add_u32 v215, 157760, v5
    v_min_u32 v5, 55, v0
    s_mul_i32 s90, s3, 896
    s_add_u32 s90, s90, 53248
    s_add_u32 m0, s75, 7168
    s_add_u32 s73, s73, 43008
    buffer_load_dwordx4 v130, s[40:43], s73 offen  lds
    v_lshl_add_u32 v133, v5, 4, s90
    s_lshl_b32 s90, s3, 10
    s_add_u32 s90, s90, 158720
    v_add_u32 v134, s90, v216
    s_lshr_b32 s97, s6, 8
    s_lshl2_add_u32 s90, s3, 157856
    v_mov_b32 v135, s90
    s_setprio 0
    s_mov_b32 s69, s74
    s_waitcnt vmcnt(7)
    s_add_u32 m0, s75, 8192
    s_add_u32 s73, s73, 43008
    buffer_load_dwordx4 v130, s[40:43], s73 offen  lds
    ds_read_b64_tr_b16 v[16:17], v14 offset:0
    ds_read_b64_tr_b16 v[18:19], v14 offset:256
    s_waitcnt vmcnt(7)
    s_add_u32 m0, s75, 9216
    s_add_u32 s73, s73, 43008
    buffer_load_dwordx4 v130, s[40:43], s73 offen  lds
    ds_read_b64_tr_b16 v[20:21], v14 offset:1024
    ds_read_b64_tr_b16 v[22:23], v14 offset:1280
    s_waitcnt vmcnt(7)
    s_add_u32 m0, s75, 10240
    s_add_u32 s73, s73, 43008
    buffer_load_dwordx4 v130, s[40:43], s73 offen  lds
    ds_read_b64_tr_b16 v[24:25], v14 offset:2048
    ds_read_b64_tr_b16 v[26:27], v14 offset:2304
    s_waitcnt vmcnt(7)
    s_add_u32 m0, s75, 11264
    s_add_u32 s73, s73, 43008
    buffer_load_dwordx4 v130, s[40:43], s73 offen  lds
    ds_read_b64_tr_b16 v[28:29], v14 offset:3072
    ds_read_b64_tr_b16 v[30:31], v14 offset:3328
    s_waitcnt vmcnt(7)
    s_add_u32 m0, s75, 12288
    s_add_u32 s73, s73, 43008
    buffer_load_dwordx4 v130, s[40:43], s73 offen  lds
    ds_read_b64_tr_b16 v[32:33], v14 offset:4096
    ds_read_b64_tr_b16 v[34:35], v14 offset:4352
    s_waitcnt vmcnt(7)
    s_add_u32 m0, s75, 13312
    s_add_u32 s73, s73, 43008
    buffer_load_dwordx4 v130, s[40:43], s73 offen  lds
    ds_read_b64_tr_b16 v[36:37], v14 offset:5120
    ds_read_b64_tr_b16 v[38:39], v14 offset:5376
    s_waitcnt vmcnt(7)
    s_add_u32 m0, s72, 0
    s_add_u32 s73, s73, 43008
    buffer_load_dwordx4 v130, s[40:43], s73 offen  lds
    ds_read_b64_tr_b16 v[40:41], v14 offset:6144
    ds_read_b64_tr_b16 v[42:43], v14 offset:6400
    buffer_load_dword v132, v131, s[56:59], 0 offen sc1
    buffer_load_dwordx4 v[136:139], v133, s[56:59], 0 offen offset:0 sc1
    buffer_load_dwordx4 v[140:143], v133, s[56:59], 0 offen offset:3584 sc1
    s_waitcnt vmcnt(10)
    s_add_u32 m0, s72, 1024
    s_add_u32 s73, s73, 43008
    buffer_load_dwordx4 v130, s[40:43], s73 offen  lds
    ds_read_b64_tr_b16 v[44:45], v14 offset:7168
    ds_read_b64_tr_b16 v[46:47], v14 offset:7424
    s_waitcnt vmcnt(10)
    s_add_u32 m0, s72, 2048
    s_add_u32 s73, s73, 43008
    buffer_load_dwordx4 v130, s[40:43], s73 offen  lds
    ds_read_b64_tr_b16 v[48:49], v14 offset:8192
    ds_read_b64_tr_b16 v[50:51], v14 offset:8448
    s_waitcnt vmcnt(10)
    s_add_u32 m0, s72, 3072
    s_add_u32 s73, s73, 43008
    buffer_load_dwordx4 v130, s[40:43], s73 offen  lds
    ds_read_b64_tr_b16 v[52:53], v14 offset:9216
    ds_read_b64_tr_b16 v[54:55], v14 offset:9472
    s_waitcnt vmcnt(10)
    s_add_u32 m0, s72, 4096
    s_add_u32 s73, s73, 43008
    buffer_load_dwordx4 v130, s[40:43], s73 offen  lds
    ds_read_b64_tr_b16 v[56:57], v14 offset:10240
    ds_read_b64_tr_b16 v[58:59], v14 offset:10496
    s_waitcnt vmcnt(10)
    s_add_u32 m0, s72, 5120
    s_add_u32 s73, s73, 43008
    buffer_load_dwordx4 v130, s[40:43], s73 offen  lds
    ds_read_b64_tr_b16 v[60:61], v14 offset:11264
    ds_read_b64_tr_b16 v[62:63], v14 offset:11520
    s_waitcnt vmcnt(10)
    s_add_u32 m0, s72, 6144
    s_add_u32 s73, s73, 43008
    buffer_load_dwordx4 v130, s[40:43], s73 offen  lds
    ds_read_b64_tr_b16 v[64:65], v14 offset:12288
    ds_read_b64_tr_b16 v[66:67], v14 offset:12544
    s_waitcnt vmcnt(10)
    s_waitcnt lgkmcnt(15)
    s_add_u32 m0, s75, 0
    s_add_u32 s73, s73, 43008
    buffer_load_dwordx4 v130, s[40:43], s73 offen  lds
    ds_read_b64_tr_b16 v[68:69], v14 offset:13312
    ds_read_b64_tr_b16 v[70:71], v14 offset:13568
    s_waitcnt vmcnt(10)
    s_add_u32 m0, s75, 1024
    s_add_u32 s73, s73, 43008
    buffer_load_dwordx4 v130, s[40:43], s73 offen  lds
    ds_read_b64_tr_b16 v[72:73], v15 offset:0
    ds_read_b64_tr_b16 v[74:75], v15 offset:256
    s_waitcnt vmcnt(8)
    v_xor_b32 v3, s6, v136
    v_bitop3_b32 v3, v3, v137, s97 bitop3:0xf6
    v_bitop3_b32 v3, v3, v140, s6 bitop3:0xf6
    v_bitop3_b32 v3, v3, v141, s97 bitop3:0xf6
    v_and_b32 v3, 0xff, v3
    v_cmp_ne_u32 vcc, 0, v3
    s_cbranch_vccnz Lre_4
Lreb_5:
    v_and_b32 v136, 0xffffff00, v136
    v_and_b32 v137, 0xffffff00, v137
    v_and_b32 v140, 0xffffff00, v140
    v_and_b32 v141, 0xffffff00, v141
    v_pk_add_f32 v[140:141], v[136:137], v[140:141]
    v_pk_add_f32 v[142:143], v[138:139], v[142:143]
    ds_write_b128 v134, v[140:143]
    ds_write_b32 v135, v217
    s_waitcnt vmcnt(7)
    s_add_u32 m0, s75, 2048
    s_add_u32 s73, s73, 43008
    buffer_load_dwordx4 v130, s[40:43], s73 offen  lds
    ds_read_b64_tr_b16 v[76:77], v15 offset:1024
    ds_read_b64_tr_b16 v[78:79], v15 offset:1280
    v_subrev_u32 v2, s6, v132
    v_cmp_le_u32 vcc, 8, v2
    s_cbranch_vccnz Lre_7
Lreb_8:
    s_getreg_b32 s91, hwreg(HW_REG_XCC_ID, 0, 3)
    s_mul_i32 s64, s5, 577536
    v_cmp_ne_u32 vcc, s91, v2
    s_cmp_lg_u64 vcc, 0
    s_cselect_b32 s7, 1, 0
    s_mul_i32 s90, s7, 29360128
    s_add_u32 s64, s64, s90
    s_add_u32 s64, s64, 4194304
    s_mul_i32 s90, s7, 473088
    s_add_u32 s65, s64, s90
    s_add_u32 s65, s65, 6144
    s_add_u32 s66, s64, 59392
    s_waitcnt vmcnt(7)
    s_add_u32 m0, s75, 3072
    s_add_u32 s73, s73, 43008
    buffer_load_dwordx4 v130, s[40:43], s73 offen  lds
    ds_read_b64_tr_b16 v[80:81], v15 offset:2048
    ds_read_b64_tr_b16 v[82:83], v15 offset:2304
    s_lshl_b32 s90, s4, 13
    s_lshl_b32 s91, s3, 10
    s_add_u32 s90, s90, s91
    s_add_u32 s67, s90, s65
    s_sub_u32 s74, s67, 4096
    s_sub_u32 s84, s67, 8192
    s_add_u32 s85, s67, 4096
    s_cmp_eq_u32 s4, 0
    s_cselect_b32 s84, s85, s84
    s_cmp_eq_u32 s4, 6
    s_cselect_b32 s85, s84, s85
    s_mul_i32 s90, s3, 14336
    s_add_u32 s90, s90, s66
    s_waitcnt vmcnt(7)
    s_add_u32 m0, s75, 4096
    s_add_u32 s73, s73, 43008
    buffer_load_dwordx4 v130, s[40:43], s73 offen  lds
    ds_read_b64_tr_b16 v[84:85], v15 offset:3072
    ds_read_b64_tr_b16 v[86:87], v15 offset:3328
    s_lshl_b32 s91, s4, 11
    s_add_u32 s86, s90, s91
    s_mul_i32 s91, s88, 7168
    s_add_u32 s83, s90, s91
    s_xor_b32 s90, s3, 1
    s_mul_i32 s90, s90, 14336
    s_add_u32 s90, s90, s66
    s_add_u32 s79, s90, s91
    s_lshl2_add_u32 s87, s4, s3
    s_lshl2_add_u32 s87, s87, s64
    s_and_b32 s90, s3, 3
    s_lshr_b32 s91, s90, 1
    s_add_u32 s91, s91, 4
    s_waitcnt vmcnt(7)
    s_waitcnt lgkmcnt(15)
    s_add_u32 m0, s75, 5120
    s_add_u32 s73, s73, 43008
    buffer_load_dwordx4 v130, s[40:43], s73 offen  lds
    ds_read_b64_tr_b16 v[88:89], v15 offset:4096
    ds_read_b64_tr_b16 v[90:91], v15 offset:4352
    s_and_b32 s90, s90, 1
    s_add_u32 s92, s4, s91
    s_add_u32 s92, s92, 1
    s_cmp_ge_u32 s92, 7
    s_cselect_b32 s93, 7, 0
    s_sub_u32 s92, s92, s93
    s_mul_i32 s80, s4, 229376
    s_lshl_b32 s93, s92, 7
    s_add_u32 s80, s80, s93
    s_lshl_b32 s94, s90, 6
    s_add_u32 s80, s80, s94
    s_and_b32 s81, s3, 3
    s_lshl2_add_u32 s81, s92, s81
    s_waitcnt vmcnt(7)
    s_add_u32 m0, s75, 6144
    s_add_u32 s73, s73, 43008
    buffer_load_dwordx4 v130, s[40:43], s73 offen  lds
    ds_read_b64_tr_b16 v[92:93], v15 offset:5120
    ds_read_b64_tr_b16 v[94:95], v15 offset:5376
    s_lshl_b32 s81, s81, 12
    s_add_u32 s81, s81, s64
    s_mul_i32 s94, s7, 358400
    s_add_u32 s81, s81, s94
    s_add_u32 s81, s81, 2048
    s_lshl_b32 s82, s91, 1
    s_add_u32 s82, s82, s90
    s_lshl_b32 s82, s82, 2
    s_add_u32 s82, s82, s93
    s_add_u32 s82, s82, s64
    s_add_u32 s82, s82, 256
    s_waitcnt vmcnt(7)
    ds_read_b64_tr_b16 v[96:97], v15 offset:6144
    ds_read_b64_tr_b16 v[98:99], v15 offset:6400
    s_add_u32 m0, s75, 7168
    s_add_u32 s90, s69, 150528
    buffer_load_dwordx4 v180, s[40:43], s90 offen lds
    s_waitcnt vmcnt(7)
    ds_read_b64_tr_b16 v[100:101], v14 offset:0
    ds_read_b64_tr_b16 v[102:103], v14 offset:256
    s_add_u32 m0, s75, 8192
    s_add_u32 s90, s69, 172032
    buffer_load_dwordx4 v180, s[40:43], s90 offen lds
    s_waitcnt vmcnt(7)
    ds_read_b64_tr_b16 v[104:105], v14 offset:1024
    ds_read_b64_tr_b16 v[106:107], v14 offset:1280
    s_add_u32 m0, s75, 9216
    s_add_u32 s90, s69, 193536
    buffer_load_dwordx4 v180, s[40:43], s90 offen lds
    s_waitcnt vmcnt(7)
    ds_read_b64_tr_b16 v[108:109], v14 offset:2048
    ds_read_b64_tr_b16 v[110:111], v14 offset:2304
    s_add_u32 m0, s75, 10240
    s_add_u32 s90, s69, 215040
    buffer_load_dwordx4 v180, s[40:43], s90 offen lds
    s_barrier
    ds_read_b128 v[128:131], v10 offset:14336
    ds_read_b128 v[132:135], v11 offset:14336
    ds_read_b128 v[136:139], v12 offset:14336
    ds_read_b128 v[140:143], v13 offset:14336
    ds_read_b128 v[144:147], v10 offset:14464
    s_waitcnt lgkmcnt(4)
    v_mfma_f32_32x32x16_bf16 v[148:163], v[16:19], v[128:131], 0
    s_add_u32 m0, s75, 11264
    s_add_u32 s90, s69, 236544
    buffer_load_dwordx4 v180, s[40:43], s90 offen lds
    ds_read_b128 v[128:131], v11 offset:14464
    s_waitcnt lgkmcnt(4)
    v_mfma_f32_32x32x16_bf16 v[148:163], v[20:23], v[132:135], v[148:163]
    s_waitcnt vmcnt(8)
    ds_read_b64_tr_b16 v[112:113], v14 offset:3072
    ds_read_b64_tr_b16 v[114:115], v14 offset:3328
    ds_read_b128 v[132:135], v12 offset:14464
    s_waitcnt lgkmcnt(6)
    v_mfma_f32_32x32x16_bf16 v[148:163], v[24:27], v[136:139], v[148:163]
    ds_read_b128 v[136:139], v13 offset:14464
    s_waitcnt lgkmcnt(6)
    v_mfma_f32_32x32x16_bf16 v[148:163], v[28:31], v[140:143], v[148:163]
    s_waitcnt vmcnt(7)
    ds_read_b64_tr_b16 v[116:117], v14 offset:4096
    ds_read_b64_tr_b16 v[118:119], v14 offset:4352
    s_add_u32 m0, s75, 12288
    s_add_u32 s90, s69, 258048
    buffer_load_dwordx4 v180, s[40:43], s90 offen lds
    ds_read_b128 v[140:143], v10 offset:14592
    s_waitcnt lgkmcnt(8)
    v_mfma_f32_32x32x16_bf16 v[148:163], v[32:35], v[144:147], v[148:163]
    ds_read_b128 v[144:147], v11 offset:14592
    s_waitcnt lgkmcnt(8)
    v_mfma_f32_32x32x16_bf16 v[148:163], v[36:39], v[128:131], v[148:163]
    s_waitcnt vmcnt(7)
    ds_read_b64_tr_b16 v[120:121], v14 offset:5120
    ds_read_b64_tr_b16 v[122:123], v14 offset:5376
    ds_read_b128 v[128:131], v12 offset:14592
    s_waitcnt lgkmcnt(8)
    v_mfma_f32_32x32x16_bf16 v[148:163], v[40:43], v[132:135], v[148:163]
    s_add_u32 m0, s75, 13312
    s_add_u32 s90, s69, 279552
    buffer_load_dwordx4 v180, s[40:43], s90 offen lds
    ds_read_b128 v[132:135], v13 offset:14592
    s_waitcnt lgkmcnt(8)
    v_mfma_f32_32x32x16_bf16 v[148:163], v[44:47], v[136:139], v[148:163]
    s_waitcnt vmcnt(7)
    ds_read_b64_tr_b16 v[124:125], v14 offset:6144
    ds_read_b64_tr_b16 v[126:127], v14 offset:6400
    ds_read_b128 v[136:139], v10 offset:14720
    s_waitcnt lgkmcnt(8)
    v_mfma_f32_32x32x16_bf16 v[148:163], v[48:51], v[140:143], v[148:163]
    ds_read_b128 v[140:143], v11 offset:14720
    s_waitcnt lgkmcnt(8)
    v_mfma_f32_32x32x16_bf16 v[148:163], v[52:55], v[144:147], v[148:163]
    s_add_u32 m0, s75, 0
    s_add_u32 s90, s69, 0
    buffer_load_dwordx4 v180, s[40:43], s90 offen lds
    ds_read_b128 v[144:147], v12 offset:14720
    s_waitcnt lgkmcnt(6)
    v_mfma_f32_32x32x16_bf16 v[148:163], v[56:59], v[128:131], v[148:163]
    ds_read_b128 v[128:131], v13 offset:14720
    s_waitcnt lgkmcnt(6)
    v_mfma_f32_32x32x16_bf16 v[148:163], v[60:63], v[132:135], v[148:163]
    ds_read_b128 v[132:135], v10 offset:14848
    s_waitcnt lgkmcnt(4)
    v_mfma_f32_32x32x16_bf16 v[148:163], v[64:67], v[136:139], v[148:163]
    s_add_u32 m0, s75, 1024
    s_add_u32 s90, s69, 21504
    buffer_load_dwordx4 v180, s[40:43], s90 offen lds
    ds_read_b128 v[136:139], v11 offset:14848
    s_waitcnt lgkmcnt(4)
    v_mfma_f32_32x32x16_bf16 v[148:163], v[68:71], v[140:143], v[148:163]
    ds_read_b128 v[140:143], v12 offset:14848
    s_waitcnt lgkmcnt(4)
    v_mfma_f32_32x32x16_bf16 v[148:163], v[72:75], v[144:147], v[148:163]
    ds_read_b128 v[144:147], v13 offset:14848
    s_waitcnt lgkmcnt(4)
    v_mfma_f32_32x32x16_bf16 v[148:163], v[76:79], v[128:131], v[148:163]
    s_add_u32 m0, s75, 2048
    s_add_u32 s90, s69, 43008
    buffer_load_dwordx4 v180, s[40:43], s90 offen lds
    ds_read_b128 v[128:131], v10 offset:14976
    s_waitcnt lgkmcnt(4)
    v_mfma_f32_32x32x16_bf16 v[148:163], v[80:83], v[132:135], v[148:163]
    ds_read_b128 v[132:135], v11 offset:14976
    s_waitcnt lgkmcnt(4)
    v_mfma_f32_32x32x16_bf16 v[148:163], v[84:87], v[136:139], v[148:163]
    ds_read_b128 v[136:139], v12 offset:14976
    s_waitcnt lgkmcnt(4)
    v_mfma_f32_32x32x16_bf16 v[148:163], v[88:91], v[140:143], v[148:163]
    s_add_u32 m0, s75, 3072
    s_add_u32 s90, s69, 64512
    buffer_load_dwordx4 v180, s[40:43], s90 offen lds
    ds_read_b128 v[140:143], v13 offset:14976
    s_waitcnt lgkmcnt(4)
    v_mfma_f32_32x32x16_bf16 v[148:163], v[92:95], v[144:147], v[148:163]
    ds_read_b128 v[144:147], v10 offset:15104
    s_waitcnt lgkmcnt(4)
    v_mfma_f32_32x32x16_bf16 v[148:163], v[96:99], v[128:131], v[148:163]
    ds_read_b128 v[128:131], v11 offset:15104
    s_waitcnt lgkmcnt(4)
    v_mfma_f32_32x32x16_bf16 v[148:163], v[100:103], v[132:135], v[148:163]
    s_add_u32 m0, s75, 4096
    s_add_u32 s90, s69, 86016
    buffer_load_dwordx4 v180, s[40:43], s90 offen lds
    ds_read_b128 v[132:135], v12 offset:15104
    s_waitcnt lgkmcnt(4)
    v_mfma_f32_32x32x16_bf16 v[148:163], v[104:107], v[136:139], v[148:163]
    ds_read_b128 v[136:139], v13 offset:15104
    s_waitcnt lgkmcnt(4)
    v_mfma_f32_32x32x16_bf16 v[148:163], v[108:111], v[140:143], v[148:163]
    s_barrier
    ds_read_b128 v[140:143], v10 offset:43008
    s_waitcnt lgkmcnt(4)
    v_mfma_f32_32x32x16_bf16 v[148:163], v[112:115], v[144:147], v[148:163]
    s_add_u32 m0, s75, 5120
    s_add_u32 s90, s69, 107520
    buffer_load_dwordx4 v180, s[40:43], s90 offen lds
    ds_read_b128 v[144:147], v11 offset:43008
    s_waitcnt lgkmcnt(4)
    v_mfma_f32_32x32x16_bf16 v[148:163], v[116:119], v[128:131], v[148:163]
    ds_read_b128 v[128:131], v12 offset:43008
    s_waitcnt lgkmcnt(4)
    v_mfma_f32_32x32x16_bf16 v[148:163], v[120:123], v[132:135], v[148:163]
    ds_read_b128 v[132:135], v13 offset:43008
    s_waitcnt lgkmcnt(4)
    v_mfma_f32_32x32x16_bf16 v[148:163], v[124:127], v[136:139], v[148:163]
    s_add_u32 m0, s75, 6144
    s_add_u32 s90, s69, 129024
    buffer_load_dwordx4 v180, s[40:43], s90 offen lds
    ds_read_b128 v[136:139], v10 offset:43136
    s_waitcnt lgkmcnt(4)
    v_mfma_f32_32x32x16_bf16 v[164:179], v[16:19], v[140:143], 0
    ds_read_b128 v[140:143], v11 offset:43136
    s_waitcnt lgkmcnt(4)
    v_mfma_f32_32x32x16_bf16 v[164:179], v[20:23], v[144:147], v[164:179]
    ds_read_b128 v[144:147], v12 offset:43136
    s_waitcnt lgkmcnt(4)
    v_mfma_f32_32x32x16_bf16 v[164:179], v[24:27], v[128:131], v[164:179]
    ds_read_b128 v[128:131], v13 offset:43136
    s_waitcnt lgkmcnt(4)
    v_mfma_f32_32x32x16_bf16 v[164:179], v[28:31], v[132:135], v[164:179]
    ds_read_b128 v[132:135], v10 offset:43264
    s_waitcnt lgkmcnt(4)
    v_mfma_f32_32x32x16_bf16 v[164:179], v[32:35], v[136:139], v[164:179]
    ds_read_b128 v[136:139], v11 offset:43264
    s_waitcnt lgkmcnt(4)
    v_mfma_f32_32x32x16_bf16 v[164:179], v[36:39], v[140:143], v[164:179]
    ds_read_b128 v[140:143], v12 offset:43264
    s_waitcnt lgkmcnt(4)
    v_mfma_f32_32x32x16_bf16 v[164:179], v[40:43], v[144:147], v[164:179]
    ds_read_b128 v[144:147], v13 offset:43264
    s_waitcnt lgkmcnt(4)
    v_mfma_f32_32x32x16_bf16 v[164:179], v[44:47], v[128:131], v[164:179]
    ds_read_b128 v[128:131], v10 offset:43392
    s_waitcnt lgkmcnt(4)
    v_mfma_f32_32x32x16_bf16 v[164:179], v[48:51], v[132:135], v[164:179]
    ds_read_b128 v[132:135], v11 offset:43392
    s_waitcnt lgkmcnt(4)
    v_mfma_f32_32x32x16_bf16 v[164:179], v[52:55], v[136:139], v[164:179]
    ds_read_b128 v[136:139], v12 offset:43392
    s_waitcnt lgkmcnt(4)
    v_mfma_f32_32x32x16_bf16 v[164:179], v[56:59], v[140:143], v[164:179]
    ds_read_b128 v[140:143], v13 offset:43392
    s_waitcnt lgkmcnt(4)
    v_mfma_f32_32x32x16_bf16 v[164:179], v[60:63], v[144:147], v[164:179]
    ds_read_b128 v[144:147], v10 offset:43520
    s_waitcnt lgkmcnt(4)
    v_mfma_f32_32x32x16_bf16 v[164:179], v[64:67], v[128:131], v[164:179]
    ds_read_b128 v[128:131], v11 offset:43520
    s_waitcnt lgkmcnt(4)
    v_mfma_f32_32x32x16_bf16 v[164:179], v[68:71], v[132:135], v[164:179]
    ds_read_b128 v[132:135], v12 offset:43520
    s_waitcnt lgkmcnt(4)
    v_mfma_f32_32x32x16_bf16 v[164:179], v[72:75], v[136:139], v[164:179]
    s_waitcnt vmcnt(0)
    s_barrier
    ds_read_b128 v[136:139], v13 offset:43520
    s_waitcnt lgkmcnt(4)
    v_mfma_f32_32x32x16_bf16 v[164:179], v[76:79], v[140:143], v[164:179]
    ds_read_b128 v[140:143], v10 offset:43648
    s_waitcnt lgkmcnt(4)
    v_mfma_f32_32x32x16_bf16 v[164:179], v[80:83], v[144:147], v[164:179]
    buffer_load_dwordx2 v[244:245], v218, s[36:39], 0 offen offset:0
    ds_read_b128 v[144:147], v11 offset:43648
    s_waitcnt lgkmcnt(4)
    v_mfma_f32_32x32x16_bf16 v[164:179], v[84:87], v[128:131], v[164:179]
    v_cvt_pk_bf16_f32 v6, v148, v149
    v_cvt_pk_bf16_f32 v7, v150, v151
    ds_write_b64 v214, v[6:7] offset:2048
    ds_read_b128 v[128:131], v12 offset:43648
    s_waitcnt lgkmcnt(5)
    v_mfma_f32_32x32x16_bf16 v[164:179], v[88:91], v[132:135], v[164:179]
    ds_read_b128 v[132:135], v13 offset:43648
    s_waitcnt lgkmcnt(5)
    v_mfma_f32_32x32x16_bf16 v[164:179], v[92:95], v[136:139], v[164:179]
    v_cvt_pk_bf16_f32 v8, v152, v153
    v_cvt_pk_bf16_f32 v9, v154, v155
    ds_write_b64 v214, v[8:9] offset:2304
    buffer_load_dwordx2 v[246:247], v218, s[36:39], 0 offen offset:32
    ds_read_b128 v[136:139], v10 offset:43776
    s_waitcnt lgkmcnt(6)
    v_mfma_f32_32x32x16_bf16 v[164:179], v[96:99], v[140:143], v[164:179]
    ds_read_b128 v[140:143], v11 offset:43776
    s_waitcnt lgkmcnt(6)
    v_mfma_f32_32x32x16_bf16 v[164:179], v[100:103], v[144:147], v[164:179]
    v_cvt_pk_bf16_f32 v6, v156, v157
    v_cvt_pk_bf16_f32 v7, v158, v159
    ds_write_b64 v214, v[6:7] offset:2560
    ds_read_b128 v[144:147], v12 offset:43776
    s_waitcnt lgkmcnt(6)
    v_mfma_f32_32x32x16_bf16 v[164:179], v[104:107], v[128:131], v[164:179]
    buffer_load_dwordx2 v[248:249], v218, s[36:39], 0 offen offset:64
    ds_read_b128 v[128:131], v13 offset:43776
    s_waitcnt lgkmcnt(6)
    v_mfma_f32_32x32x16_bf16 v[164:179], v[108:111], v[132:135], v[164:179]
    v_cvt_pk_bf16_f32 v8, v160, v161
    v_cvt_pk_bf16_f32 v9, v162, v163
    ds_write_b64 v214, v[8:9] offset:2816
    ds_read_b128 v[132:135], v10 offset:0
    s_waitcnt lgkmcnt(6)
    v_mfma_f32_32x32x16_bf16 v[164:179], v[112:115], v[136:139], v[164:179]
    ds_read_b128 v[136:139], v11 offset:0
    s_waitcnt lgkmcnt(6)
    v_mfma_f32_32x32x16_bf16 v[164:179], v[116:119], v[140:143], v[164:179]
    buffer_load_dwordx2 v[250:251], v218, s[36:39], 0 offen offset:96
    ds_read_b128 v[140:143], v12 offset:0
    s_waitcnt lgkmcnt(5)
    v_mfma_f32_32x32x16_bf16 v[164:179], v[120:123], v[144:147], v[164:179]
    ds_read_b128 v[144:147], v13 offset:0
    s_waitcnt lgkmcnt(5)
    v_mfma_f32_32x32x16_bf16 v[164:179], v[124:127], v[128:131], v[164:179]
    s_cmp_ge_u32 s3, 2
    s_cbranch_scc1 L_10
    ds_read_b128 v[128:131], v10 offset:128
    s_waitcnt lgkmcnt(4)
    v_mfma_f32_32x32x16_bf16 v[148:163], v[16:19], v[132:135], 0
    ds_read_b128 v[132:135], v11 offset:128
    s_waitcnt lgkmcnt(4)
    v_mfma_f32_32x32x16_bf16 v[148:163], v[20:23], v[136:139], v[148:163]
    ds_read_b128 v[136:139], v12 offset:128
    s_waitcnt lgkmcnt(4)
    v_mfma_f32_32x32x16_bf16 v[148:163], v[24:27], v[140:143], v[148:163]
    ds_read_b128 v[140:143], v13 offset:128
    s_waitcnt lgkmcnt(4)
    v_mfma_f32_32x32x16_bf16 v[148:163], v[28:31], v[144:147], v[148:163]
    ds_read_b128 v[144:147], v10 offset:256
    s_waitcnt lgkmcnt(4)
    v_mfma_f32_32x32x16_bf16 v[148:163], v[32:35], v[128:131], v[148:163]
    ds_read_b128 v[128:131], v11 offset:256
    s_waitcnt lgkmcnt(4)
    v_mfma_f32_32x32x16_bf16 v[148:163], v[36:39], v[132:135], v[148:163]
    v_cvt_pk_bf16_f32 v6, v164, v165
    v_cvt_pk_bf16_f32 v7, v166, v167
    ds_write_b64 v214, v[6:7] offset:6144
    ds_read_b128 v[132:135], v12 offset:256
    s_waitcnt lgkmcnt(5)
    v_mfma_f32_32x32x16_bf16 v[148:163], v[40:43], v[136:139], v[148:163]
    ds_read_b128 v[136:139], v13 offset:256
    s_waitcnt lgkmcnt(5)
    v_mfma_f32_32x32x16_bf16 v[148:163], v[44:47], v[140:143], v[148:163]
    v_cvt_pk_bf16_f32 v8, v168, v169
    v_cvt_pk_bf16_f32 v9, v170, v171
    ds_write_b64 v214, v[8:9] offset:6400
    ds_read_b128 v[140:143], v10 offset:384
    s_waitcnt lgkmcnt(6)
    v_mfma_f32_32x32x16_bf16 v[148:163], v[48:51], v[144:147], v[148:163]
    ds_read_b128 v[144:147], v11 offset:384
    s_waitcnt lgkmcnt(6)
    v_mfma_f32_32x32x16_bf16 v[148:163], v[52:55], v[128:131], v[148:163]
    v_cvt_pk_bf16_f32 v6, v172, v173
    v_cvt_pk_bf16_f32 v7, v174, v175
    ds_write_b64 v214, v[6:7] offset:6656
    ds_read_b128 v[128:131], v12 offset:384
    s_waitcnt lgkmcnt(6)
    v_mfma_f32_32x32x16_bf16 v[148:163], v[56:59], v[132:135], v[148:163]
    ds_read_b128 v[132:135], v13 offset:384
    s_waitcnt lgkmcnt(6)
    v_mfma_f32_32x32x16_bf16 v[148:163], v[60:63], v[136:139], v[148:163]
    v_cvt_pk_bf16_f32 v8, v176, v177
    v_cvt_pk_bf16_f32 v9, v178, v179
    ds_write_b64 v214, v[8:9] offset:6912
    ds_read_b128 v[136:139], v10 offset:512
    s_waitcnt lgkmcnt(6)
    v_mfma_f32_32x32x16_bf16 v[148:163], v[64:67], v[140:143], v[148:163]
    ds_read_b128 v[140:143], v11 offset:512
    s_waitcnt lgkmcnt(6)
    v_mfma_f32_32x32x16_bf16 v[148:163], v[68:71], v[144:147], v[148:163]
    ds_read_b128 v[144:147], v12 offset:512
    s_waitcnt lgkmcnt(5)
    v_mfma_f32_32x32x16_bf16 v[148:163], v[72:75], v[128:131], v[148:163]
    ds_read_b128 v[128:131], v13 offset:512
    s_waitcnt lgkmcnt(5)
    v_mfma_f32_32x32x16_bf16 v[148:163], v[76:79], v[132:135], v[148:163]
    ds_read_b128 v[132:135], v10 offset:640
    s_waitcnt lgkmcnt(4)
    v_mfma_f32_32x32x16_bf16 v[148:163], v[80:83], v[136:139], v[148:163]
    ds_read_b128 v[136:139], v11 offset:640
    s_waitcnt lgkmcnt(4)
    v_mfma_f32_32x32x16_bf16 v[148:163], v[84:87], v[140:143], v[148:163]
    ds_read_b128 v[140:143], v12 offset:640
    s_waitcnt lgkmcnt(4)
    v_mfma_f32_32x32x16_bf16 v[148:163], v[88:91], v[144:147], v[148:163]
    ds_read_b128 v[144:147], v13 offset:640
    s_waitcnt lgkmcnt(4)
    v_mfma_f32_32x32x16_bf16 v[148:163], v[92:95], v[128:131], v[148:163]
    ds_read_b128 v[128:131], v10 offset:768
    s_waitcnt lgkmcnt(4)
    v_mfma_f32_32x32x16_bf16 v[148:163], v[96:99], v[132:135], v[148:163]
    ds_read_b128 v[132:135], v11 offset:768
    s_waitcnt lgkmcnt(4)
    v_mfma_f32_32x32x16_bf16 v[148:163], v[100:103], v[136:139], v[148:163]
    ds_read_b128 v[136:139], v12 offset:768
    s_waitcnt lgkmcnt(4)
    v_mfma_f32_32x32x16_bf16 v[148:163], v[104:107], v[140:143], v[148:163]
    ds_read_b128 v[140:143], v13 offset:768
    s_waitcnt lgkmcnt(4)
    v_mfma_f32_32x32x16_bf16 v[148:163], v[108:111], v[144:147], v[148:163]
    s_waitcnt lgkmcnt(3)
    v_mfma_f32_32x32x16_bf16 v[148:163], v[112:115], v[128:131], v[148:163]
    s_waitcnt lgkmcnt(2)
    v_mfma_f32_32x32x16_bf16 v[148:163], v[116:119], v[132:135], v[148:163]
    s_waitcnt lgkmcnt(1)
    v_mfma_f32_32x32x16_bf16 v[148:163], v[120:123], v[136:139], v[148:163]
    s_waitcnt lgkmcnt(0)
    v_mfma_f32_32x32x16_bf16 v[148:163], v[124:127], v[140:143], v[148:163]
    s_nop 11
    v_cvt_pk_bf16_f32 v6, v148, v149
    v_cvt_pk_bf16_f32 v7, v150, v151
    ds_write_b64 v214, v[6:7] offset:0
    v_cvt_pk_bf16_f32 v8, v152, v153
    v_cvt_pk_bf16_f32 v9, v154, v155
    ds_write_b64 v214, v[8:9] offset:256
    v_cvt_pk_bf16_f32 v6, v156, v157
    v_cvt_pk_bf16_f32 v7, v158, v159
    ds_write_b64 v214, v[6:7] offset:512
    v_cvt_pk_bf16_f32 v8, v160, v161
    v_cvt_pk_bf16_f32 v9, v162, v163
    ds_write_b64 v214, v[8:9] offset:768
L_11:
    s_setprio 3
    v_mov_b32 v131, v217
    v_mov_b32 v135, v217
    s_mov_b32 s90, 0x05030201
    s_mov_b32 s91, 0x06030201
    s_mov_b32 s92, 0x07030201
    s_waitcnt lgkmcnt(0)
    s_barrier
    ds_read_b64 v[16:17], v185
    ds_read_b64 v[18:19], v186
    ds_read_b64 v[20:21], v181 offset:0
    ds_read_b64 v[22:23], v181 offset:512
    ds_read_b64 v[24:25], v181 offset:2048
    ds_read_b64 v[26:27], v181 offset:2560
    ds_read_b64 v[76:77], v191
    ds_read_b64 v[78:79], v192
    ds_read_b64 v[80:81], v184 offset:0
    ds_read_b64 v[82:83], v184 offset:512
    ds_read_b64 v[84:85], v184 offset:2048
    ds_read_b64 v[86:87], v184 offset:2560
    s_waitcnt lgkmcnt(6)
    v_mfma_f32_16x16x32_bf16 v[28:31], v[20:23], v[16:19], v[204:207]
    v_mfma_f32_16x16x32_bf16 v[32:35], v[24:27], v[16:19], v[208:211]
    s_waitcnt lgkmcnt(0)
    v_mfma_f32_16x16x32_bf16 v[88:91], v[80:83], v[76:79], v[204:207]
    v_mfma_f32_16x16x32_bf16 v[92:95], v[84:87], v[76:79], v[208:211]
    ds_read_b64 v[36:37], v187
    ds_read_b64 v[38:39], v188
    ds_read_b64 v[40:41], v182 offset:0
    ds_read_b64 v[42:43], v182 offset:512
    ds_read_b64 v[44:45], v182 offset:2048
    ds_read_b64 v[46:47], v182 offset:2560
    v_cndmask_b32 v96, v28, v29, s[70:71]
    v_cndmask_b32 v97, v30, v31, s[70:71]
    v_cndmask_b32 v98, v32, v33, s[70:71]
    v_cndmask_b32 v99, v34, v35, s[70:71]
    v_perm_b32 v128, v99, v96, s90
    v_perm_b32 v129, v99, v97, s91
    v_perm_b32 v130, v99, v98, s92
    v_cndmask_b32 v108, v88, v89, s[70:71]
    v_cndmask_b32 v109, v90, v91, s[70:71]
    v_cndmask_b32 v110, v92, v93, s[70:71]
    v_cndmask_b32 v111, v94, v95, s[70:71]
    v_perm_b32 v132, v111, v108, s90
    v_perm_b32 v133, v111, v109, s91
    v_perm_b32 v134, v111, v110, s92
    s_cmp_lg_u32 s7, 0
    s_cbranch_scc1 Lslow_12
    buffer_store_dwordx4 v[128:131], v216, s[56:59], s74 offen
    buffer_store_dwordx4 v[132:135], v216, s[56:59], s67 offen
Lback_13:
    ds_read_b64 v[56:57], v189
    ds_read_b64 v[58:59], v190
    ds_read_b64 v[60:61], v183 offset:0
    ds_read_b64 v[62:63], v183 offset:512
    ds_read_b64 v[64:65], v183 offset:2048
    ds_read_b64 v[66:67], v183 offset:2560
    s_waitcnt lgkmcnt(6)
    v_mfma_f32_16x16x32_bf16 v[48:51], v[40:43], v[36:39], v[204:207]
    v_mfma_f32_16x16x32_bf16 v[52:55], v[44:47], v[36:39], v[208:211]
    s_waitcnt lgkmcnt(0)
    v_mfma_f32_16x16x32_bf16 v[68:71], v[60:63], v[56:59], v[204:207]
    v_mfma_f32_16x16x32_bf16 v[72:75], v[64:67], v[56:59], v[208:211]
    s_setprio 1
    s_mov_b32 s94, 0x3e8b97f6
    s_mov_b32 s90, 0x0c07030c
    s_mov_b32 s91, 0xff000000
    s_nop 1
    v_cndmask_b32 v100, v48, v49, s[70:71]
    v_cndmask_b32 v101, v50, v51, s[70:71]
    v_cndmask_b32 v102, v52, v53, s[70:71]
    v_cndmask_b32 v103, v54, v55, s[70:71]
    v_cndmask_b32 v104, v68, v69, s[70:71]
    v_cndmask_b32 v105, v70, v71, s[70:71]
    v_cndmask_b32 v106, v72, v73, s[70:71]
    v_cndmask_b32 v107, v74, v75, s[70:71]
    v_max3_f32 v2, v100, v101, v102
    v_max_f32 v2, v2, v103
    v_max3_f32 v3, v104, v105, v106
    v_max_f32 v3, v3, v107
    s_nop 1
    v_permlane32_swap_b32 v2, v3
    v_max_f32 v2, v2, v3
    v_mov_b32 v4, v2
    s_nop 1
    v_permlane16_swap_b32 v2, v4
    v_max_f32 v2, v2, v4
    v_mov_b32 v3, v2
    s_nop 1
    v_permlane32_swap_b32 v2, v3
    v_mul_f32 v2, s94, v2
    v_mul_f32 v3, s94, v3
    v_fma_f32 v100, v100, s94, -v2
    v_fma_f32 v101, v101, s94, -v2
    v_fma_f32 v102, v102, s94, -v2
    v_fma_f32 v103, v103, s94, -v2
    v_fma_f32 v104, v104, s94, -v3
    v_fma_f32 v105, v105, s94, -v3
    v_fma_f32 v106, v106, s94, -v3
    v_fma_f32 v107, v107, s94, -v3
    v_exp_f32 v100, v100
    v_exp_f32 v101, v101
    v_exp_f32 v102, v102
    v_exp_f32 v103, v103
    v_exp_f32 v104, v104
    v_exp_f32 v105, v105
    v_exp_f32 v106, v106
    v_exp_f32 v107, v107
    v_add_f32 v2, v100, v101
    v_add_f32 v4, v102, v103
    v_add_f32 v2, v2, v4
    v_add_f32 v3, v104, v105
    v_add_f32 v4, v106, v107
    v_add_f32 v3, v3, v4
    s_nop 1
    v_permlane32_swap_b32 v2, v3
    v_add_f32 v2, v2, v3
    v_mov_b32 v4, v2
    s_nop 1
    v_permlane16_swap_b32 v2, v4
    v_add_f32 v2, v2, v4
    v_mov_b32 v3, v2
    s_nop 1
    v_permlane32_swap_b32 v2, v3
    v_rcp_f32 v2, v2
    v_rcp_f32 v3, v3
    v_mul_f32 v100, v100, v2
    v_mul_f32 v101, v101, v2
    v_mul_f32 v102, v102, v2
    v_mul_f32 v103, v103, v2
    v_mul_f32 v104, v104, v3
    v_mul_f32 v105, v105, v3
    v_mul_f32 v106, v106, v3
    v_mul_f32 v107, v107, v3
    s_setprio 3
    buffer_load_dwordx4 v[136:139], v216, s[56:59], s84 offen sc1
    buffer_load_dwordx4 v[140:143], v216, s[56:59], s85 offen sc1
    s_setprio 1
    v_cvt_pk_bf16_f32 v4, v100, v101
    v_perm_b32 v116, v4, v4, v212
    v_perm_b32 v117, v4, v4, v213
    v_cvt_pk_bf16_f32 v4, v102, v103
    v_perm_b32 v118, v4, v4, v212
    v_perm_b32 v119, v4, v4, v213
    v_cvt_pk_bf16_f32 v4, v104, v105
    v_perm_b32 v120, v4, v4, v212
    v_perm_b32 v121, v4, v4, v213
    v_cvt_pk_bf16_f32 v4, v106, v107
    v_perm_b32 v122, v4, v4, v212
    v_perm_b32 v123, v4, v4, v213
    s_setprio 3
    s_waitcnt vmcnt(0)
    v_xor_b32 v4, s6, v139
    v_bitop3_b32 v4, v4, v143, s6 bitop3:0xf6
    v_cmp_ne_u32 vcc, 0, v4
    s_cbranch_vccnz Lre_14
Lreb_15:
    s_setprio 1
    v_perm_b32 v4, v137, v136, s90
    v_and_or_b32 v4, v138, s91, v4
    v_add_f32 v99, v99, v4
    v_lshlrev_b32 v4, 8, v136
    v_add_f32 v96, v96, v4
    v_lshlrev_b32 v4, 8, v137
    v_add_f32 v97, v97, v4
    v_lshlrev_b32 v4, 8, v138
    v_add_f32 v98, v98, v4
    v_perm_b32 v4, v141, v140, s90
    v_and_or_b32 v4, v142, s91, v4
    v_add_f32 v111, v111, v4
    v_lshlrev_b32 v4, 8, v140
    v_add_f32 v108, v108, v4
    v_lshlrev_b32 v4, 8, v141
    v_add_f32 v109, v109, v4
    v_lshlrev_b32 v4, 8, v142
    v_add_f32 v110, v110, v4
    v_max3_f32 v2, v96, v97, v98
    v_max_f32 v2, v2, v99
    v_max3_f32 v3, v108, v109, v110
    v_max_f32 v3, v3, v111
    s_nop 1
    v_permlane32_swap_b32 v2, v3
    v_max_f32 v2, v2, v3
    v_mov_b32 v4, v2
    s_nop 1
    v_permlane16_swap_b32 v2, v4
    v_max_f32 v2, v2, v4
    v_mov_b32 v3, v2
    s_nop 1
    v_permlane32_swap_b32 v2, v3
    v_mul_f32 v2, s94, v2
    v_mul_f32 v3, s94, v3
    v_fma_f32 v96, v96, s94, -v2
    v_fma_f32 v97, v97, s94, -v2
    v_fma_f32 v98, v98, s94, -v2
    v_fma_f32 v99, v99, s94, -v2
    v_fma_f32 v108, v108, s94, -v3
    v_fma_f32 v109, v109, s94, -v3
    v_fma_f32 v110, v110, s94, -v3
    v_fma_f32 v111, v111, s94, -v3
    v_exp_f32 v96, v96
    v_exp_f32 v97, v97
    v_exp_f32 v98, v98
    v_exp_f32 v99, v99
    v_exp_f32 v108, v108
    v_exp_f32 v109, v109
    v_exp_f32 v110, v110
    v_exp_f32 v111, v111
    ds_read_b32 v5, v215 offset:32
    ds_read_b64 v[16:17], v193
    ds_read_b64 v[18:19], v193 offset:512
    ds_read_b64 v[20:21], v194
    ds_read_b64 v[22:23], v194 offset:512
    ds_read_b64 v[24:25], v195
    ds_read_b64 v[26:27], v195 offset:512
    ds_read_b64 v[28:29], v196
    ds_read_b64 v[30:31], v196 offset:512
    ds_read_b64 v[32:33], v197
    ds_read_b64 v[34:35], v197 offset:512
    ds_read_b64 v[36:37], v198
    ds_read_b64 v[38:39], v198 offset:512
    ds_read_b64 v[40:41], v199
    ds_read_b64 v[42:43], v199 offset:512
    ds_read_b64 v[44:45], v200
    ds_read_b64 v[46:47], v200 offset:512
    v_add_f32 v2, v96, v97
    v_add_f32 v4, v98, v99
    v_add_f32 v2, v2, v4
    v_add_f32 v3, v108, v109
    v_add_f32 v4, v110, v111
    v_add_f32 v3, v3, v4
    ds_read_b64 v[48:49], v201
    ds_read_b64 v[50:51], v201 offset:512
    v_permlane32_swap_b32 v2, v3
    v_add_f32 v2, v2, v3
    v_mov_b32 v4, v2
    ds_read_b64 v[52:53], v202
    ds_read_b64 v[54:55], v202 offset:512
    v_permlane16_swap_b32 v2, v4
    v_add_f32 v2, v2, v4
    v_mov_b32 v3, v2
    ds_read_b64 v[56:57], v203
    ds_read_b64 v[58:59], v203 offset:512
    v_permlane32_swap_b32 v2, v3
    v_rcp_f32 v2, v2
    v_rcp_f32 v3, v3
    v_mul_f32 v96, v96, v2
    v_mul_f32 v97, v97, v2
    v_mul_f32 v98, v98, v2
    v_mul_f32 v99, v99, v2
    v_mul_f32 v108, v108, v3
    v_mul_f32 v109, v109, v3
    v_mul_f32 v110, v110, v3
    v_mul_f32 v111, v111, v3
    s_waitcnt lgkmcnt(15)
    v_cmp_ne_u32 vcc, s6, v5
    s_cbranch_vccnz Llr_17
Llrb_18:
    v_mfma_f32_16x16x32_bf16 v[144:147], v[16:19], v[116:119], 0
    v_mfma_f32_16x16x32_bf16 v[148:151], v[20:23], v[116:119], 0
    v_mfma_f32_16x16x32_bf16 v[152:155], v[24:27], v[116:119], 0
    s_waitcnt lgkmcnt(14)
    v_mfma_f32_16x16x32_bf16 v[156:159], v[28:31], v[116:119], 0
    s_waitcnt lgkmcnt(12)
    v_mfma_f32_16x16x32_bf16 v[148:151], v[32:35], v[120:123], v[148:151]
    s_waitcnt lgkmcnt(10)
    v_mfma_f32_16x16x32_bf16 v[152:155], v[36:39], v[120:123], v[152:155]
    s_waitcnt lgkmcnt(8)
    v_mfma_f32_16x16x32_bf16 v[156:159], v[40:43], v[120:123], v[156:159]
    v_cvt_pk_bf16_f32 v4, v96, v97
    v_perm_b32 v112, v4, v4, v212
    v_perm_b32 v113, v4, v4, v213
    v_cvt_pk_bf16_f32 v4, v98, v99
    v_perm_b32 v114, v4, v4, v212
    v_perm_b32 v115, v4, v4, v213
    v_cvt_pk_bf16_f32 v4, v108, v109
    v_perm_b32 v124, v4, v4, v212
    v_perm_b32 v125, v4, v4, v213
    v_cvt_pk_bf16_f32 v4, v110, v111
    v_perm_b32 v126, v4, v4, v212
    v_perm_b32 v127, v4, v4, v213
    s_waitcnt lgkmcnt(6)
    v_mfma_f32_16x16x32_bf16 v[144:147], v[44:47], v[112:115], v[144:147]
    s_waitcnt lgkmcnt(4)
    v_mfma_f32_16x16x32_bf16 v[148:151], v[48:51], v[112:115], v[148:151]
    s_waitcnt lgkmcnt(2)
    v_mfma_f32_16x16x32_bf16 v[152:155], v[52:55], v[124:127], v[152:155]
    s_waitcnt lgkmcnt(0)
    v_mfma_f32_16x16x32_bf16 v[156:159], v[56:59], v[124:127], v[156:159]
    v_xor_b32 v220, 64, v219
    v_xor_b32 v2, 32, v219
    v_xor_b32 v3, 0x60, v219
    s_setprio 3
    s_nop 1
    v_cvt_pk_bf16_f32 v200, v144, v145
    v_cvt_pk_bf16_f32 v201, v146, v147
    v_cvt_pk_bf16_f32 v202, v148, v149
    v_cvt_pk_bf16_f32 v203, v150, v151
    v_cvt_pk_bf16_f32 v204, v152, v153
    v_cvt_pk_bf16_f32 v205, v154, v155
    v_cvt_pk_bf16_f32 v206, v156, v157
    v_cvt_pk_bf16_f32 v207, v158, v159
    s_cmp_lg_u32 s7, 0
    s_cbranch_scc1 Lslow_20
    buffer_store_dwordx4 v[200:203], v216, s[56:59], s86 offen
    buffer_store_dwordx4 v[204:207], v216, s[56:59], s86 offen offset:1024
Lback_21:
    v_bfe_u32 v5, v0, 2, 2
    v_lshrrev_b32 v7, 5, v0
    v_lshl_add_u32 v5, v7, 2, v5
    v_and_b32 v7, 16, v0
    v_add_u32 v5, v5, v7
    v_mul_u32_u24 v228, 3584, v5
    v_and_b32 v5, 3, v0
    v_lshl_add_u32 v228, v5, 4, v228
    v_lshrrev_b32 v5, 2, v0
    v_mul_u32_u24 v252, 896, v5
    v_and_b32 v5, 3, v0
    v_lshl_add_u32 v252, v5, 4, v252
    v_lshrrev_b32 v5, 5, v0
    v_lshlrev_b32 v7, 9, v5
    v_bfe_u32 v5, v0, 2, 2
    v_lshl_add_u32 v7, v5, 6, v7
    v_bfe_u32 v5, v0, 4, 1
    v_lshl_add_u32 v7, v5, 5, v7
    v_and_b32 v5, 1, v0
    v_lshl_add_u32 v7, v5, 4, v7
    v_bfe_u32 v5, v0, 1, 1
    v_lshl_add_u32 v7, v5, 3, v7
    v_add_u32 v229, s72, v7
    s_mul_i32 s77, s3, 9216
    s_add_u32 s77, s77, 61440
    v_add_u32 v231, s77, v7
    s_mul_i32 s78, s3, 14336
    s_add_u32 s78, s78, 100352
    v_add_u32 v253, s78, v7
    v_add_u32 v236, 100352, v216
    s_lshl_b32 s90, s3, 11
    s_add_u32 s90, s90, 28672
    v_add_u32 v237, s90, v216
    v_add_u32 v238, 160256, v216
    v_and_b32 v239, 0x1f0, v216
    v_add_u32 v239, 162304, v239
    v_add_u32 v240, 28672, v216
    v_bfe_u32 v5, v0, 4, 1
    v_xor_b32 v5, 1, v5
    v_lshl_add_u32 v5, s89, 1, v5
    v_mul_u32_u24 v5, 7168, v5
    v_lshrrev_b32 v7, 5, v0
    v_lshl_add_u32 v5, v7, 9, v5
    s_lshl_b32 s90, s88, 10
    v_and_b32 v8, 0xf0, v216
    v_add3_u32 v230, v5, v8, s90
    v_and_b32 v5, 31, v0
    v_mul_u32_u24 v5, 896, v5
    v_lshl_add_u32 v5, v7, 4, v5
    s_mul_i32 s90, s89, 28672
    s_lshl3_add_u32 s73, s4, s3
    s_lshl_b32 s73, s73, 6
    s_add_u32 s73, s73, 602112
    s_waitcnt vmcnt(0)
    s_cmp_lg_u32 s7, 0
    s_cbranch_scc1 Lslow_22
    s_mov_b64 exec, 1
    buffer_store_dword v217, off, s[56:59], s87 offset:0
    s_mov_b64 exec, -1
Lback_23:
    s_mov_b32 s95, 0x400000
Lsp_24:
    ds_read_b32 v4, v215 offset:48
    s_waitcnt lgkmcnt(0)
    v_cmp_ne_u32 vcc, s6, v4
    s_cbranch_vccz Lspd_25
    s_sub_u32 s95, s95, 1
    s_cbranch_scc0 Lsp_24
Lspd_25:
    ds_read_b64_tr_b16 v[16:17], v219 offset:0
    ds_read_b64_tr_b16 v[18:19], v219 offset:2048
    ds_read_b64_tr_b16 v[20:21], v2 offset:0
    ds_read_b64_tr_b16 v[22:23], v2 offset:2048
    ds_read_b64_tr_b16 v[24:25], v220 offset:0
    ds_read_b64_tr_b16 v[26:27], v220 offset:2048
    ds_read_b64_tr_b16 v[28:29], v3 offset:0
    ds_read_b64_tr_b16 v[30:31], v3 offset:2048
    ds_read_b64_tr_b16 v[32:33], v219 offset:4096
    ds_read_b64_tr_b16 v[34:35], v219 offset:6144
    s_add_u32 s90, s90, s68
    s_lshl1_add_u32 s91, s4, s88
    s_lshl_b32 s91, s91, 6
    s_add_u32 s90, s90, s91
    v_add_u32 v241, s90, v5
    s_lshl2_add_u32 s90, s3, 157760
    v_mov_b32 v5, s90
    v_xor_b32 v6, 4, v5
    v_bfe_u32 v7, v0, 1, 2
    v_and_b32 v8, 1, v0
    ds_read_b64_tr_b16 v[36:37], v2 offset:4096
    ds_read_b64_tr_b16 v[38:39], v2 offset:6144
    ds_read_b64_tr_b16 v[40:41], v220 offset:4096
    ds_read_b64_tr_b16 v[42:43], v220 offset:6144
    ds_read_b64_tr_b16 v[44:45], v3 offset:4096
    ds_read_b64_tr_b16 v[46:47], v3 offset:6144
    ds_read_b64_tr_b16 v[48:49], v219 offset:8192
    ds_read_b64_tr_b16 v[50:51], v219 offset:10240
    ds_read_b64_tr_b16 v[52:53], v2 offset:8192
    ds_read_b64_tr_b16 v[54:55], v2 offset:10240
    v_lshl_add_u32 v7, v7, 2, v8
    s_mul_i32 s90, s88, 12
    s_lshl1_add_u32 s90, s89, s90
    v_add_lshl_u32 v9, v7, s90, 2
    s_lshl_b32 s76, s4, 9
    s_add_u32 s76, s76, 49152
    s_mov_b32 s94, 0xffff0000
    ds_write_b32 v5, v217 offset:128
    v_and_b32 v10, 7, v0
    v_lshlrev_b32 v10, 2, v10
    ds_read_b64_tr_b16 v[56:57], v220 offset:8192
    ds_read_b64_tr_b16 v[58:59], v220 offset:10240
    ds_read_b64_tr_b16 v[60:61], v3 offset:8192
    ds_read_b64_tr_b16 v[62:63], v3 offset:10240
    ds_read_b64_tr_b16 v[64:65], v219 offset:12288
    ds_read_b64_tr_b16 v[66:67], v219 offset:14336
    ds_read_b64_tr_b16 v[68:69], v2 offset:12288
    ds_read_b64_tr_b16 v[70:71], v2 offset:14336
    ds_read_b64_tr_b16 v[72:73], v220 offset:12288
    ds_read_b64_tr_b16 v[74:75], v220 offset:14336
    v_add_u32 v10, 157888, v10
    s_mov_b32 s95, 0x40000
Lpoll_26:
    buffer_load_dword v4, v9, s[56:59], s64 offen offset:0 sc1
    s_waitcnt vmcnt(0)
    v_cmp_ne_u32 vcc, s6, v4
    s_cbranch_vccz Lgot_27
    s_sub_u32 s95, s95, 1
    s_cbranch_scc0 Lpoll_26
Lgot_27:
    buffer_load_dwordx4 v[128:131], v216, s[56:59], s79 offen offset:0 sc1
    buffer_load_dwordx4 v[132:135], v216, s[56:59], s79 offen offset:1024 sc1
    buffer_load_dwordx4 v[136:139], v216, s[56:59], s79 offen offset:2048 sc1
    buffer_load_dwordx4 v[140:143], v216, s[56:59], s79 offen offset:3072 sc1
    s_add_u32 s79, s79, 4096
    buffer_load_dwordx4 v[144:147], v216, s[56:59], s79 offen offset:0 sc1
    ds_read_b64_tr_b16 v[76:77], v3 offset:12288
    ds_read_b64_tr_b16 v[78:79], v3 offset:14336
    ds_read_b64_tr_b16 v[80:81], v219 offset:16384
    ds_read_b64_tr_b16 v[82:83], v219 offset:18432
    ds_read_b64_tr_b16 v[84:85], v2 offset:16384
    ds_read_b64_tr_b16 v[86:87], v2 offset:18432
    ds_read_b64_tr_b16 v[88:89], v220 offset:16384
    ds_read_b64_tr_b16 v[90:91], v220 offset:18432
    ds_read_b64_tr_b16 v[92:93], v3 offset:16384
    ds_read_b64_tr_b16 v[94:95], v3 offset:18432
    ds_read_b64_tr_b16 v[96:97], v219 offset:20480
    ds_read_b64_tr_b16 v[98:99], v219 offset:22528
    ds_read_b64_tr_b16 v[100:101], v2 offset:20480
    ds_read_b64_tr_b16 v[102:103], v2 offset:22528
    ds_read_b64_tr_b16 v[104:105], v220 offset:20480
    ds_read_b64_tr_b16 v[106:107], v220 offset:22528
    s_waitcnt vmcnt(4) lgkmcnt(15)
    v_mfma_f32_16x16x32_bf16 v[200:203], v[16:19], v[128:131], 0
    buffer_load_dwordx4 v[148:151], v216, s[56:59], s79 offen offset:1024 sc1
    v_mfma_f32_16x16x32_bf16 v[204:207], v[20:23], v[128:131], 0
    v_mfma_f32_16x16x32_bf16 v[208:211], v[24:27], v[128:131], 0
    v_mfma_f32_16x16x32_bf16 v[212:215], v[28:31], v[128:131], 0
    ds_read_b64_tr_b16 v[108:109], v3 offset:20480
    ds_read_b64_tr_b16 v[110:111], v3 offset:22528
    ds_read_b64_tr_b16 v[112:113], v219 offset:24576
    ds_read_b64_tr_b16 v[114:115], v219 offset:26624
    s_waitcnt vmcnt(4)
    v_mfma_f32_16x16x32_bf16 v[200:203], v[32:35], v[132:135], v[200:203]
    buffer_load_dwordx4 v[152:155], v216, s[56:59], s79 offen offset:2048 sc1
    v_mfma_f32_16x16x32_bf16 v[204:207], v[36:39], v[132:135], v[204:207]
    v_mfma_f32_16x16x32_bf16 v[208:211], v[40:43], v[132:135], v[208:211]
    v_mfma_f32_16x16x32_bf16 v[212:215], v[44:47], v[132:135], v[212:215]
    ds_read_b64_tr_b16 v[116:117], v2 offset:24576
    ds_read_b64_tr_b16 v[118:119], v2 offset:26624
    ds_read_b64_tr_b16 v[120:121], v220 offset:24576
    ds_read_b64_tr_b16 v[122:123], v220 offset:26624
    s_waitcnt vmcnt(4)
    v_mfma_f32_16x16x32_bf16 v[200:203], v[48:51], v[136:139], v[200:203]
    buffer_load_dwordx4 v[156:159], v216, s[56:59], s83 offen offset:0 sc1
    v_mfma_f32_16x16x32_bf16 v[204:207], v[52:55], v[136:139], v[204:207]
    v_mfma_f32_16x16x32_bf16 v[208:211], v[56:59], v[136:139], v[208:211]
    v_mfma_f32_16x16x32_bf16 v[212:215], v[60:63], v[136:139], v[212:215]
    ds_read_b64_tr_b16 v[124:125], v3 offset:24576
    ds_read_b64_tr_b16 v[126:127], v3 offset:26624
    s_waitcnt vmcnt(4) lgkmcnt(15)
    v_mfma_f32_16x16x32_bf16 v[200:203], v[64:67], v[140:143], v[200:203]
    buffer_load_dwordx4 v[160:163], v216, s[56:59], s83 offen offset:1024 sc1
    v_mfma_f32_16x16x32_bf16 v[204:207], v[68:71], v[140:143], v[204:207]
    v_mfma_f32_16x16x32_bf16 v[208:211], v[72:75], v[140:143], v[208:211]
    v_mfma_f32_16x16x32_bf16 v[212:215], v[76:79], v[140:143], v[212:215]
    s_waitcnt vmcnt(4)
    v_mfma_f32_16x16x32_bf16 v[200:203], v[80:83], v[144:147], v[200:203]
    buffer_load_dwordx4 v[164:167], v216, s[56:59], s83 offen offset:2048 sc1
    v_mfma_f32_16x16x32_bf16 v[204:207], v[84:87], v[144:147], v[204:207]
    v_mfma_f32_16x16x32_bf16 v[208:211], v[88:91], v[144:147], v[208:211]
    v_mfma_f32_16x16x32_bf16 v[212:215], v[92:95], v[144:147], v[212:215]
    ds_read_b32 v7, v10
    s_waitcnt vmcnt(4) lgkmcnt(9)
    v_mfma_f32_16x16x32_bf16 v[200:203], v[96:99], v[148:151], v[200:203]
    buffer_load_dwordx4 v[168:171], v216, s[56:59], s83 offen offset:3072 sc1
    v_mfma_f32_16x16x32_bf16 v[204:207], v[100:103], v[148:151], v[204:207]
    v_mfma_f32_16x16x32_bf16 v[208:211], v[104:107], v[148:151], v[208:211]
    v_mfma_f32_16x16x32_bf16 v[212:215], v[108:111], v[148:151], v[212:215]
    s_waitcnt vmcnt(4) lgkmcnt(1)
    v_mfma_f32_16x16x32_bf16 v[200:203], v[112:115], v[152:155], v[200:203]
    s_add_u32 s83, s83, 4096
    buffer_load_dwordx4 v[172:175], v216, s[56:59], s83 offen offset:0 sc1
    v_mfma_f32_16x16x32_bf16 v[204:207], v[116:119], v[152:155], v[204:207]
    v_mfma_f32_16x16x32_bf16 v[208:211], v[120:123], v[152:155], v[208:211]
    v_mfma_f32_16x16x32_bf16 v[212:215], v[124:127], v[152:155], v[212:215]
    ds_write_b32 v5, v217 offset:160
    s_waitcnt vmcnt(4)
    v_mfma_f32_16x16x32_bf16 v[184:187], v[16:19], v[156:159], 0
    buffer_load_dwordx4 v[176:179], v216, s[56:59], s83 offen offset:1024 sc1
    v_mfma_f32_16x16x32_bf16 v[188:191], v[20:23], v[156:159], 0
    v_mfma_f32_16x16x32_bf16 v[192:195], v[24:27], v[156:159], 0
    v_mfma_f32_16x16x32_bf16 v[196:199], v[28:31], v[156:159], 0
    s_waitcnt lgkmcnt(1)
    v_cmp_ne_u32 vcc, s6, v7
    s_cbranch_vccnz Llr_28
Llrb_29:
    s_waitcnt vmcnt(4)
    v_mfma_f32_16x16x32_bf16 v[184:187], v[32:35], v[160:163], v[184:187]
    buffer_load_dwordx4 v[180:183], v216, s[56:59], s83 offen offset:2048 sc1
    v_mfma_f32_16x16x32_bf16 v[188:191], v[36:39], v[160:163], v[188:191]
    v_mfma_f32_16x16x32_bf16 v[192:195], v[40:43], v[160:163], v[192:195]
    v_mfma_f32_16x16x32_bf16 v[196:199], v[44:47], v[160:163], v[196:199]
    buffer_load_dword v4, v227, s[56:59], s64 offen offset:0 sc1
    ds_write_b128 v221, v[200:203] offset:0
    ds_write_b128 v221, v[204:207] offset:1024
    s_waitcnt vmcnt(5)
    v_mfma_f32_16x16x32_bf16 v[184:187], v[48:51], v[164:167], v[184:187]
    v_mfma_f32_16x16x32_bf16 v[188:191], v[52:55], v[164:167], v[188:191]
    v_mfma_f32_16x16x32_bf16 v[192:195], v[56:59], v[164:167], v[192:195]
    v_mfma_f32_16x16x32_bf16 v[196:199], v[60:63], v[164:167], v[196:199]
    ds_write_b128 v221, v[208:211] offset:2048
    ds_write_b128 v221, v[212:215] offset:3072
    ds_write_b32 v5, v217
    s_waitcnt vmcnt(4)
    v_mfma_f32_16x16x32_bf16 v[184:187], v[64:67], v[168:171], v[184:187]
    v_lshlrev_b32 v200, 16, v244
    v_and_b32 v201, s94, v244
    v_mfma_f32_16x16x32_bf16 v[188:191], v[68:71], v[168:171], v[188:191]
    v_lshlrev_b32 v202, 16, v245
    v_and_b32 v203, s94, v245
    v_mfma_f32_16x16x32_bf16 v[192:195], v[72:75], v[168:171], v[192:195]
    v_mfma_f32_16x16x32_bf16 v[196:199], v[76:79], v[168:171], v[196:199]
    ds_read_b128 v[16:19], v223 offset:0
    ds_read_b128 v[20:23], v223 offset:64
    ds_read_b128 v[24:27], v223 offset:128
    ds_read_b128 v[28:31], v223 offset:192
    s_waitcnt vmcnt(3)
    v_mfma_f32_16x16x32_bf16 v[184:187], v[80:83], v[172:175], v[184:187]
    v_lshlrev_b32 v204, 16, v246
    v_and_b32 v205, s94, v246
    v_mfma_f32_16x16x32_bf16 v[188:191], v[84:87], v[172:175], v[188:191]
    v_lshlrev_b32 v206, 16, v247
    v_and_b32 v207, s94, v247
    v_mfma_f32_16x16x32_bf16 v[192:195], v[88:91], v[172:175], v[192:195]
    v_mfma_f32_16x16x32_bf16 v[196:199], v[92:95], v[172:175], v[196:199]
    ds_read_b128 v[32:35], v223 offset:512
    ds_read_b128 v[36:39], v223 offset:576
    ds_read_b128 v[40:43], v223 offset:640
    ds_read_b128 v[44:47], v223 offset:704
    s_waitcnt vmcnt(2)
    v_mfma_f32_16x16x32_bf16 v[184:187], v[96:99], v[176:179], v[184:187]
    v_lshlrev_b32 v208, 16, v248
    v_and_b32 v209, s94, v248
    v_mfma_f32_16x16x32_bf16 v[188:191], v[100:103], v[176:179], v[188:191]
    v_lshlrev_b32 v210, 16, v249
    v_and_b32 v211, s94, v249
    v_mfma_f32_16x16x32_bf16 v[192:195], v[104:107], v[176:179], v[192:195]
    v_mfma_f32_16x16x32_bf16 v[196:199], v[108:111], v[176:179], v[196:199]
    ds_read_b32 v7, v6
    ds_read_b128 v[128:131], v222 offset:0
    ds_read_b128 v[132:135], v222 offset:1024
    ds_read_b128 v[136:139], v222 offset:2048
    ds_read_b128 v[140:143], v222 offset:3072
    s_waitcnt vmcnt(1)
    v_mfma_f32_16x16x32_bf16 v[184:187], v[112:115], v[180:183], v[184:187]
    v_lshlrev_b32 v212, 16, v250
    v_and_b32 v213, s94, v250
    v_mfma_f32_16x16x32_bf16 v[188:191], v[116:119], v[180:183], v[188:191]
    v_lshlrev_b32 v214, 16, v251
    v_and_b32 v215, s94, v251
    v_mfma_f32_16x16x32_bf16 v[192:195], v[120:123], v[180:183], v[192:195]
    v_mfma_f32_16x16x32_bf16 v[196:199], v[124:127], v[180:183], v[196:199]
    s_waitcnt vmcnt(0)
    v_cmp_ne_u32 vcc, s6, v4
    s_cbranch_vccnz Lre_31
Lreb_32:
    s_waitcnt lgkmcnt(0)
    v_cmp_ne_u32 vcc, s6, v7
    s_cbranch_vccnz Llr_34
Llrb_35:
    ds_read_b128 v[100:103], v223 offset:256
    ds_read_b128 v[104:107], v223 offset:320
    ds_read_b128 v[108:111], v223 offset:384
    ds_read_b128 v[112:115], v223 offset:448
    v_pk_add_f32 v[184:185], v[184:185], v[128:129]
    v_pk_add_f32 v[186:187], v[186:187], v[130:131]
    v_pk_add_f32 v[188:189], v[188:189], v[132:133]
    v_pk_add_f32 v[190:191], v[190:191], v[134:135]
    v_pk_add_f32 v[192:193], v[192:193], v[136:137]
    v_pk_add_f32 v[194:195], v[194:195], v[138:139]
    v_pk_add_f32 v[196:197], v[196:197], v[140:141]
    v_pk_add_f32 v[198:199], v[198:199], v[142:143]
    v_pk_fma_f32 v[184:185], v[184:185], v[16:17], v[200:201]
    v_pk_fma_f32 v[186:187], v[186:187], v[18:19], v[202:203]
    v_pk_fma_f32 v[188:189], v[188:189], v[20:21], v[204:205]
    v_pk_fma_f32 v[190:191], v[190:191], v[22:23], v[206:207]
    v_pk_fma_f32 v[192:193], v[192:193], v[24:25], v[208:209]
    v_pk_fma_f32 v[194:195], v[194:195], v[26:27], v[210:211]
    v_pk_fma_f32 v[196:197], v[196:197], v[28:29], v[212:213]
    v_pk_fma_f32 v[198:199], v[198:199], v[30:31], v[214:215]
    v_pk_mul_f32 v[200:201], v[184:185], v[32:33]
    v_pk_mul_f32 v[202:203], v[186:187], v[34:35]
    v_pk_mul_f32 v[204:205], v[188:189], v[36:37]
    v_pk_mul_f32 v[206:207], v[190:191], v[38:39]
    v_pk_mul_f32 v[208:209], v[192:193], v[40:41]
    v_pk_mul_f32 v[210:211], v[194:195], v[42:43]
    v_pk_mul_f32 v[212:213], v[196:197], v[44:45]
    v_pk_mul_f32 v[214:215], v[198:199], v[46:47]
    v_cvt_pk_bf16_f32 v128, v200, v201
    v_cvt_pk_bf16_f32 v129, v202, v203
    v_cvt_pk_bf16_f32 v130, v204, v205
    v_cvt_pk_bf16_f32 v131, v206, v207
    v_cvt_pk_bf16_f32 v132, v208, v209
    v_cvt_pk_bf16_f32 v133, v210, v211
    v_cvt_pk_bf16_f32 v134, v212, v213
    v_cvt_pk_bf16_f32 v135, v214, v215
    s_cmp_lg_u32 s7, 0
    s_cbranch_scc1 Lslow_37
    buffer_store_dwordx4 v[128:131], v224, s[56:59], s64 offen
    buffer_store_dwordx4 v[132:135], v224, s[56:59], s64 offen offset:2048
Lback_38:
    buffer_load_dwordx4 v[152:155], v232, s[56:59], 0 offen sc1
    buffer_load_dwordx4 v[144:147], off, s[56:59], s76 sc1
    buffer_load_dwordx4 v[148:151], off, s[56:59], s76 offset:16 sc1
    s_waitcnt lgkmcnt(0)
    v_pk_add_f32 v[116:117], v[184:185], v[186:187]
    v_pk_mul_f32 v[118:119], v[184:185], v[184:185]
    v_pk_add_f32 v[120:121], v[200:201], v[202:203]
    v_pk_mul_f32 v[122:123], v[200:201], v[200:201]
    v_pk_mul_f32 v[124:125], v[200:201], v[32:33]
    v_pk_mul_f32 v[126:127], v[200:201], v[100:101]
    v_pk_fma_f32 v[118:119], v[186:187], v[186:187], v[118:119]
    v_pk_fma_f32 v[122:123], v[202:203], v[202:203], v[122:123]
    v_pk_fma_f32 v[124:125], v[202:203], v[34:35], v[124:125]
    v_pk_fma_f32 v[126:127], v[202:203], v[102:103], v[126:127]
    v_pk_add_f32 v[116:117], v[116:117], v[188:189]
    v_pk_add_f32 v[120:121], v[120:121], v[204:205]
    v_pk_fma_f32 v[118:119], v[188:189], v[188:189], v[118:119]
    v_pk_fma_f32 v[122:123], v[204:205], v[204:205], v[122:123]
    v_pk_fma_f32 v[124:125], v[204:205], v[36:37], v[124:125]
    v_pk_fma_f32 v[126:127], v[204:205], v[104:105], v[126:127]
    v_pk_add_f32 v[116:117], v[116:117], v[190:191]
    v_pk_add_f32 v[120:121], v[120:121], v[206:207]
    v_pk_fma_f32 v[118:119], v[190:191], v[190:191], v[118:119]
    v_pk_fma_f32 v[122:123], v[206:207], v[206:207], v[122:123]
    v_pk_fma_f32 v[124:125], v[206:207], v[38:39], v[124:125]
    v_pk_fma_f32 v[126:127], v[206:207], v[106:107], v[126:127]
    v_pk_add_f32 v[116:117], v[116:117], v[192:193]
    v_pk_add_f32 v[120:121], v[120:121], v[208:209]
    v_pk_fma_f32 v[118:119], v[192:193], v[192:193], v[118:119]
    v_pk_fma_f32 v[122:123], v[208:209], v[208:209], v[122:123]
    v_pk_fma_f32 v[124:125], v[208:209], v[40:41], v[124:125]
    v_pk_fma_f32 v[126:127], v[208:209], v[108:109], v[126:127]
    v_pk_add_f32 v[116:117], v[116:117], v[194:195]
    v_pk_add_f32 v[120:121], v[120:121], v[210:211]
    v_pk_fma_f32 v[118:119], v[194:195], v[194:195], v[118:119]
    v_pk_fma_f32 v[122:123], v[210:211], v[210:211], v[122:123]
    v_pk_fma_f32 v[124:125], v[210:211], v[42:43], v[124:125]
    v_pk_fma_f32 v[126:127], v[210:211], v[110:111], v[126:127]
    v_pk_add_f32 v[116:117], v[116:117], v[196:197]
    v_pk_add_f32 v[120:121], v[120:121], v[212:213]
    v_pk_fma_f32 v[118:119], v[196:197], v[196:197], v[118:119]
    v_pk_fma_f32 v[122:123], v[212:213], v[212:213], v[122:123]
    v_pk_fma_f32 v[124:125], v[212:213], v[44:45], v[124:125]
    v_pk_fma_f32 v[126:127], v[212:213], v[112:113], v[126:127]
    v_pk_add_f32 v[116:117], v[116:117], v[198:199]
    v_pk_add_f32 v[120:121], v[120:121], v[214:215]
    v_pk_fma_f32 v[118:119], v[198:199], v[198:199], v[118:119]
    v_pk_fma_f32 v[122:123], v[214:215], v[214:215], v[122:123]
    v_pk_fma_f32 v[124:125], v[214:215], v[46:47], v[124:125]
    v_pk_fma_f32 v[126:127], v[214:215], v[114:115], v[126:127]
    v_add_f32 v136, v116, v117
    v_add_f32 v137, v118, v119
    v_add_f32 v138, v120, v121
    v_add_f32 v140, v122, v123
    v_add_f32 v141, v124, v125
    v_add_f32 v142, v126, v127
    s_lshl_b32 s90, s4, 11
    v_permlane16_swap_b32 v136, v140
    v_permlane16_swap_b32 v137, v141
    v_permlane16_swap_b32 v138, v142
    v_add_f32 v136, v136, v140
    v_add_f32 v137, v137, v141
    v_add_f32 v138, v138, v142
    v_mov_b32 v140, v136
    v_mov_b32 v141, v137
    v_mov_b32 v142, v138
    v_mov_b32 v139, v217
    s_add_u32 s84, s90, s64
    v_permlane32_swap_b32 v136, v140
    v_permlane32_swap_b32 v137, v141
    v_permlane32_swap_b32 v138, v142
    v_add_f32 v136, v136, v140
    v_add_f32 v137, v137, v141
    v_add_f32 v138, v138, v142
    s_cmp_lg_u32 s7, 0
    s_cbranch_scc1 Lslow_39
    s_mov_b32 exec_hi, 0
    buffer_store_dwordx4 v[136:139], v225, s[56:59], s84 offen
    s_mov_b32 exec_hi, -1
Lback_40:
    s_waitcnt vmcnt(4)
    s_cmp_lg_u32 s7, 0
    s_cbranch_scc1 Lslow_41
    s_mov_b64 exec, 1
    buffer_store_dword v217, off, s[56:59], s87 offset:128
    s_mov_b64 exec, -1
Lback_42:
    s_setprio 1
    v_cvt_pk_bf16_f32 v200, v184, v185
    v_cvt_pk_bf16_f32 v201, v186, v187
    v_cvt_pk_bf16_f32 v202, v188, v189
    v_cvt_pk_bf16_f32 v203, v190, v191
    v_cvt_pk_bf16_f32 v204, v192, v193
    v_cvt_pk_bf16_f32 v205, v194, v195
    v_cvt_pk_bf16_f32 v206, v196, v197
    v_cvt_pk_bf16_f32 v207, v198, v199
    ds_write_b128 v222, v[200:203] offset:0
    ds_write_b128 v222, v[204:207] offset:1024
    s_waitcnt vmcnt(2)
    v_xor_b32 v4, s6, v155
    v_bitop3_b32 v4, v4, v147, s6 bitop3:0xf6
    v_bitop3_b32 v4, v4, v151, s6 bitop3:0xf6
    v_cmp_ne_u32 vcc, 0, v4
    s_cbranch_vccnz Lre_43
Lreb_44:
    v_mov_b32 v155, v233
    s_add_u32 s74, s64, 4096
    s_add_u32 s75, s64, 8192
    v_and_b32 v7, 0xf0, v216
    v_and_b32 v12, 1, v254
    v_lshl_add_u32 v9, v12, 10, v7
    s_lshl_b32 s90, s3, 8
    s_add_u32 s91, s90, 129024
    v_add_u32 v226, s91, v9
    s_add_u32 s90, s90, 162304
    v_add_u32 v235, s90, v7
    v_lshl_add_u32 v9, v12, 9, v7
    s_lshl2_add_u32 s90, s89, s88
    s_lshl_b32 s90, s90, 8
    s_add_u32 s90, s90, 160256
    v_add_u32 v234, s90, v9
    v_lshrrev_b32 v7, 3, v0
    v_mul_u32_u24 v220, 896, v7
    v_bfe_u32 v7, v0, 4, 1
    v_lshlrev_b32 v7, 2, v7
    v_and_b32 v8, 7, v0
    v_xor_b32 v7, v7, v8
    v_lshl_add_u32 v220, v7, 4, v220
    s_lshl2_add_u32 s90, s4, s3
    s_mul_i32 s79, s90, 57344
    s_lshl_b32 s90, s4, 7
    s_add_u32 s79, s79, s90
    s_add_u32 s84, s90, s64
    s_lshl2_add_u32 s90, s4, s88
    s_lshl1_add_u32 s90, s90, s89
    s_lshl_b32 s90, s90, 11
    s_add_u32 s90, s90, s64
    s_mul_i32 s87, s7, 358400
    s_add_u32 s87, s87, s90
    s_add_u32 s87, s87, 2048
    s_add_u32 s86, s87, 8192
    v_min_u32 v7, 6, v0
    v_lshlrev_b32 v14, 2, v7
    v_add_u32 v13, s77, v216
    v_and_b32 v7, 1, v0
    v_lshl_add_u32 v7, v7, 1, s88
    v_lshlrev_b32 v15, 2, v7
    v_lshrrev_b32 v7, 5, v0
    v_lshlrev_b32 v9, 10, v7
    v_bfe_u32 v8, v0, 2, 2
    v_lshl_add_u32 v9, v8, 7, v9
    v_bfe_u32 v8, v0, 3, 1
    v_xor_b32 v8, s88, v8
    v_lshl_add_u32 v9, v8, 6, v9
    v_bfe_u32 v8, v0, 4, 1
    v_lshl_add_u32 v9, v8, 5, v9
    v_and_b32 v8, 1, v0
    v_lshl_add_u32 v9, v8, 4, v9
    v_bfe_u32 v8, v0, 1, 1
    v_lshl_add_u32 v9, v8, 3, v9
    v_add_u32 v219, 102400, v9
    s_lshl_b32 s90, s88, 7
    s_add_u32 s90, s90, 158720
    v_lshl_add_u32 v223, v7, 5, s90
    v_and_b32 v6, 3, v0
    v_lshlrev_b32 v6, 2, v6
    v_add_u32 v6, 157776, v6
    buffer_load_dwordx4 v[160:163], v225, s[56:59], s64 offen sc1
    buffer_load_dwordx4 v[164:167], v225, s[56:59], s74 offen sc1
    buffer_load_dwordx4 v[168:171], v225, s[56:59], s75 offen sc1
    buffer_load_dwordx4 v[172:175], v226, s[56:59], s64 offen sc1
    s_waitcnt vmcnt(0)
    v_xor_b32 v4, s6, v163
    v_bitop3_b32 v4, v4, v167, s6 bitop3:0xf6
    v_bitop3_b32 v4, v4, v171, s6 bitop3:0xf6
    v_bitop3_b32 v4, v4, v175, s6 bitop3:0xf6
    v_cmp_ne_u32 vcc, 0, v4
    s_cbranch_vccnz Lre_46
Lreb_47:
    v_add_f32 v160, v160, v164
    v_add_f32 v161, v161, v165
    v_add_f32 v162, v162, v166
    v_add_f32 v160, v160, v168
    v_add_f32 v161, v161, v169
    v_add_f32 v162, v162, v170
    v_mov_b32 v164, v160
    v_mov_b32 v165, v161
    v_mov_b32 v166, v162
    s_nop 0
    v_permlane32_swap_b32 v160, v164
    v_permlane32_swap_b32 v161, v165
    v_permlane32_swap_b32 v162, v166
    v_add_f32 v160, v160, v164
    v_add_f32 v161, v161, v165
    v_add_f32 v162, v162, v166
    v_add_f32 v160, v160, v172
    v_add_f32 v161, v161, v173
    v_add_f32 v162, v162, v174
    v_mov_b32 v164, v160
    v_mov_b32 v165, v161
    v_mov_b32 v166, v162
    v_cmp_eq_u32 vcc, 1, v12
    v_permlane16_swap_b32 v160, v164
    v_permlane16_swap_b32 v161, v165
    v_permlane16_swap_b32 v162, v166
    v_mul_f32 v168, 0x3b124925, v160
    v_mul_f32 v171, 0x3b124925, v161
    v_fma_f32 v171, -v168, v168, v171
    v_max_f32 v171, 0, v171
    v_add_f32 v171, 0x3727c5ac, v171
    v_rsq_f32 v169, v171
    v_fma_f32 v170, -v168, v146, v162
    v_mul_f32 v177, v171, v169
    v_fma_f32 v172, v169, v170, v150
    v_mul_f32 v172, 0x3b124925, v172
    v_fma_f32 v171, v168, v144, -v165
    v_sub_f32 v171, v171, v165
    v_fma_f32 v171, v171, v168, v164
    v_fma_f32 v170, -v168, v145, v166
    v_add_f32 v170, v170, v170
    v_fma_f32 v171, v171, v169, v170
    v_fma_f32 v171, v171, v169, v149
    v_mul_f32 v171, 0x3b124925, v171
    v_fma_f32 v171, -v172, v172, v171
    v_max_f32 v171, 0, v171
    v_add_f32 v171, 0x3727c5ac, v171
    v_rsq_f32 v173, v171
    v_sub_f32 v176, 0, v168
    v_mul_f32 v178, -v172, v177
    v_mul_f32 v171, v171, v173
    v_mul_f32 v179, v171, v177
    v_mul_f32 v173, v173, v169
    v_mov_b32 v162, v179
    v_mul_f32 v160, 0xc0135761, v173
    v_mul_f32 v161, v173, v173
    v_mul_f32 v173, 0xbdd2d3e8, v173
    v_mul_f32 v161, v161, v173
    v_cvt_pk_bf16_f32 v180, v176, v176
    v_cvt_pk_bf16_f32 v181, v177, v177
    v_cvt_pk_bf16_f32 v182, v178, v178
    v_cvt_pk_bf16_f32 v183, v179, v179
    v_and_b32 v168, 0xffff0000, v180
    v_and_b32 v169, 0xffff0000, v181
    v_and_b32 v170, 0xffff0000, v182
    v_and_b32 v171, 0xffff0000, v183
    v_sub_f32 v168, v176, v168
    v_sub_f32 v169, v177, v169
    v_sub_f32 v170, v178, v170
    v_sub_f32 v171, v179, v171
    v_cvt_pk_bf16_f32 v168, v168, v168
    v_cvt_pk_bf16_f32 v169, v169, v169
    v_cvt_pk_bf16_f32 v170, v170, v170
    v_cvt_pk_bf16_f32 v171, v171, v171
    v_cndmask_b32 v180, v180, v168, vcc
    v_cndmask_b32 v181, v181, v169, vcc
    v_cndmask_b32 v182, v182, v170, vcc
    v_cndmask_b32 v183, v183, v171, vcc
    ds_write_b128 v234, v[180:183]
    ds_write_b128 v235, v[160:163]
    s_setprio 1
    s_waitcnt lgkmcnt(2)
    s_barrier
    ds_read_b64_tr_b16 v[16:17], v231 offset:0
    ds_read_b64_tr_b16 v[18:19], v231 offset:256
    s_add_u32 m0, s72, 2048
    s_add_u32 s73, s73, 86016
    buffer_load_dwordx4 v228, s[48:51], s73 offen  lds
    ds_read_b64_tr_b16 v[20:21], v231 offset:1024
    ds_read_b64_tr_b16 v[22:23], v231 offset:1280
    s_add_u32 m0, s72, 3072
    s_add_u32 s73, s73, 28672
    buffer_load_dwordx4 v228, s[48:51], s73 offen  lds
    ds_read_b64_tr_b16 v[24:25], v231 offset:2048
    ds_read_b64_tr_b16 v[26:27], v231 offset:2304
    s_waitcnt lgkmcnt(4)
    s_add_u32 m0, s77, 0
    s_add_u32 s73, s73, 86016
    buffer_load_dwordx4 v228, s[48:51], s73 offen  lds
    ds_read_b64_tr_b16 v[28:29], v231 offset:3072
    ds_read_b64_tr_b16 v[30:31], v231 offset:3328
    s_waitcnt lgkmcnt(4)
    s_add_u32 m0, s77, 1024
    s_add_u32 s73, s73, 28672
    buffer_load_dwordx4 v228, s[48:51], s73 offen  lds
    ds_read_b64_tr_b16 v[32:33], v231 offset:4096
    ds_read_b64_tr_b16 v[34:35], v231 offset:4352
    s_waitcnt lgkmcnt(4)
    s_add_u32 m0, s77, 2048
    s_add_u32 s73, s73, 86016
    buffer_load_dwordx4 v228, s[48:51], s73 offen  lds
    ds_read_b64_tr_b16 v[36:37], v231 offset:5120
    ds_read_b64_tr_b16 v[38:39], v231 offset:5376
    s_waitcnt lgkmcnt(4)
    s_add_u32 m0, s77, 3072
    s_add_u32 s73, s73, 28672
    buffer_load_dwordx4 v228, s[48:51], s73 offen  lds
    ds_read_b64_tr_b16 v[40:41], v231 offset:6144
    ds_read_b64_tr_b16 v[42:43], v231 offset:6400
    s_waitcnt lgkmcnt(4)
    s_add_u32 m0, s77, 4096
    s_add_u32 s73, s73, 86016
    buffer_load_dwordx4 v228, s[48:51], s73 offen  lds
    ds_read_b64_tr_b16 v[44:45], v231 offset:7168
    ds_read_b64_tr_b16 v[46:47], v231 offset:7424
    s_waitcnt lgkmcnt(4)
    s_add_u32 m0, s77, 5120
    s_add_u32 s73, s73, 28672
    buffer_load_dwordx4 v228, s[48:51], s73 offen  lds
    ds_read_b64_tr_b16 v[48:49], v231 offset:8192
    ds_read_b64_tr_b16 v[50:51], v231 offset:8448
    s_waitcnt lgkmcnt(4)
    s_add_u32 m0, s77, 6144
    s_add_u32 s73, s73, 86016
    buffer_load_dwordx4 v228, s[48:51], s73 offen  lds
    ds_read_b64_tr_b16 v[52:53], v229 offset:4096
    ds_read_b64_tr_b16 v[54:55], v229 offset:4352
    ds_read_b64_tr_b16 v[56:57], v229 offset:5120
    ds_read_b64_tr_b16 v[58:59], v229 offset:5376
    ds_read_b64_tr_b16 v[60:61], v229 offset:6144
    ds_read_b64_tr_b16 v[62:63], v229 offset:6400
    ds_read2_b64 v[184:187], v230 offset0:0 offset1:32
    ds_read2_b64 v[188:191], v230 offset0:1 offset1:33
    ds_read_b128 v[128:131], v236 offset:0
    ds_read_b128 v[132:135], v236 offset:1024
    ds_read_b128 v[136:139], v236 offset:2048
    ds_read_b128 v[140:143], v236 offset:3072
    s_waitcnt lgkmcnt(4)
    s_setprio 1
    s_barrier
    ds_read_b128 v[180:183], v238
    ds_read_b128 v[208:211], v239
    ds_read_b128 v[144:147], v236 offset:4096
    s_waitcnt lgkmcnt(6)
    v_mfma_f32_32x32x16_bf16 v[192:207], v[16:19], v[128:131], 0
    s_add_u32 m0, s77, 7168
    s_add_u32 s73, s73, 28672
    buffer_load_dwordx4 v228, s[48:51], s73 offen  lds
    ds_read_b128 v[128:131], v236 offset:5120
    s_waitcnt lgkmcnt(6)
    v_mfma_f32_32x32x16_bf16 v[192:207], v[20:23], v[132:135], v[192:207]
    ds_read_b128 v[132:135], v236 offset:6144
    s_waitcnt lgkmcnt(6)
    v_mfma_f32_32x32x16_bf16 v[192:207], v[24:27], v[136:139], v[192:207]
    s_add_u32 m0, s77, 8192
    s_add_u32 s73, s73, 86016
    buffer_load_dwordx4 v228, s[48:51], s73 offen  lds
    ds_read_b128 v[136:139], v236 offset:14336
    s_waitcnt lgkmcnt(6)
    v_mfma_f32_32x32x16_bf16 v[192:207], v[28:31], v[140:143], v[192:207]
    ds_read_b128 v[140:143], v236 offset:15360
    s_waitcnt lgkmcnt(4)
    v_mfma_f32_32x32x16_bf16 v[192:207], v[32:35], v[144:147], v[192:207]
    s_add_u32 m0, s72, 4096
    s_add_u32 s73, s73, 28672
    buffer_load_dwordx4 v228, s[48:51], s73 offen  lds
    ds_read_b128 v[144:147], v236 offset:16384
    s_waitcnt lgkmcnt(4)
    v_mfma_f32_32x32x16_bf16 v[192:207], v[36:39], v[128:131], v[192:207]
    ds_read_b128 v[128:131], v236 offset:17408
    s_waitcnt lgkmcnt(4)
    v_mfma_f32_32x32x16_bf16 v[192:207], v[40:43], v[132:135], v[192:207]
    s_add_u32 m0, s72, 5120
    s_add_u32 s73, s73, 86016
    buffer_load_dwordx4 v228, s[48:51], s73 offen  lds
    ds_read_b128 v[132:135], v236 offset:18432
    s_waitcnt lgkmcnt(4)
    v_mfma_f32_32x32x16_bf16 v[192:207], v[44:47], v[136:139], v[192:207]
    ds_read_b128 v[136:139], v236 offset:19456
    s_waitcnt lgkmcnt(4)
    v_mfma_f32_32x32x16_bf16 v[192:207], v[48:51], v[140:143], v[192:207]
    s_add_u32 m0, s72, 6144
    s_add_u32 s73, s73, 28672
    buffer_load_dwordx4 v228, s[48:51], s73 offen  lds
    s_waitcnt vmcnt(13)
    ds_read_b64_tr_b16 v[64:65], v229 offset:2048
    ds_read_b64_tr_b16 v[66:67], v229 offset:2304
    ds_read_b128 v[140:143], v236 offset:20480
    s_waitcnt lgkmcnt(6)
    v_mfma_f32_32x32x16_bf16 v[192:207], v[52:55], v[144:147], v[192:207]
    s_waitcnt vmcnt(12)
    ds_read_b64_tr_b16 v[68:69], v229 offset:3072
    ds_read_b64_tr_b16 v[70:71], v229 offset:3328
    ds_read_b128 v[144:147], v236 offset:28672
    s_waitcnt lgkmcnt(8)
    v_mfma_f32_32x32x16_bf16 v[192:207], v[56:59], v[128:131], v[192:207]
    s_waitcnt lgkmcnt(4)
    s_add_u32 m0, s72, 2048
    s_add_u32 s73, s73, 86016
    buffer_load_dwordx4 v228, s[48:51], s73 offen  lds
    s_waitcnt vmcnt(12)
    ds_read_b64_tr_b16 v[72:73], v231 offset:0
    ds_read_b64_tr_b16 v[74:75], v231 offset:256
    ds_read_b128 v[128:131], v236 offset:29696
    v_mfma_f32_32x32x16_bf16 v[192:207], v[60:63], v[132:135], v[192:207]
    s_waitcnt vmcnt(11)
    ds_read_b64_tr_b16 v[76:77], v231 offset:1024
    ds_read_b64_tr_b16 v[78:79], v231 offset:1280
    ds_read_b128 v[132:135], v236 offset:30720
    v_mfma_f32_32x32x16_bf16 v[192:207], v[64:67], v[136:139], v[192:207]
    s_waitcnt lgkmcnt(7)
    s_add_u32 m0, s72, 3072
    s_add_u32 s73, s73, 28672
    buffer_load_dwordx4 v228, s[48:51], s73 offen  lds
    s_waitcnt vmcnt(11)
    ds_read_b64_tr_b16 v[80:81], v231 offset:2048
    ds_read_b64_tr_b16 v[82:83], v231 offset:2304
    ds_read_b128 v[136:139], v236 offset:31744
    v_mfma_f32_32x32x16_bf16 v[192:207], v[68:71], v[140:143], v[192:207]
    s_waitcnt vmcnt(10)
    ds_read_b64_tr_b16 v[84:85], v231 offset:3072
    ds_read_b64_tr_b16 v[86:87], v231 offset:3328
    ds_read_b128 v[140:143], v236 offset:32768
    s_waitcnt lgkmcnt(12)
    s_waitcnt lgkmcnt(10)
    v_mfma_f32_32x32x16_bf16 v[192:207], v[72:75], v[144:147], v[192:207]
    s_waitcnt vmcnt(9)
    ds_read_b64_tr_b16 v[88:89], v231 offset:4096
    ds_read_b64_tr_b16 v[90:91], v231 offset:4352
    ds_read_b128 v[144:147], v236 offset:33792
    s_waitcnt lgkmcnt(12)
    s_waitcnt lgkmcnt(10)
    v_mfma_f32_32x32x16_bf16 v[192:207], v[76:79], v[128:131], v[192:207]
    s_waitcnt vmcnt(8)
    ds_read_b64_tr_b16 v[92:93], v231 offset:5120
    ds_read_b64_tr_b16 v[94:95], v231 offset:5376
    ds_read_b128 v[128:131], v236 offset:34816
    s_waitcnt lgkmcnt(12)
    s_waitcnt lgkmcnt(10)
    v_mfma_f32_32x32x16_bf16 v[192:207], v[80:83], v[132:135], v[192:207]
    s_waitcnt vmcnt(7)
    ds_read_b64_tr_b16 v[96:97], v231 offset:6144
    ds_read_b64_tr_b16 v[98:99], v231 offset:6400
    ds_read_b128 v[132:135], v236 offset:43008
    s_waitcnt lgkmcnt(12)
    s_waitcnt lgkmcnt(10)
    v_mfma_f32_32x32x16_bf16 v[192:207], v[84:87], v[136:139], v[192:207]
    s_waitcnt vmcnt(6)
    ds_read_b64_tr_b16 v[100:101], v231 offset:7168
    ds_read_b64_tr_b16 v[102:103], v231 offset:7424
    ds_read_b128 v[136:139], v236 offset:44032
    s_waitcnt lgkmcnt(12)
    s_waitcnt lgkmcnt(10)
    v_mfma_f32_32x32x16_bf16 v[192:207], v[88:91], v[140:143], v[192:207]
    s_waitcnt vmcnt(5)
    ds_read_b64_tr_b16 v[104:105], v231 offset:8192
    ds_read_b64_tr_b16 v[106:107], v231 offset:8448
    ds_read_b128 v[140:143], v236 offset:45056
    s_waitcnt lgkmcnt(12)
    s_waitcnt lgkmcnt(10)
    v_mfma_f32_32x32x16_bf16 v[192:207], v[92:95], v[144:147], v[192:207]
    s_waitcnt vmcnt(4)
    ds_read_b64_tr_b16 v[108:109], v229 offset:4096
    ds_read_b64_tr_b16 v[110:111], v229 offset:4352
    ds_read_b128 v[144:147], v236 offset:46080
    s_waitcnt lgkmcnt(12)
    s_waitcnt lgkmcnt(10)
    v_mfma_f32_32x32x16_bf16 v[192:207], v[96:99], v[128:131], v[192:207]
    s_waitcnt vmcnt(3)
    ds_read_b64_tr_b16 v[112:113], v229 offset:5120
    ds_read_b64_tr_b16 v[114:115], v229 offset:5376
    ds_read_b128 v[128:131], v236 offset:47104
    s_waitcnt lgkmcnt(12)
    s_waitcnt lgkmcnt(10)
    v_mfma_f32_32x32x16_bf16 v[192:207], v[100:103], v[132:135], v[192:207]
    s_waitcnt vmcnt(2)
    ds_read_b64_tr_b16 v[116:117], v229 offset:6144
    ds_read_b64_tr_b16 v[118:119], v229 offset:6400
    ds_read_b128 v[132:135], v236 offset:48128
    s_waitcnt lgkmcnt(12)
    s_waitcnt lgkmcnt(10)
    v_mfma_f32_32x32x16_bf16 v[192:207], v[104:107], v[136:139], v[192:207]
    s_waitcnt vmcnt(1)
    ds_read_b64_tr_b16 v[120:121], v229 offset:2048
    ds_read_b64_tr_b16 v[122:123], v229 offset:2304
    ds_read_b128 v[136:139], v236 offset:49152
    s_waitcnt lgkmcnt(12)
    s_waitcnt lgkmcnt(10)
    v_mfma_f32_32x32x16_bf16 v[192:207], v[108:111], v[140:143], v[192:207]
    s_waitcnt vmcnt(0)
    ds_read_b64_tr_b16 v[124:125], v229 offset:3072
    ds_read_b64_tr_b16 v[126:127], v229 offset:3328
    s_waitcnt lgkmcnt(11)
    s_waitcnt lgkmcnt(9)
    v_mfma_f32_32x32x16_bf16 v[192:207], v[112:115], v[144:147], v[192:207]
    s_waitcnt lgkmcnt(8)
    s_waitcnt lgkmcnt(6)
    v_mfma_f32_32x32x16_bf16 v[192:207], v[116:119], v[128:131], v[192:207]
    s_waitcnt lgkmcnt(5)
    s_waitcnt lgkmcnt(3)
    v_mfma_f32_32x32x16_bf16 v[192:207], v[120:123], v[132:135], v[192:207]
    s_waitcnt lgkmcnt(2)
    s_waitcnt lgkmcnt(0)
    v_mfma_f32_32x32x16_bf16 v[192:207], v[124:127], v[136:139], v[192:207]
    v_mfma_f32_32x32x16_bf16 v[192:207], v[152:155], v[180:183], v[192:207]
    ds_read_b128 v[180:183], v238 offset:1024
    ds_read_b128 v[212:215], v239 offset:512
    s_setprio 1
    s_nop 8
    v_mul_f32 v160, v192, v192
    v_mul_f32 v161, v193, v193
    v_mul_f32 v162, v194, v194
    v_mul_f32 v163, v195, v195
    v_mul_f32 v164, v196, v196
    v_mul_f32 v165, v197, v197
    v_mul_f32 v166, v198, v198
    v_mul_f32 v167, v199, v199
    s_barrier
    v_mul_f32 v168, v200, v200
    v_mul_f32 v169, v201, v201
    v_mul_f32 v170, v202, v202
    v_mul_f32 v171, v203, v203
    v_mul_f32 v172, v204, v204
    v_mul_f32 v173, v205, v205
    v_mul_f32 v174, v206, v206
    v_mul_f32 v175, v207, v207
    v_fma_f32 v160, v160, v209, v208
    v_fma_f32 v161, v161, v209, v208
    v_fma_f32 v162, v162, v209, v208
    v_fma_f32 v163, v163, v209, v208
    v_fma_f32 v164, v164, v209, v208
    v_fma_f32 v165, v165, v209, v208
    v_fma_f32 v166, v166, v209, v208
    v_fma_f32 v167, v167, v209, v208
    v_fma_f32 v168, v168, v209, v208
    v_fma_f32 v169, v169, v209, v208
    v_fma_f32 v170, v170, v209, v208
    v_fma_f32 v171, v171, v209, v208
    v_fma_f32 v172, v172, v209, v208
    v_fma_f32 v173, v173, v209, v208
    v_fma_f32 v174, v174, v209, v208
    v_fma_f32 v175, v175, v209, v208
    v_mul_f32 v160, v160, v192
    v_mul_f32 v161, v161, v193
    v_mul_f32 v162, v162, v194
    v_mul_f32 v163, v163, v195
    v_mul_f32 v164, v164, v196
    v_mul_f32 v165, v165, v197
    v_mul_f32 v166, v166, v198
    v_mul_f32 v167, v167, v199
    v_mul_f32 v168, v168, v200
    v_mul_f32 v169, v169, v201
    v_mul_f32 v170, v170, v202
    v_mul_f32 v171, v171, v203
    v_mul_f32 v172, v172, v204
    v_mul_f32 v173, v173, v205
    v_mul_f32 v174, v174, v206
    v_mul_f32 v175, v175, v207
    v_exp_f32 v160, v160
    v_exp_f32 v161, v161
    v_exp_f32 v162, v162
    v_exp_f32 v163, v163
    v_exp_f32 v164, v164
    v_exp_f32 v165, v165
    v_exp_f32 v166, v166
    v_exp_f32 v167, v167
    v_exp_f32 v168, v168
    v_exp_f32 v169, v169
    v_exp_f32 v170, v170
    v_exp_f32 v171, v171
    v_exp_f32 v172, v172
    v_exp_f32 v173, v173
    v_exp_f32 v174, v174
    v_exp_f32 v175, v175
    v_fma_f32 v160, v160, v210, v210
    v_fma_f32 v161, v161, v210, v210
    v_fma_f32 v162, v162, v210, v210
    v_fma_f32 v163, v163, v210, v210
    v_fma_f32 v164, v164, v210, v210
    v_fma_f32 v165, v165, v210, v210
    v_fma_f32 v166, v166, v210, v210
    v_fma_f32 v167, v167, v210, v210
    v_fma_f32 v168, v168, v210, v210
    v_fma_f32 v169, v169, v210, v210
    v_fma_f32 v170, v170, v210, v210
    v_fma_f32 v171, v171, v210, v210
    v_fma_f32 v172, v172, v210, v210
    v_fma_f32 v173, v173, v210, v210
    v_fma_f32 v174, v174, v210, v210
    v_fma_f32 v175, v175, v210, v210
    v_rcp_f32 v160, v160
    v_rcp_f32 v161, v161
    v_rcp_f32 v162, v162
    v_rcp_f32 v163, v163
    v_rcp_f32 v164, v164
    v_rcp_f32 v165, v165
    v_rcp_f32 v166, v166
    v_rcp_f32 v167, v167
    v_rcp_f32 v168, v168
    v_rcp_f32 v169, v169
    v_rcp_f32 v170, v170
    v_rcp_f32 v171, v171
    v_rcp_f32 v172, v172
    v_rcp_f32 v173, v173
    v_rcp_f32 v174, v174
    v_rcp_f32 v175, v175
    v_mul_f32 v160, v160, v192
    v_mul_f32 v161, v161, v193
    v_mul_f32 v162, v162, v194
    v_mul_f32 v163, v163, v195
    ds_read_b128 v[128:131], v236 offset:7168
    ds_read_b128 v[132:135], v236 offset:8192
    ds_read_b128 v[136:139], v236 offset:9216
    ds_read_b128 v[140:143], v236 offset:10240
    v_mul_f32 v164, v164, v196
    v_mul_f32 v165, v165, v197
    v_mul_f32 v166, v166, v198
    v_mul_f32 v167, v167, v199
    v_mul_f32 v168, v168, v200
    v_mul_f32 v169, v169, v201
    v_mul_f32 v170, v170, v202
    v_mul_f32 v171, v171, v203
    v_mul_f32 v172, v172, v204
    v_mul_f32 v173, v173, v205
    v_mul_f32 v174, v174, v206
    v_mul_f32 v175, v175, v207
    v_cvt_pk_bf16_f32 v192, v160, v161
    v_cvt_pk_bf16_f32 v193, v162, v163
    v_cvt_pk_bf16_f32 v194, v164, v165
    v_cvt_pk_bf16_f32 v195, v166, v167
    ds_write_b128 v237, v[192:195] offset:0
    v_cvt_pk_bf16_f32 v196, v168, v169
    v_cvt_pk_bf16_f32 v197, v170, v171
    v_cvt_pk_bf16_f32 v198, v172, v173
    v_cvt_pk_bf16_f32 v199, v174, v175
    ds_write_b128 v237, v[196:199] offset:1024
    s_setprio 1
    ds_read_b128 v[144:147], v236 offset:11264
    s_waitcnt lgkmcnt(6)
    v_mfma_f32_32x32x16_bf16 v[192:207], v[16:19], v[128:131], 0
    ds_read_b128 v[128:131], v236 offset:12288
    s_waitcnt lgkmcnt(6)
    v_mfma_f32_32x32x16_bf16 v[192:207], v[20:23], v[132:135], v[192:207]
    ds_read_b128 v[132:135], v236 offset:13312
    s_waitcnt lgkmcnt(6)
    v_mfma_f32_32x32x16_bf16 v[192:207], v[24:27], v[136:139], v[192:207]
    ds_read_b128 v[136:139], v236 offset:21504
    s_waitcnt lgkmcnt(6)
    v_mfma_f32_32x32x16_bf16 v[192:207], v[28:31], v[140:143], v[192:207]
    ds_read_b128 v[140:143], v236 offset:22528
    s_waitcnt lgkmcnt(4)
    v_mfma_f32_32x32x16_bf16 v[192:207], v[32:35], v[144:147], v[192:207]
    ds_read_b128 v[144:147], v236 offset:23552
    s_waitcnt lgkmcnt(4)
    v_mfma_f32_32x32x16_bf16 v[192:207], v[36:39], v[128:131], v[192:207]
    ds_read_b128 v[128:131], v236 offset:24576
    s_waitcnt lgkmcnt(4)
    v_mfma_f32_32x32x16_bf16 v[192:207], v[40:43], v[132:135], v[192:207]
    ds_read_b128 v[132:135], v236 offset:25600
    s_waitcnt lgkmcnt(4)
    v_mfma_f32_32x32x16_bf16 v[192:207], v[44:47], v[136:139], v[192:207]
    ds_read_b128 v[136:139], v236 offset:26624
    s_waitcnt lgkmcnt(4)
    v_mfma_f32_32x32x16_bf16 v[192:207], v[48:51], v[140:143], v[192:207]
    s_add_u32 m0, s78, 0
    s_nop 0
    buffer_load_dwordx4 v252, s[52:55], s80 offen  lds
    ds_read_b128 v[140:143], v236 offset:27648
    s_waitcnt lgkmcnt(4)
    v_mfma_f32_32x32x16_bf16 v[192:207], v[52:55], v[144:147], v[192:207]
    ds_read_b128 v[144:147], v236 offset:35840
    s_waitcnt lgkmcnt(4)
    v_mfma_f32_32x32x16_bf16 v[192:207], v[56:59], v[128:131], v[192:207]
    ds_read_b128 v[128:131], v236 offset:36864
    s_waitcnt lgkmcnt(4)
    v_mfma_f32_32x32x16_bf16 v[192:207], v[60:63], v[132:135], v[192:207]
    s_add_u32 m0, s78, 1024
    s_add_u32 s80, s80, 14336
    buffer_load_dwordx4 v252, s[52:55], s80 offen  lds
    ds_read_b128 v[132:135], v236 offset:37888
    s_waitcnt lgkmcnt(4)
    v_mfma_f32_32x32x16_bf16 v[192:207], v[64:67], v[136:139], v[192:207]
    ds_read_b128 v[136:139], v236 offset:38912
    s_waitcnt lgkmcnt(4)
    v_mfma_f32_32x32x16_bf16 v[192:207], v[68:71], v[140:143], v[192:207]
    ds_read_b128 v[140:143], v236 offset:39936
    s_waitcnt lgkmcnt(4)
    v_mfma_f32_32x32x16_bf16 v[192:207], v[72:75], v[144:147], v[192:207]
    s_add_u32 m0, s78, 2048
    s_add_u32 s80, s80, 14336
    buffer_load_dwordx4 v252, s[52:55], s80 offen  lds
    ds_read_b128 v[144:147], v236 offset:40960
    s_waitcnt lgkmcnt(4)
    v_mfma_f32_32x32x16_bf16 v[192:207], v[76:79], v[128:131], v[192:207]
    ds_read_b128 v[128:131], v236 offset:41984
    s_waitcnt lgkmcnt(4)
    v_mfma_f32_32x32x16_bf16 v[192:207], v[80:83], v[132:135], v[192:207]
    ds_read_b128 v[132:135], v236 offset:50176
    s_waitcnt lgkmcnt(4)
    v_mfma_f32_32x32x16_bf16 v[192:207], v[84:87], v[136:139], v[192:207]
    s_add_u32 m0, s78, 3072
    s_add_u32 s80, s80, 14336
    buffer_load_dwordx4 v252, s[52:55], s80 offen  lds
    ds_read_b128 v[136:139], v236 offset:51200
    s_waitcnt lgkmcnt(4)
    v_mfma_f32_32x32x16_bf16 v[192:207], v[88:91], v[140:143], v[192:207]
    ds_read_b128 v[140:143], v236 offset:52224
    s_waitcnt lgkmcnt(4)
    v_mfma_f32_32x32x16_bf16 v[192:207], v[92:95], v[144:147], v[192:207]
    ds_read_b128 v[144:147], v236 offset:53248
    s_waitcnt lgkmcnt(4)
    v_mfma_f32_32x32x16_bf16 v[192:207], v[96:99], v[128:131], v[192:207]
    s_add_u32 m0, s78, 4096
    s_add_u32 s80, s80, 14336
    buffer_load_dwordx4 v252, s[52:55], s80 offen  lds
    ds_read_b128 v[128:131], v236 offset:54272
    s_waitcnt lgkmcnt(4)
    v_mfma_f32_32x32x16_bf16 v[192:207], v[100:103], v[132:135], v[192:207]
    ds_read_b128 v[132:135], v236 offset:55296
    s_waitcnt lgkmcnt(4)
    v_mfma_f32_32x32x16_bf16 v[192:207], v[104:107], v[136:139], v[192:207]
    ds_read_b128 v[136:139], v236 offset:56320
    s_waitcnt lgkmcnt(4)
    v_mfma_f32_32x32x16_bf16 v[192:207], v[108:111], v[140:143], v[192:207]
    s_add_u32 m0, s78, 5120
    s_add_u32 s80, s80, 14336
    buffer_load_dwordx4 v252, s[52:55], s80 offen  lds
    s_waitcnt lgkmcnt(3)
    v_mfma_f32_32x32x16_bf16 v[192:207], v[112:115], v[144:147], v[192:207]
    s_waitcnt lgkmcnt(2)
    v_mfma_f32_32x32x16_bf16 v[192:207], v[116:119], v[128:131], v[192:207]
    s_waitcnt lgkmcnt(1)
    v_mfma_f32_32x32x16_bf16 v[192:207], v[120:123], v[132:135], v[192:207]
    s_add_u32 m0, s78, 6144
    s_add_u32 s80, s80, 14336
    buffer_load_dwordx4 v252, s[52:55], s80 offen  lds
    s_waitcnt lgkmcnt(0)
    v_mfma_f32_32x32x16_bf16 v[192:207], v[124:127], v[136:139], v[192:207]
    v_mfma_f32_32x32x16_bf16 v[192:207], v[152:155], v[180:183], v[192:207]
    s_setprio 1
    s_nop 10
    v_mul_f32 v160, v192, v192
    v_mul_f32 v161, v193, v193
    v_mul_f32 v162, v194, v194
    v_mul_f32 v163, v195, v195
    v_mul_f32 v164, v196, v196
    v_mul_f32 v165, v197, v197
    v_mul_f32 v166, v198, v198
    v_mul_f32 v167, v199, v199
    v_mul_f32 v168, v200, v200
    v_mul_f32 v169, v201, v201
    v_mul_f32 v170, v202, v202
    v_mul_f32 v171, v203, v203
    v_mul_f32 v172, v204, v204
    v_mul_f32 v173, v205, v205
    v_mul_f32 v174, v206, v206
    v_mul_f32 v175, v207, v207
    v_fma_f32 v160, v160, v213, v212
    v_fma_f32 v161, v161, v213, v212
    v_fma_f32 v162, v162, v213, v212
    v_fma_f32 v163, v163, v213, v212
    v_fma_f32 v164, v164, v213, v212
    v_fma_f32 v165, v165, v213, v212
    v_fma_f32 v166, v166, v213, v212
    v_fma_f32 v167, v167, v213, v212
    s_barrier
    v_fma_f32 v168, v168, v213, v212
    v_fma_f32 v169, v169, v213, v212
    v_fma_f32 v170, v170, v213, v212
    v_fma_f32 v171, v171, v213, v212
    v_fma_f32 v172, v172, v213, v212
    v_fma_f32 v173, v173, v213, v212
    v_fma_f32 v174, v174, v213, v212
    v_fma_f32 v175, v175, v213, v212
    v_mul_f32 v160, v160, v192
    v_mul_f32 v161, v161, v193
    v_mul_f32 v162, v162, v194
    v_mul_f32 v163, v163, v195
    v_mul_f32 v164, v164, v196
    v_mul_f32 v165, v165, v197
    v_mul_f32 v166, v166, v198
    v_mul_f32 v167, v167, v199
    v_mul_f32 v168, v168, v200
    v_mul_f32 v169, v169, v201
    v_mul_f32 v170, v170, v202
    v_mul_f32 v171, v171, v203
    v_mul_f32 v172, v172, v204
    v_mul_f32 v173, v173, v205
    v_mul_f32 v174, v174, v206
    v_mul_f32 v175, v175, v207
    v_exp_f32 v160, v160
    v_exp_f32 v161, v161
    v_exp_f32 v162, v162
    v_exp_f32 v163, v163
    v_exp_f32 v164, v164
    v_exp_f32 v165, v165
    v_exp_f32 v166, v166
    v_exp_f32 v167, v167
    v_exp_f32 v168, v168
    v_exp_f32 v169, v169
    v_exp_f32 v170, v170
    v_exp_f32 v171, v171
    v_exp_f32 v172, v172
    v_exp_f32 v173, v173
    v_exp_f32 v174, v174
    v_exp_f32 v175, v175
    v_fma_f32 v160, v160, v214, v214
    v_fma_f32 v161, v161, v214, v214
    v_fma_f32 v162, v162, v214, v214
    v_fma_f32 v163, v163, v214, v214
    v_fma_f32 v164, v164, v214, v214
    v_fma_f32 v165, v165, v214, v214
    v_fma_f32 v166, v166, v214, v214
    v_fma_f32 v167, v167, v214, v214
    v_fma_f32 v168, v168, v214, v214
    v_fma_f32 v169, v169, v214, v214
    v_fma_f32 v170, v170, v214, v214
    v_fma_f32 v171, v171, v214, v214
    v_fma_f32 v172, v172, v214, v214
    v_fma_f32 v173, v173, v214, v214
    v_fma_f32 v174, v174, v214, v214
    v_fma_f32 v175, v175, v214, v214
    v_rcp_f32 v160, v160
    v_rcp_f32 v161, v161
    v_rcp_f32 v162, v162
    v_rcp_f32 v163, v163
    v_rcp_f32 v164, v164
    v_rcp_f32 v165, v165
    v_rcp_f32 v166, v166
    v_rcp_f32 v167, v167
    v_rcp_f32 v168, v168
    v_rcp_f32 v169, v169
    v_rcp_f32 v170, v170
    v_rcp_f32 v171, v171
    v_rcp_f32 v172, v172
    v_rcp_f32 v173, v173
    v_rcp_f32 v174, v174
    v_rcp_f32 v175, v175
    v_mul_f32 v160, v160, v192
    v_mul_f32 v161, v161, v193
    v_mul_f32 v162, v162, v194
    v_mul_f32 v163, v163, v195
    v_mul_f32 v164, v164, v196
    v_mul_f32 v165, v165, v197
    v_mul_f32 v166, v166, v198
    v_mul_f32 v167, v167, v199
    v_mul_f32 v168, v168, v200
    v_mul_f32 v169, v169, v201
    v_mul_f32 v170, v170, v202
    v_mul_f32 v171, v171, v203
    v_mul_f32 v172, v172, v204
    v_mul_f32 v173, v173, v205
    v_mul_f32 v174, v174, v206
    v_mul_f32 v175, v175, v207
    v_cvt_pk_bf16_f32 v192, v160, v161
    v_cvt_pk_bf16_f32 v193, v162, v163
    v_cvt_pk_bf16_f32 v194, v164, v165
    v_cvt_pk_bf16_f32 v195, v166, v167
    ds_write_b128 v237, v[192:195] offset:16384
    v_cvt_pk_bf16_f32 v196, v168, v169
    v_cvt_pk_bf16_f32 v197, v170, v171
    v_cvt_pk_bf16_f32 v198, v172, v173
    v_cvt_pk_bf16_f32 v199, v174, v175
    ds_write_b128 v237, v[196:199] offset:17408
    s_setprio 1
    s_waitcnt lgkmcnt(0)
    s_barrier
    buffer_load_dword v3, v14, s[56:59], s64 offen offset:1152 sc1
    s_add_u32 m0, s78, 7168
    s_add_u32 s80, s80, 14336
    buffer_load_dwordx4 v252, s[52:55], s80 offen  lds
    s_waitcnt vmcnt(8)
    ds_read_b64_tr_b16 v[16:17], v253 offset:0
    ds_read_b64_tr_b16 v[18:19], v253 offset:256
    s_add_u32 m0, s78, 8192
    s_add_u32 s80, s80, 14336
    buffer_load_dwordx4 v252, s[52:55], s80 offen  lds
    s_waitcnt vmcnt(8)
    ds_read_b64_tr_b16 v[20:21], v253 offset:1024
    ds_read_b64_tr_b16 v[22:23], v253 offset:1280
    s_add_u32 m0, s78, 9216
    s_add_u32 s80, s80, 14336
    buffer_load_dwordx4 v252, s[52:55], s80 offen  lds
    s_waitcnt vmcnt(8)
    ds_read_b64_tr_b16 v[24:25], v253 offset:2048
    ds_read_b64_tr_b16 v[26:27], v253 offset:2304
    s_add_u32 m0, s78, 10240
    s_add_u32 s80, s80, 14336
    buffer_load_dwordx4 v252, s[52:55], s80 offen  lds
    s_waitcnt vmcnt(8)
    ds_read_b64_tr_b16 v[28:29], v253 offset:3072
    ds_read_b64_tr_b16 v[30:31], v253 offset:3328
    s_add_u32 m0, s78, 11264
    s_add_u32 s80, s80, 14336
    buffer_load_dwordx4 v252, s[52:55], s80 offen  lds
    s_waitcnt vmcnt(8)
    ds_read_b64_tr_b16 v[32:33], v253 offset:4096
    ds_read_b64_tr_b16 v[34:35], v253 offset:4352
    s_add_u32 m0, s78, 12288
    s_add_u32 s80, s80, 14336
    buffer_load_dwordx4 v252, s[52:55], s80 offen  lds
    s_waitcnt vmcnt(8)
    ds_read_b64_tr_b16 v[36:37], v253 offset:5120
    ds_read_b64_tr_b16 v[38:39], v253 offset:5376
    s_add_u32 m0, s78, 13312
    s_add_u32 s80, s80, 14336
    buffer_load_dwordx4 v252, s[52:55], s80 offen  lds
    s_waitcnt vmcnt(8)
    ds_read_b64_tr_b16 v[40:41], v253 offset:6144
    ds_read_b64_tr_b16 v[42:43], v253 offset:6400
    s_waitcnt lgkmcnt(12)
    s_add_u32 m0, s78, 0
    s_add_u32 s80, s80, 14336
    buffer_load_dwordx4 v252, s[52:55], s80 offen  lds
    s_waitcnt lgkmcnt(10)
    s_add_u32 m0, s78, 1024
    s_add_u32 s80, s80, 14336
    buffer_load_dwordx4 v252, s[52:55], s80 offen  lds
    v_lshrrev_b32 v7, 5, v0
    v_bfe_u32 v10, v0, 1, 1
    v_mov_b32 v8, 0x3f80
    v_mov_b32 v9, 0x3f800000
    v_cndmask_b32 v8, v8, v9, s[70:71]
    v_bfe_u32 v9, v0, 2, 1
    s_waitcnt lgkmcnt(8)
    s_add_u32 m0, s78, 2048
    s_nop 0
    buffer_load_dwordx4 v220, s[52:55], s79 offen  lds
    v_xor_b32 v9, v9, v7
    v_bfe_u32 v11, v0, 3, 2
    v_lshl_add_u32 v11, v11, 1, v10
    v_lshl_add_u32 v11, v9, 3, v11
    v_cmp_eq_u32 s[90:91], 0, v11
    v_cmp_eq_u32 s[92:93], 1, v11
    s_waitcnt lgkmcnt(6)
    s_add_u32 m0, s78, 3072
    s_add_u32 s79, s79, 7168
    buffer_load_dwordx4 v220, s[52:55], s79 offen  lds
    s_nop 0
    v_cndmask_b32 v148, 0, v8, s[90:91]
    v_cndmask_b32 v149, 0, v8, s[92:93]
    v_cmp_eq_u32 s[90:91], 2, v11
    v_cmp_eq_u32 s[92:93], 3, v11
    s_nop 0
    s_waitcnt lgkmcnt(4)
    s_add_u32 m0, s78, 4096
    s_add_u32 s79, s79, 7168
    buffer_load_dwordx4 v220, s[52:55], s79 offen  lds
    v_cndmask_b32 v150, 0, v8, s[90:91]
    v_cndmask_b32 v151, 0, v8, s[92:93]
    v_cmp_eq_u32 s[90:91], 4, v11
    v_cmp_eq_u32 s[92:93], 5, v11
    s_nop 0
    v_cndmask_b32 v152, 0, v8, s[90:91]
    s_waitcnt lgkmcnt(2)
    s_add_u32 m0, s78, 5120
    s_add_u32 s79, s79, 7168
    buffer_load_dwordx4 v220, s[52:55], s79 offen  lds
    v_cndmask_b32 v153, 0, v8, s[92:93]
    v_cmp_eq_u32 s[90:91], 6, v11
    v_cmp_eq_u32 s[92:93], 7, v11
    s_nop 0
    v_cndmask_b32 v154, 0, v8, s[90:91]
    v_cndmask_b32 v155, 0, v8, s[92:93]
    s_waitcnt lgkmcnt(0)
    s_add_u32 m0, s78, 6144
    s_add_u32 s79, s79, 7168
    buffer_load_dwordx4 v220, s[52:55], s79 offen  lds
    s_waitcnt vmcnt(13)
    ds_read_b64_tr_b16 v[44:45], v253 offset:7168
    ds_read_b64_tr_b16 v[46:47], v253 offset:7424
    s_waitcnt vmcnt(12)
    ds_read_b64_tr_b16 v[48:49], v253 offset:8192
    ds_read_b64_tr_b16 v[50:51], v253 offset:8448
    s_waitcnt vmcnt(11)
    ds_read_b64_tr_b16 v[52:53], v253 offset:9216
    ds_read_b64_tr_b16 v[54:55], v253 offset:9472
    s_mov_b32 s94, 0xffff0000
    v_lshlrev_b32 v224, 16, v184
    v_and_b32 v225, s94, v184
    v_lshlrev_b32 v226, 16, v185
    v_and_b32 v227, s94, v185
    v_lshlrev_b32 v228, 16, v186
    s_waitcnt lgkmcnt(4)
    s_add_u32 m0, s78, 7168
    s_add_u32 s79, s79, 7168
    buffer_load_dwordx4 v220, s[52:55], s79 offen  lds
    v_and_b32 v229, s94, v186
    v_lshlrev_b32 v230, 16, v187
    v_and_b32 v231, s94, v187
    v_lshlrev_b32 v232, 16, v188
    v_and_b32 v233, s94, v188
    v_lshlrev_b32 v234, 16, v189
    s_waitcnt lgkmcnt(2)
    s_add_u32 m0, s78, 8192
    s_add_u32 s79, s79, 7168
    buffer_load_dwordx4 v220, s[52:55], s79 offen  lds
    v_and_b32 v235, s94, v189
    v_lshlrev_b32 v236, 16, v190
    v_and_b32 v237, s94, v190
    v_lshlrev_b32 v238, 16, v191
    v_and_b32 v239, s94, v191
    ds_read_b128 v[192:195], v223 offset:1024
    s_waitcnt lgkmcnt(1)
    s_add_u32 m0, s78, 9216
    s_add_u32 s79, s79, 7168
    buffer_load_dwordx4 v220, s[52:55], s79 offen  lds
    ds_read_b128 v[196:199], v223 offset:1040
    ds_read_b128 v[200:203], v223 offset:1088
    ds_read_b128 v[204:207], v223 offset:1104
    ds_read_b128 v[160:163], v223 offset:768
    ds_read_b128 v[164:167], v223 offset:784
    ds_read_b128 v[168:171], v223 offset:832
    ds_read_b128 v[172:175], v223 offset:848
    v_cmp_ne_u32 vcc, s6, v3
    s_cbranch_vccnz Lre_49
Lreb_50:
    s_waitcnt vmcnt(13)
    ds_read_b64_tr_b16 v[56:57], v253 offset:10240
    ds_read_b64_tr_b16 v[58:59], v253 offset:10496
    s_waitcnt vmcnt(12)
    ds_read_b64_tr_b16 v[60:61], v253 offset:11264
    ds_read_b64_tr_b16 v[62:63], v253 offset:11520
    s_setprio 1
    ds_read_b128 v[128:131], v240 offset:0
    ds_read_b128 v[132:135], v240 offset:1024
    ds_read_b128 v[136:139], v240 offset:2048
    ds_read_b128 v[140:143], v240 offset:3072
    ds_read_b128 v[144:147], v240 offset:4096
    s_waitcnt lgkmcnt(4)
    v_mfma_f32_32x32x16_bf16 v[80:95], v[16:19], v[128:131], 0
    s_waitcnt vmcnt(11)
    ds_read_b64_tr_b16 v[64:65], v253 offset:12288
    ds_read_b64_tr_b16 v[66:67], v253 offset:12544
    ds_read_b128 v[128:131], v240 offset:5120
    s_waitcnt lgkmcnt(6)
    v_mfma_f32_32x32x16_bf16 v[80:95], v[20:23], v[132:135], v[80:95]
    ds_read_b128 v[132:135], v240 offset:6144
    s_waitcnt lgkmcnt(6)
    v_mfma_f32_32x32x16_bf16 v[80:95], v[24:27], v[136:139], v[80:95]
    s_waitcnt vmcnt(10)
    ds_read_b64_tr_b16 v[68:69], v253 offset:13312
    ds_read_b64_tr_b16 v[70:71], v253 offset:13568
    ds_read_b128 v[136:139], v240 offset:7168
    s_waitcnt lgkmcnt(8)
    v_mfma_f32_32x32x16_bf16 v[80:95], v[28:31], v[140:143], v[80:95]
    ds_read_b128 v[140:143], v240 offset:8192
    s_waitcnt lgkmcnt(8)
    v_mfma_f32_32x32x16_bf16 v[80:95], v[32:35], v[144:147], v[80:95]
    s_waitcnt vmcnt(9)
    ds_read_b64_tr_b16 v[72:73], v253 offset:0
    ds_read_b64_tr_b16 v[74:75], v253 offset:256
    ds_read_b128 v[144:147], v240 offset:9216
    s_waitcnt lgkmcnt(8)
    v_mfma_f32_32x32x16_bf16 v[80:95], v[36:39], v[128:131], v[80:95]
    ds_read_b128 v[128:131], v240 offset:10240
    s_waitcnt lgkmcnt(8)
    v_mfma_f32_32x32x16_bf16 v[80:95], v[40:43], v[132:135], v[80:95]
    s_waitcnt vmcnt(8)
    ds_read_b64_tr_b16 v[76:77], v253 offset:1024
    ds_read_b64_tr_b16 v[78:79], v253 offset:1280
    ds_read_b128 v[132:135], v240 offset:11264
    s_waitcnt lgkmcnt(8)
    v_mfma_f32_32x32x16_bf16 v[80:95], v[44:47], v[136:139], v[80:95]
    ds_read_b128 v[136:139], v240 offset:12288
    s_waitcnt lgkmcnt(8)
    v_mfma_f32_32x32x16_bf16 v[80:95], v[48:51], v[140:143], v[80:95]
    ds_read_b128 v[140:143], v240 offset:13312
    s_waitcnt lgkmcnt(6)
    v_mfma_f32_32x32x16_bf16 v[80:95], v[52:55], v[144:147], v[80:95]
    ds_read_b128 v[144:147], v240 offset:14336
    s_waitcnt lgkmcnt(6)
    v_mfma_f32_32x32x16_bf16 v[80:95], v[56:59], v[128:131], v[80:95]
    ds_read_b128 v[128:131], v240 offset:15360
    s_waitcnt lgkmcnt(4)
    v_mfma_f32_32x32x16_bf16 v[80:95], v[60:63], v[132:135], v[80:95]
    ds_read_b128 v[132:135], v240 offset:16384
    s_waitcnt lgkmcnt(4)
    v_mfma_f32_32x32x16_bf16 v[80:95], v[64:67], v[136:139], v[80:95]
    ds_read_b128 v[136:139], v240 offset:17408
    s_waitcnt lgkmcnt(4)
    v_mfma_f32_32x32x16_bf16 v[80:95], v[68:71], v[140:143], v[80:95]
    ds_read_b128 v[140:143], v240 offset:18432
    s_waitcnt lgkmcnt(4)
    v_mfma_f32_32x32x16_bf16 v[80:95], v[72:75], v[144:147], v[80:95]
    ds_read_b128 v[144:147], v240 offset:19456
    s_waitcnt lgkmcnt(4)
    v_mfma_f32_32x32x16_bf16 v[80:95], v[76:79], v[128:131], v[80:95]
    ds_read_b128 v[128:131], v240 offset:20480
    s_waitcnt lgkmcnt(4)
    v_mfma_f32_32x32x16_bf16 v[96:111], v[16:19], v[132:135], 0
    ds_read_b128 v[132:135], v240 offset:21504
    s_waitcnt lgkmcnt(4)
    v_mfma_f32_32x32x16_bf16 v[96:111], v[20:23], v[136:139], v[96:111]
    ds_read_b128 v[136:139], v240 offset:22528
    s_waitcnt lgkmcnt(4)
    v_mfma_f32_32x32x16_bf16 v[96:111], v[24:27], v[140:143], v[96:111]
    ds_read_b128 v[140:143], v240 offset:23552
    s_waitcnt lgkmcnt(4)
    v_mfma_f32_32x32x16_bf16 v[96:111], v[28:31], v[144:147], v[96:111]
    v_cvt_pk_bf16_f32 v112, v80, v81
    v_cvt_pk_bf16_f32 v113, v82, v83
    v_cvt_pk_bf16_f32 v114, v84, v85
    v_cvt_pk_bf16_f32 v115, v86, v87
    v_cvt_pk_bf16_f32 v116, v88, v89
    v_cvt_pk_bf16_f32 v117, v90, v91
    v_cvt_pk_bf16_f32 v118, v92, v93
    v_cvt_pk_bf16_f32 v119, v94, v95
    s_cmp_lg_u32 s7, 0
    s_cbranch_scc1 Lslow_52
    buffer_store_dwordx4 v[112:115], v216, s[56:59], s81 offen offset:0
    buffer_store_dwordx4 v[116:119], v216, s[56:59], s81 offen offset:1024
Lback_53:
    ds_read_b128 v[144:147], v240 offset:24576
    s_waitcnt lgkmcnt(4)
    v_mfma_f32_32x32x16_bf16 v[96:111], v[32:35], v[128:131], v[96:111]
    ds_read_b128 v[128:131], v240 offset:25600
    s_waitcnt lgkmcnt(4)
    v_mfma_f32_32x32x16_bf16 v[96:111], v[36:39], v[132:135], v[96:111]
    ds_read_b128 v[132:135], v240 offset:26624
    s_waitcnt lgkmcnt(4)
    v_mfma_f32_32x32x16_bf16 v[96:111], v[40:43], v[136:139], v[96:111]
    s_waitcnt vmcnt(2)
    ds_write_b32 v5, v217 offset:16
    ds_read_b128 v[136:139], v240 offset:27648
    s_waitcnt lgkmcnt(5)
    v_mfma_f32_32x32x16_bf16 v[96:111], v[44:47], v[140:143], v[96:111]
    ds_read_b128 v[140:143], v240 offset:28672
    s_waitcnt lgkmcnt(5)
    v_mfma_f32_32x32x16_bf16 v[96:111], v[48:51], v[144:147], v[96:111]
    ds_read_b128 v[144:147], v240 offset:29696
    s_waitcnt lgkmcnt(5)
    v_mfma_f32_32x32x16_bf16 v[96:111], v[52:55], v[128:131], v[96:111]
    ds_read_b32 v2, v6
    ds_read_b128 v[128:131], v240 offset:30720
    s_waitcnt lgkmcnt(6)
    v_mfma_f32_32x32x16_bf16 v[96:111], v[56:59], v[132:135], v[96:111]
    ds_read_b128 v[132:135], v240 offset:31744
    s_waitcnt lgkmcnt(5)
    v_mfma_f32_32x32x16_bf16 v[96:111], v[60:63], v[136:139], v[96:111]
    s_waitcnt lgkmcnt(2)
    v_cmp_ne_u32 vcc, s6, v2
    s_cbranch_vccnz Llr_54
Llrb_55:
    ds_read_b64_tr_b16 v[16:17], v219 offset:0
    ds_read_b64_tr_b16 v[18:19], v219 offset:512
    ds_read_b128 v[136:139], v243 offset:0
    v_mfma_f32_32x32x16_bf16 v[96:111], v[64:67], v[140:143], v[96:111]
    ds_read_b64_tr_b16 v[20:21], v219 offset:2048
    ds_read_b64_tr_b16 v[22:23], v219 offset:2560
    ds_read_b128 v[140:143], v243 offset:1024
    v_mfma_f32_32x32x16_bf16 v[96:111], v[68:71], v[144:147], v[96:111]
    ds_read_b64_tr_b16 v[24:25], v219 offset:4096
    ds_read_b64_tr_b16 v[26:27], v219 offset:4608
    ds_read_b128 v[144:147], v243 offset:2048
    s_waitcnt lgkmcnt(10)
    v_mfma_f32_32x32x16_bf16 v[96:111], v[72:75], v[128:131], v[96:111]
    ds_read_b64_tr_b16 v[28:29], v219 offset:6144
    ds_read_b64_tr_b16 v[30:31], v219 offset:6656
    ds_read_b128 v[128:131], v243 offset:3072
    s_waitcnt lgkmcnt(12)
    v_mfma_f32_32x32x16_bf16 v[96:111], v[76:79], v[132:135], v[96:111]
    ds_read_b64_tr_b16 v[32:33], v219 offset:14336
    ds_read_b64_tr_b16 v[34:35], v219 offset:14848
    ds_read_b128 v[132:135], v243 offset:4096
    s_waitcnt lgkmcnt(12)
    v_mfma_f32_32x32x16_bf16 v[192:207], v[16:19], v[136:139], v[192:207]
    ds_read_b64_tr_b16 v[36:37], v219 offset:16384
    ds_read_b64_tr_b16 v[38:39], v219 offset:16896
    ds_read_b128 v[136:139], v243 offset:5120
    s_waitcnt lgkmcnt(12)
    v_mfma_f32_32x32x16_bf16 v[192:207], v[20:23], v[140:143], v[192:207]
    ds_read_b64_tr_b16 v[40:41], v219 offset:18432
    ds_read_b64_tr_b16 v[42:43], v219 offset:18944
    ds_read_b128 v[140:143], v243 offset:6144
    s_waitcnt lgkmcnt(12)
    v_mfma_f32_32x32x16_bf16 v[192:207], v[24:27], v[144:147], v[192:207]
    ds_read_b64_tr_b16 v[44:45], v219 offset:20480
    ds_read_b64_tr_b16 v[46:47], v219 offset:20992
    v_cvt_pk_bf16_f32 v120, v96, v97
    v_cvt_pk_bf16_f32 v121, v98, v99
    v_cvt_pk_bf16_f32 v122, v100, v101
    v_cvt_pk_bf16_f32 v123, v102, v103
    v_cvt_pk_bf16_f32 v124, v104, v105
    v_cvt_pk_bf16_f32 v125, v106, v107
    v_cvt_pk_bf16_f32 v126, v108, v109
    v_cvt_pk_bf16_f32 v127, v110, v111
    s_cmp_lg_u32 s7, 0
    s_cbranch_scc1 Lslow_57
    buffer_store_dwordx4 v[120:123], v216, s[56:59], s81 offen offset:2048
    buffer_store_dwordx4 v[124:127], v216, s[56:59], s81 offen offset:3072
Lback_58:
    ds_read_b128 v[144:147], v243 offset:7168
    s_waitcnt lgkmcnt(12)
    v_mfma_f32_32x32x16_bf16 v[192:207], v[28:31], v[128:131], v[192:207]
    ds_read_b64_tr_b16 v[48:49], v219 offset:28672
    ds_read_b64_tr_b16 v[50:51], v219 offset:29184
    ds_read_b128 v[128:131], v243 offset:8192
    s_waitcnt lgkmcnt(12)
    v_mfma_f32_32x32x16_bf16 v[192:207], v[32:35], v[132:135], v[192:207]
    ds_read_b64_tr_b16 v[52:53], v219 offset:30720
    ds_read_b64_tr_b16 v[54:55], v219 offset:31232
    ds_read_b128 v[132:135], v243 offset:9216
    s_waitcnt lgkmcnt(12)
    v_mfma_f32_32x32x16_bf16 v[192:207], v[36:39], v[136:139], v[192:207]
    ds_read_b64_tr_b16 v[56:57], v219 offset:32768
    ds_read_b64_tr_b16 v[58:59], v219 offset:33280
    ds_read_b128 v[136:139], v243 offset:10240
    s_waitcnt lgkmcnt(12)
    v_mfma_f32_32x32x16_bf16 v[192:207], v[40:43], v[140:143], v[192:207]
    ds_read_b64_tr_b16 v[60:61], v219 offset:34816
    ds_read_b64_tr_b16 v[62:63], v219 offset:35328
    ds_read_b128 v[140:143], v243 offset:11264
    s_waitcnt lgkmcnt(12)
    v_mfma_f32_32x32x16_bf16 v[192:207], v[44:47], v[144:147], v[192:207]
    ds_read_b64_tr_b16 v[64:65], v219 offset:43008
    ds_read_b64_tr_b16 v[66:67], v219 offset:43520
    ds_read_b128 v[144:147], v243 offset:12288
    s_waitcnt lgkmcnt(12)
    v_mfma_f32_32x32x16_bf16 v[192:207], v[48:51], v[128:131], v[192:207]
    ds_read_b64_tr_b16 v[68:69], v219 offset:45056
    ds_read_b64_tr_b16 v[70:71], v219 offset:45568
    ds_read_b128 v[128:131], v243 offset:13312
    s_waitcnt lgkmcnt(12)
    v_mfma_f32_32x32x16_bf16 v[192:207], v[52:55], v[132:135], v[192:207]
    ds_read_b64_tr_b16 v[72:73], v219 offset:47104
    ds_read_b64_tr_b16 v[74:75], v219 offset:47616
    ds_read_b128 v[132:135], v243 offset:14336
    s_waitcnt lgkmcnt(12)
    v_mfma_f32_32x32x16_bf16 v[192:207], v[56:59], v[136:139], v[192:207]
    ds_read_b64_tr_b16 v[76:77], v219 offset:49152
    ds_read_b64_tr_b16 v[78:79], v219 offset:49664
    ds_read_b128 v[136:139], v243 offset:15360
    s_waitcnt lgkmcnt(12)
    v_mfma_f32_32x32x16_bf16 v[192:207], v[60:63], v[140:143], v[192:207]
    s_waitcnt lgkmcnt(9)
    v_mfma_f32_32x32x16_bf16 v[192:207], v[64:67], v[144:147], v[192:207]
    s_waitcnt lgkmcnt(6)
    v_mfma_f32_32x32x16_bf16 v[192:207], v[68:71], v[128:131], v[192:207]
    s_waitcnt lgkmcnt(3)
    v_mfma_f32_32x32x16_bf16 v[192:207], v[72:75], v[132:135], v[192:207]
    s_waitcnt lgkmcnt(0)
    v_mfma_f32_32x32x16_bf16 v[192:207], v[76:79], v[136:139], v[192:207]
    s_waitcnt vmcnt(0)
    s_cmp_lg_u32 s7, 0
    s_cbranch_scc1 Lslow_59
    s_mov_b64 exec, 1
    buffer_store_dword v217, off, s[56:59], s82 offset:0
    s_mov_b64 exec, -1
Lback_60:
    s_mov_b32 s95, 0x40000
Lpoll_61:
    buffer_load_dword v2, v15, s[56:59], s84 offen offset:288 sc1
    s_waitcnt vmcnt(0)
    v_cmp_ne_u32 vcc, s6, v2
    s_cbranch_vccz Lgot_62
    s_sub_u32 s95, s95, 1
    s_cbranch_scc0 Lpoll_61
Lgot_62:
    buffer_load_dwordx4 v[208:211], v216, s[56:59], s87 offen offset:0 sc1
    buffer_load_dwordx4 v[212:215], v216, s[56:59], s87 offen offset:1024 sc1
    buffer_load_dwordx4 v[244:247], v216, s[56:59], s86 offen offset:0 sc1
    buffer_load_dwordx4 v[248:251], v216, s[56:59], s86 offen offset:1024 sc1
    ds_read_b32 v7, v5 offset:64
    ds_read_b128 v[80:83], v13 offset:0
    ds_read_b128 v[84:87], v13 offset:1024
    ds_read_b128 v[88:91], v13 offset:2048
    ds_read_b128 v[92:95], v13 offset:3072
    ds_read_b128 v[96:99], v13 offset:4096
    ds_read_b128 v[100:103], v13 offset:5120
    ds_read_b128 v[104:107], v13 offset:6144
    ds_read_b128 v[108:111], v13 offset:7168
    s_waitcnt lgkmcnt(8)
    v_cmp_ne_u32 vcc, s6, v7
    s_cbranch_vccnz Llr_63
Llrb_64:
    s_waitcnt lgkmcnt(7)
    v_mfma_f32_32x32x16_bf16 v[192:207], v[148:151], v[80:83], v[192:207]
    s_waitcnt lgkmcnt(6)
    v_mfma_f32_32x32x16_bf16 v[192:207], v[152:155], v[84:87], v[192:207]
    s_waitcnt lgkmcnt(5)
    v_mfma_f32_32x32x16_bf16 v[192:207], v[148:151], v[88:91], v[192:207]
    s_waitcnt lgkmcnt(4)
    v_mfma_f32_32x32x16_bf16 v[192:207], v[152:155], v[92:95], v[192:207]
    s_waitcnt lgkmcnt(3)
    v_mfma_f32_32x32x16_bf16 v[192:207], v[148:151], v[96:99], v[192:207]
    s_waitcnt lgkmcnt(2)
    v_mfma_f32_32x32x16_bf16 v[192:207], v[152:155], v[100:103], v[192:207]
    s_waitcnt lgkmcnt(1)
    v_mfma_f32_32x32x16_bf16 v[192:207], v[148:151], v[104:107], v[192:207]
    s_waitcnt lgkmcnt(0)
    v_mfma_f32_32x32x16_bf16 v[192:207], v[152:155], v[108:111], v[192:207]
    s_waitcnt vmcnt(3)
    v_mfma_f32_32x32x16_bf16 v[192:207], v[148:151], v[208:211], v[192:207]
    s_waitcnt vmcnt(2)
    v_mfma_f32_32x32x16_bf16 v[192:207], v[152:155], v[212:215], v[192:207]
    s_waitcnt vmcnt(1)
    v_mfma_f32_32x32x16_bf16 v[192:207], v[148:151], v[244:247], v[192:207]
    s_waitcnt vmcnt(0)
    v_mfma_f32_32x32x16_bf16 v[192:207], v[152:155], v[248:251], v[192:207]
    s_nop 11
    v_pk_fma_f32 v[224:225], v[192:193], v[160:161], v[224:225]
    v_pk_fma_f32 v[226:227], v[194:195], v[162:163], v[226:227]
    v_pk_fma_f32 v[228:229], v[196:197], v[164:165], v[228:229]
    v_pk_fma_f32 v[230:231], v[198:199], v[166:167], v[230:231]
    v_cvt_pk_bf16_f32 v48, v224, v225
    v_cvt_pk_bf16_f32 v49, v226, v227
    v_cvt_pk_bf16_f32 v50, v228, v229
    v_cvt_pk_bf16_f32 v51, v230, v231
    buffer_store_dwordx4 v[48:51], v241, s[60:63], 0 offen offset:0
    v_pk_fma_f32 v[232:233], v[200:201], v[168:169], v[232:233]
    v_pk_fma_f32 v[234:235], v[202:203], v[170:171], v[234:235]
    v_pk_fma_f32 v[236:237], v[204:205], v[172:173], v[236:237]
    v_pk_fma_f32 v[238:239], v[206:207], v[174:175], v[238:239]
    v_cvt_pk_bf16_f32 v52, v232, v233
    v_cvt_pk_bf16_f32 v53, v234, v235
    v_cvt_pk_bf16_f32 v54, v236, v237
    v_cvt_pk_bf16_f32 v55, v238, v239
    buffer_store_dwordx4 v[52:55], v241, s[60:63], 0 offen offset:32
    s_endpgm
L_B:
    s_load_dword s99, s[32:33], 0
    s_mov_b64 s[40:41], s[10:11]
    s_mov_b32 s42, 1204224
    s_mov_b32 s43, 0x20000
    s_mov_b64 s[44:45], s[12:13]
    s_mov_b32 s46, 401408
    s_mov_b32 s47, 0x20000
    s_mov_b64 s[48:49], s[16:17]
    s_mov_b32 s50, 1605632
    s_mov_b32 s51, 0x20000
    s_mov_b64 s[52:53], s[20:21]
    s_mov_b32 s54, 1605632
    s_mov_b32 s55, 0x20000
    s_mov_b64 s[56:57], s[32:33]
    s_mov_b32 s58, 268435456
    s_mov_b32 s59, 0x20000
    s_mov_b64 s[60:61], s[28:29]
    s_mov_b32 s62, 1835008
    s_mov_b32 s63, 0x20000
    s_mov_b32 s73, 0x3f803f80
    s_mov_b32 s74, 0xffff0000
    v_add_u32 v243, 158720, v15
    s_and_b32 s89, s69, 1
    s_lshr_b32 s91, s69, 1
    s_lshl2_add_u32 s91, s91, s89
    v_xor_b32 v3, s91, v0
    s_add_u32 s90, s88, 28672
    v_cmp_gt_u32 vcc, 56, v0
    v_lshl_add_u32 v4, v3, 4, s90
    v_mov_b32 v5, 262144
    v_cndmask_b32 v240, v5, v4, vcc
    v_xor_b32 v241, 32, v240
    s_waitcnt lgkmcnt(0)
    s_add_u32 s6, s99, 0x9e3779b9
    v_lshrrev_b32 v3, 5, v0
    v_lshlrev_b32 v4, 10, v3
    v_bfe_u32 v5, v0, 2, 2
    v_lshl_add_u32 v4, v5, 7, v4
    v_bfe_u32 v5, v0, 3, 1
    v_xor_b32 v5, s89, v5
    v_lshl_add_u32 v4, v5, 6, v4
    v_bfe_u32 v6, v0, 4, 1
    v_lshl_add_u32 v4, v6, 5, v4
    v_and_b32 v5, 3, v0
    v_lshl_add_u32 v4, v5, 3, v4
    v_add_u32 v242, 100352, v4
    s_mul_i32 s91, s89, 5120
    s_add_u32 s91, s91, 18432
    v_and_b32 v5, 15, v0
    v_lshl_add_u32 v244, v5, 3, s91
    v_lshl_add_u32 v244, v3, 7, v244
    v_mul_u32_u24 v6, 2560, v6
    v_add_u32 v244, v6, v244
    v_mov_b32 v251, s6
    s_lshl_b32 s75, s4, 7
    v_lshrrev_b32 v3, 3, v0
    v_mul_u32_u24 v246, 896, v3
    v_bfe_u32 v3, v0, 4, 2
    v_lshlrev_b32 v3, 1, v3
    v_and_b32 v4, 7, v0
    v_xor_b32 v3, v3, v4
    v_lshl_add_u32 v246, v3, 4, v246
    v_bfe_u32 v3, v0, 2, 2
    v_lshrrev_b32 v4, 5, v0
    v_lshl_add_u32 v3, v4, 2, v3
    v_and_b32 v4, 16, v0
    v_add_u32 v3, v3, v4
    v_mul_u32_u24 v245, 3584, v3
    v_and_b32 v3, 3, v0
    v_lshl_add_u32 v245, v3, 4, v245
    s_mul_i32 s86, s69, 7168
    s_add_u32 s86, s86, s75
    s_lshl_b32 s87, s69, 10
    s_add_u32 s87, s87, 100352
    v_min_u32 v3, 55, v0
    s_lshr_b32 s90, s2, 6
    s_lshl1_add_u32 s90, s90, s89
    s_mul_i32 s90, s90, 56
    v_add_u32 v3, s90, v3
    v_mul_u32_u24 v3, 896, v3
    v_add_u32 v247, s75, v3
    v_bfe_u32 v2, v0, 1, 1
    v_bfe_u32 v3, v0, 2, 1
    v_lshl_add_u32 v2, v2, 1, v3
    v_bfe_u32 v3, v0, 3, 1
    v_lshl_add_u32 v2, v3, 2, v2
    v_lshrrev_b32 v3, 5, v0
    v_xor_b32 v2, v2, v3
    v_and_b32 v3, 31, v0
    v_mul_u32_u24 v3, 896, v3
    v_lshl_add_u32 v3, v2, 4, v3
    v_add_u32 v4, 28672, v3
    v_xor_b32 v5, 32, v4
    v_xor_b32 v6, 64, v4
    v_xor_b32 v7, 0x60, v4
    v_lshrrev_b32 v2, 5, v0
    v_lshlrev_b32 v8, 9, v2
    v_bfe_u32 v2, v0, 2, 2
    v_lshl_add_u32 v8, v2, 6, v8
    v_bfe_u32 v2, v0, 4, 1
    v_lshl_add_u32 v8, v2, 5, v8
    v_and_b32 v2, 1, v0
    v_lshl_add_u32 v8, v2, 4, v8
    v_bfe_u32 v2, v0, 1, 1
    v_lshl_add_u32 v8, v2, 3, v8
    s_mul_i32 s90, s69, 7168
    s_add_u32 s90, s90, 28672
    v_add_u32 v9, s90, v8
    s_lshl2_add_u32 s90, s69, 157760
    v_mov_b32 v254, s90
    v_and_b32 v2, 7, v0
    v_bfe_u32 v3, v0, 3, 1
    v_mul_u32_u24 v10, 896, v3
    v_lshl_add_u32 v10, v2, 4, v10
    s_mul_i32 s90, s69, 1792
    s_add_u32 s90, s90, s75
    s_add_u32 s90, s90, 11776
    v_add_u32 v10, s90, v10
    v_max_u32 v12, 1, v2
    s_lshl_b32 s90, s5, 7
    s_add_u32 s90, s90, 4096
    v_lshl_add_u32 v12, v12, 2, s90
    v_lshl_add_u32 v13, v0, 1, s75
    v_and_b32 v14, 15, v0
    v_lshlrev_b32 v14, 7, v14
    s_lshl2_add_u32 s90, s4, s69
    s_lshl_b32 s67, s90, 11
    s_mul_i32 s91, s5, 577536
    s_add_u32 s67, s67, s91
    s_add_u32 s67, s67, 4196352
    s_mul_i32 s91, s5, 28
    s_add_u32 s90, s90, s91
    s_mul_i32 s66, s90, 1792
    v_min_u32 v253, 1664, v14
    v_and_b32 v11, 0x13, v0
    v_bfe_u32 v252, v0, 2, 1
    v_lshl_add_u32 v11, v252, 3, v11
    v_bfe_u32 v252, v0, 3, 1
    v_lshl_add_u32 v11, v252, 2, v11
    s_lshl3_add_u32 s90, s4, s3
    s_lshl_b32 s90, s90, 5
    v_add_u32 v11, s90, v11
    v_lshlrev_b32 v252, 1, v11
    v_lshlrev_b32 v11, 4, v11
    v_add_u32 v11, 20480, v11
    global_load_ushort v252, v252, s[18:19]
    global_load_ushort v249, v13, s[22:23]
    s_barrier
    s_cmp_eq_u32 s3, 4
    s_cbranch_scc0 L_66
    s_getreg_b32 s91, hwreg(HW_REG_XCC_ID, 0, 3)
    s_add_u32 s91, s91, s6
    v_mov_b32 v2, s91
    s_and_b32 s90, s98, 7
    s_lshl_b32 s90, s90, 2
    s_lshl_b32 s91, s5, 7
    s_add_u32 s90, s90, s91
    s_add_u32 s90, s90, 4096
    s_mov_b64 exec, 1
    buffer_store_dword v2, off, s[56:59], s90 sc1
    s_mov_b64 exec, -1
L_66:
    buffer_load_dwordx4 v[116:119], v1, s[36:39], s72 offen offset:1792
    buffer_load_dwordx4 v[124:127], v1, s[36:39], s72 offen offset:2688
    s_add_u32 s72, s72, 14336
    buffer_load_dwordx4 v[132:135], v1, s[36:39], s72 offen offset:0
    s_waitcnt vmcnt(10)
    buffer_load_dwordx4 v[140:143], v1, s[36:39], s72 offen offset:896
    v_dot2_f32_bf16 v16, v68, s73, 0
    v_dot2_f32_bf16 v20, v68, v68, 0
    v_lshlrev_b32 v64, 16, v68
    v_and_b32 v65, s74, v68
    v_dot2_f32_bf16 v16, v69, s73, v16
    v_dot2_f32_bf16 v20, v69, v69, v20
    v_lshlrev_b32 v66, 16, v69
    v_and_b32 v67, s74, v69
    v_dot2_f32_bf16 v16, v70, s73, v16
    v_dot2_f32_bf16 v20, v70, v70, v20
    v_lshlrev_b32 v68, 16, v70
    v_and_b32 v69, s74, v70
    v_dot2_f32_bf16 v16, v71, s73, v16
    v_dot2_f32_bf16 v20, v71, v71, v20
    v_lshlrev_b32 v70, 16, v71
    v_and_b32 v71, s74, v71
    s_waitcnt vmcnt(10)
    buffer_load_dwordx4 v[148:151], v1, s[36:39], s72 offen offset:1792
    v_dot2_f32_bf16 v17, v76, s73, 0
    v_dot2_f32_bf16 v21, v76, v76, 0
    v_lshlrev_b32 v72, 16, v76
    v_and_b32 v73, s74, v76
    v_dot2_f32_bf16 v17, v77, s73, v17
    v_dot2_f32_bf16 v21, v77, v77, v21
    v_lshlrev_b32 v74, 16, v77
    v_and_b32 v75, s74, v77
    v_dot2_f32_bf16 v17, v78, s73, v17
    v_dot2_f32_bf16 v21, v78, v78, v21
    v_lshlrev_b32 v76, 16, v78
    v_and_b32 v77, s74, v78
    v_dot2_f32_bf16 v17, v79, s73, v17
    v_dot2_f32_bf16 v21, v79, v79, v21
    v_lshlrev_b32 v78, 16, v79
    v_and_b32 v79, s74, v79
    s_waitcnt vmcnt(10)
    buffer_load_dwordx4 v[156:159], v1, s[36:39], s72 offen offset:2688
    v_dot2_f32_bf16 v18, v84, s73, 0
    v_dot2_f32_bf16 v22, v84, v84, 0
    v_lshlrev_b32 v80, 16, v84
    v_and_b32 v81, s74, v84
    v_dot2_f32_bf16 v18, v85, s73, v18
    v_dot2_f32_bf16 v22, v85, v85, v22
    v_lshlrev_b32 v82, 16, v85
    v_and_b32 v83, s74, v85
    v_dot2_f32_bf16 v18, v86, s73, v18
    v_dot2_f32_bf16 v22, v86, v86, v22
    v_lshlrev_b32 v84, 16, v86
    v_and_b32 v85, s74, v86
    v_dot2_f32_bf16 v18, v87, s73, v18
    v_dot2_f32_bf16 v22, v87, v87, v22
    v_lshlrev_b32 v86, 16, v87
    v_and_b32 v87, s74, v87
    s_waitcnt vmcnt(10)
    s_add_u32 s72, s72, 14336
    buffer_load_dwordx4 v[164:167], v1, s[36:39], s72 offen offset:0
    v_dot2_f32_bf16 v19, v92, s73, 0
    v_dot2_f32_bf16 v23, v92, v92, 0
    v_lshlrev_b32 v88, 16, v92
    v_and_b32 v89, s74, v92
    v_dot2_f32_bf16 v19, v93, s73, v19
    v_dot2_f32_bf16 v23, v93, v93, v23
    v_lshlrev_b32 v90, 16, v93
    v_and_b32 v91, s74, v93
    v_dot2_f32_bf16 v19, v94, s73, v19
    v_dot2_f32_bf16 v23, v94, v94, v23
    v_lshlrev_b32 v92, 16, v94
    v_and_b32 v93, s74, v94
    v_dot2_f32_bf16 v19, v95, s73, v19
    v_dot2_f32_bf16 v23, v95, v95, v23
    v_lshlrev_b32 v94, 16, v95
    v_and_b32 v95, s74, v95
    v_permlane32_swap_b32 v16, v18
    v_permlane32_swap_b32 v20, v22
    v_permlane32_swap_b32 v17, v19
    v_permlane32_swap_b32 v21, v23
    v_add_f32 v16, v16, v18
    v_add_f32 v17, v17, v19
    v_add_f32 v20, v20, v22
    v_add_f32 v21, v21, v23
    v_permlane16_swap_b32 v16, v17
    s_nop 0
    v_permlane16_swap_b32 v20, v21
    v_add_f32 v16, v16, v17
    v_add_f32 v20, v20, v21
    s_nop 0
    v_add_f32_dpp v16, v16, v16 row_ror:8 row_mask:0xf bank_mask:0xf
    v_add_f32_dpp v20, v20, v20 row_ror:8 row_mask:0xf bank_mask:0xf
    s_nop 0
    v_add_f32_dpp v16, v16, v16 row_ror:4 row_mask:0xf bank_mask:0xf
    v_add_f32_dpp v20, v20, v20 row_ror:4 row_mask:0xf bank_mask:0xf
    s_nop 0
    v_add_f32_dpp v16, v16, v16 row_ror:2 row_mask:0xf bank_mask:0xf
    v_add_f32_dpp v20, v20, v20 row_ror:2 row_mask:0xf bank_mask:0xf
    s_nop 0
    v_add_f32_dpp v16, v16, v16 row_ror:1 row_mask:0xf bank_mask:0xf
    v_add_f32_dpp v20, v20, v20 row_ror:1 row_mask:0xf bank_mask:0xf
    v_mul_f32 v16, 0x3b124925, v16
    v_mul_f32 v20, 0x3b124925, v20
    v_fma_f32 v20, -v16, v16, v20
    v_max_f32 v20, 0, v20
    v_add_f32 v20, 0x3727c5ac, v20
    v_rsq_f32 v20, v20
    s_nop 0
    v_mul_f32 v16, -v16, v20
    v_readlane_b32 s76, v20, 0
    v_readlane_b32 s78, v20, 16
    v_readlane_b32 s80, v20, 32
    v_readlane_b32 s82, v20, 48
    v_readlane_b32 s77, v16, 0
    v_readlane_b32 s79, v16, 16
    v_readlane_b32 s81, v16, 32
    v_readlane_b32 s83, v16, 48
    v_pk_fma_f32 v[64:65], v[64:65], s[76:77], s[76:77] op_sel:[0,0,1] op_sel_hi:[1,0,1]
    v_pk_fma_f32 v[66:67], v[66:67], s[76:77], s[76:77] op_sel:[0,0,1] op_sel_hi:[1,0,1]
    v_pk_fma_f32 v[68:69], v[68:69], s[76:77], s[76:77] op_sel:[0,0,1] op_sel_hi:[1,0,1]
    v_pk_fma_f32 v[70:71], v[70:71], s[76:77], s[76:77] op_sel:[0,0,1] op_sel_hi:[1,0,1]
    v_pk_fma_f32 v[72:73], v[72:73], s[78:79], s[78:79] op_sel:[0,0,1] op_sel_hi:[1,0,1]
    v_pk_fma_f32 v[74:75], v[74:75], s[78:79], s[78:79] op_sel:[0,0,1] op_sel_hi:[1,0,1]
    v_pk_fma_f32 v[76:77], v[76:77], s[78:79], s[78:79] op_sel:[0,0,1] op_sel_hi:[1,0,1]
    v_pk_fma_f32 v[78:79], v[78:79], s[78:79], s[78:79] op_sel:[0,0,1] op_sel_hi:[1,0,1]
    v_pk_fma_f32 v[80:81], v[80:81], s[80:81], s[80:81] op_sel:[0,0,1] op_sel_hi:[1,0,1]
    v_pk_fma_f32 v[82:83], v[82:83], s[80:81], s[80:81] op_sel:[0,0,1] op_sel_hi:[1,0,1]
    v_pk_fma_f32 v[84:85], v[84:85], s[80:81], s[80:81] op_sel:[0,0,1] op_sel_hi:[1,0,1]
    v_pk_fma_f32 v[86:87], v[86:87], s[80:81], s[80:81] op_sel:[0,0,1] op_sel_hi:[1,0,1]
    v_pk_fma_f32 v[88:89], v[88:89], s[82:83], s[82:83] op_sel:[0,0,1] op_sel_hi:[1,0,1]
    v_pk_fma_f32 v[90:91], v[90:91], s[82:83], s[82:83] op_sel:[0,0,1] op_sel_hi:[1,0,1]
    v_pk_fma_f32 v[92:93], v[92:93], s[82:83], s[82:83] op_sel:[0,0,1] op_sel_hi:[1,0,1]
    v_pk_fma_f32 v[94:95], v[94:95], s[82:83], s[82:83] op_sel:[0,0,1] op_sel_hi:[1,0,1]
    s_waitcnt vmcnt(10)
    buffer_load_dwordx4 v[172:175], v1, s[36:39], s72 offen offset:896
    v_dot2_f32_bf16 v16, v100, s73, 0
    v_dot2_f32_bf16 v20, v100, v100, 0
    v_lshlrev_b32 v96, 16, v100
    v_and_b32 v97, s74, v100
    v_dot2_f32_bf16 v16, v101, s73, v16
    v_dot2_f32_bf16 v20, v101, v101, v20
    v_lshlrev_b32 v98, 16, v101
    v_and_b32 v99, s74, v101
    v_dot2_f32_bf16 v16, v102, s73, v16
    v_dot2_f32_bf16 v20, v102, v102, v20
    v_lshlrev_b32 v100, 16, v102
    v_and_b32 v101, s74, v102
    v_dot2_f32_bf16 v16, v103, s73, v16
    v_dot2_f32_bf16 v20, v103, v103, v20
    v_lshlrev_b32 v102, 16, v103
    v_and_b32 v103, s74, v103
    s_waitcnt vmcnt(10)
    buffer_load_dwordx4 v[180:183], v1, s[36:39], s72 offen offset:1792
    v_dot2_f32_bf16 v17, v108, s73, 0
    v_dot2_f32_bf16 v21, v108, v108, 0
    v_lshlrev_b32 v104, 16, v108
    v_and_b32 v105, s74, v108
    v_dot2_f32_bf16 v17, v109, s73, v17
    v_dot2_f32_bf16 v21, v109, v109, v21
    v_lshlrev_b32 v106, 16, v109
    v_and_b32 v107, s74, v109
    v_dot2_f32_bf16 v17, v110, s73, v17
    v_dot2_f32_bf16 v21, v110, v110, v21
    v_lshlrev_b32 v108, 16, v110
    v_and_b32 v109, s74, v110
    v_dot2_f32_bf16 v17, v111, s73, v17
    v_dot2_f32_bf16 v21, v111, v111, v21
    v_lshlrev_b32 v110, 16, v111
    v_and_b32 v111, s74, v111
    s_waitcnt vmcnt(8)
    buffer_load_dwordx4 v[188:191], v1, s[36:39], s72 offen offset:2688
    v_dot2_f32_bf16 v18, v116, s73, 0
    v_dot2_f32_bf16 v22, v116, v116, 0
    v_lshlrev_b32 v112, 16, v116
    v_and_b32 v113, s74, v116
    v_dot2_f32_bf16 v18, v117, s73, v18
    v_dot2_f32_bf16 v22, v117, v117, v22
    v_lshlrev_b32 v114, 16, v117
    v_and_b32 v115, s74, v117
    v_dot2_f32_bf16 v18, v118, s73, v18
    v_dot2_f32_bf16 v22, v118, v118, v22
    v_lshlrev_b32 v116, 16, v118
    v_and_b32 v117, s74, v118
    v_dot2_f32_bf16 v18, v119, s73, v18
    v_dot2_f32_bf16 v22, v119, v119, v22
    v_lshlrev_b32 v118, 16, v119
    v_and_b32 v119, s74, v119
    s_waitcnt vmcnt(8)
    s_sub_u32 s72, s68, 14336
    s_max_i32 s72, s72, 0
    s_add_u32 s72, s72, s88
    buffer_load_dwordx4 v[196:199], v1, s[36:39], s72 offen offset:0
    v_dot2_f32_bf16 v19, v124, s73, 0
    v_dot2_f32_bf16 v23, v124, v124, 0
    v_lshlrev_b32 v120, 16, v124
    v_and_b32 v121, s74, v124
    v_dot2_f32_bf16 v19, v125, s73, v19
    v_dot2_f32_bf16 v23, v125, v125, v23
    v_lshlrev_b32 v122, 16, v125
    v_and_b32 v123, s74, v125
    v_dot2_f32_bf16 v19, v126, s73, v19
    v_dot2_f32_bf16 v23, v126, v126, v23
    v_lshlrev_b32 v124, 16, v126
    v_and_b32 v125, s74, v126
    v_dot2_f32_bf16 v19, v127, s73, v19
    v_dot2_f32_bf16 v23, v127, v127, v23
    v_lshlrev_b32 v126, 16, v127
    v_and_b32 v127, s74, v127
    v_permlane32_swap_b32 v16, v18
    v_permlane32_swap_b32 v20, v22
    v_permlane32_swap_b32 v17, v19
    v_permlane32_swap_b32 v21, v23
    v_add_f32 v16, v16, v18
    v_add_f32 v17, v17, v19
    v_add_f32 v20, v20, v22
    v_add_f32 v21, v21, v23
    v_permlane16_swap_b32 v16, v17
    s_nop 0
    v_permlane16_swap_b32 v20, v21
    v_add_f32 v16, v16, v17
    v_add_f32 v20, v20, v21
    s_nop 0
    v_add_f32_dpp v16, v16, v16 row_ror:8 row_mask:0xf bank_mask:0xf
    v_add_f32_dpp v20, v20, v20 row_ror:8 row_mask:0xf bank_mask:0xf
    s_nop 0
    v_add_f32_dpp v16, v16, v16 row_ror:4 row_mask:0xf bank_mask:0xf
    v_add_f32_dpp v20, v20, v20 row_ror:4 row_mask:0xf bank_mask:0xf
    s_nop 0
    v_add_f32_dpp v16, v16, v16 row_ror:2 row_mask:0xf bank_mask:0xf
    v_add_f32_dpp v20, v20, v20 row_ror:2 row_mask:0xf bank_mask:0xf
    s_nop 0
    v_add_f32_dpp v16, v16, v16 row_ror:1 row_mask:0xf bank_mask:0xf
    v_add_f32_dpp v20, v20, v20 row_ror:1 row_mask:0xf bank_mask:0xf
    v_mul_f32 v16, 0x3b124925, v16
    v_mul_f32 v20, 0x3b124925, v20
    v_fma_f32 v20, -v16, v16, v20
    v_max_f32 v20, 0, v20
    v_add_f32 v20, 0x3727c5ac, v20
    v_rsq_f32 v20, v20
    s_nop 0
    v_mul_f32 v16, -v16, v20
    v_readlane_b32 s76, v20, 0
    v_readlane_b32 s78, v20, 16
    v_readlane_b32 s80, v20, 32
    v_readlane_b32 s82, v20, 48
    v_readlane_b32 s77, v16, 0
    v_readlane_b32 s79, v16, 16
    v_readlane_b32 s81, v16, 32
    v_readlane_b32 s83, v16, 48
    v_pk_fma_f32 v[96:97], v[96:97], s[76:77], s[76:77] op_sel:[0,0,1] op_sel_hi:[1,0,1]
    v_pk_fma_f32 v[98:99], v[98:99], s[76:77], s[76:77] op_sel:[0,0,1] op_sel_hi:[1,0,1]
    v_pk_fma_f32 v[100:101], v[100:101], s[76:77], s[76:77] op_sel:[0,0,1] op_sel_hi:[1,0,1]
    v_pk_fma_f32 v[102:103], v[102:103], s[76:77], s[76:77] op_sel:[0,0,1] op_sel_hi:[1,0,1]
    v_pk_fma_f32 v[104:105], v[104:105], s[78:79], s[78:79] op_sel:[0,0,1] op_sel_hi:[1,0,1]
    v_pk_fma_f32 v[106:107], v[106:107], s[78:79], s[78:79] op_sel:[0,0,1] op_sel_hi:[1,0,1]
    v_pk_fma_f32 v[108:109], v[108:109], s[78:79], s[78:79] op_sel:[0,0,1] op_sel_hi:[1,0,1]
    v_pk_fma_f32 v[110:111], v[110:111], s[78:79], s[78:79] op_sel:[0,0,1] op_sel_hi:[1,0,1]
    v_pk_fma_f32 v[112:113], v[112:113], s[80:81], s[80:81] op_sel:[0,0,1] op_sel_hi:[1,0,1]
    v_pk_fma_f32 v[114:115], v[114:115], s[80:81], s[80:81] op_sel:[0,0,1] op_sel_hi:[1,0,1]
    v_pk_fma_f32 v[116:117], v[116:117], s[80:81], s[80:81] op_sel:[0,0,1] op_sel_hi:[1,0,1]
    v_pk_fma_f32 v[118:119], v[118:119], s[80:81], s[80:81] op_sel:[0,0,1] op_sel_hi:[1,0,1]
    v_pk_fma_f32 v[120:121], v[120:121], s[82:83], s[82:83] op_sel:[0,0,1] op_sel_hi:[1,0,1]
    v_pk_fma_f32 v[122:123], v[122:123], s[82:83], s[82:83] op_sel:[0,0,1] op_sel_hi:[1,0,1]
    v_pk_fma_f32 v[124:125], v[124:125], s[82:83], s[82:83] op_sel:[0,0,1] op_sel_hi:[1,0,1]
    v_pk_fma_f32 v[126:127], v[126:127], s[82:83], s[82:83] op_sel:[0,0,1] op_sel_hi:[1,0,1]
    s_waitcnt vmcnt(8)
    buffer_load_dwordx4 v[204:207], v1, s[36:39], s72 offen offset:896
    v_dot2_f32_bf16 v16, v132, s73, 0
    v_dot2_f32_bf16 v20, v132, v132, 0
    v_lshlrev_b32 v128, 16, v132
    v_and_b32 v129, s74, v132
    v_dot2_f32_bf16 v16, v133, s73, v16
    v_dot2_f32_bf16 v20, v133, v133, v20
    v_lshlrev_b32 v130, 16, v133
    v_and_b32 v131, s74, v133
    v_dot2_f32_bf16 v16, v134, s73, v16
    v_dot2_f32_bf16 v20, v134, v134, v20
    v_lshlrev_b32 v132, 16, v134
    v_and_b32 v133, s74, v134
    v_dot2_f32_bf16 v16, v135, s73, v16
    v_dot2_f32_bf16 v20, v135, v135, v20
    v_lshlrev_b32 v134, 16, v135
    v_and_b32 v135, s74, v135
    s_waitcnt vmcnt(8)
    buffer_load_dwordx4 v[212:215], v1, s[36:39], s72 offen offset:1792
    v_dot2_f32_bf16 v17, v140, s73, 0
    v_dot2_f32_bf16 v21, v140, v140, 0
    v_lshlrev_b32 v136, 16, v140
    v_and_b32 v137, s74, v140
    v_dot2_f32_bf16 v17, v141, s73, v17
    v_dot2_f32_bf16 v21, v141, v141, v21
    v_lshlrev_b32 v138, 16, v141
    v_and_b32 v139, s74, v141
    v_dot2_f32_bf16 v17, v142, s73, v17
    v_dot2_f32_bf16 v21, v142, v142, v21
    v_lshlrev_b32 v140, 16, v142
    v_and_b32 v141, s74, v142
    v_dot2_f32_bf16 v17, v143, s73, v17
    v_dot2_f32_bf16 v21, v143, v143, v21
    v_lshlrev_b32 v142, 16, v143
    v_and_b32 v143, s74, v143
    s_waitcnt vmcnt(8)
    buffer_load_dwordx4 v[220:223], v1, s[36:39], s72 offen offset:2688
    s_setprio 1
    v_dot2_f32_bf16 v18, v148, s73, 0
    v_dot2_f32_bf16 v22, v148, v148, 0
    v_lshlrev_b32 v144, 16, v148
    v_and_b32 v145, s74, v148
    v_dot2_f32_bf16 v18, v149, s73, v18
    v_dot2_f32_bf16 v22, v149, v149, v22
    v_lshlrev_b32 v146, 16, v149
    v_and_b32 v147, s74, v149
    v_dot2_f32_bf16 v18, v150, s73, v18
    v_dot2_f32_bf16 v22, v150, v150, v22
    v_lshlrev_b32 v148, 16, v150
    v_and_b32 v149, s74, v150
    v_dot2_f32_bf16 v18, v151, s73, v18
    v_dot2_f32_bf16 v22, v151, v151, v22
    v_lshlrev_b32 v150, 16, v151
    v_and_b32 v151, s74, v151
    s_waitcnt vmcnt(8)
    v_dot2_f32_bf16 v19, v156, s73, 0
    v_dot2_f32_bf16 v23, v156, v156, 0
    v_lshlrev_b32 v152, 16, v156
    v_and_b32 v153, s74, v156
    v_dot2_f32_bf16 v19, v157, s73, v19
    v_dot2_f32_bf16 v23, v157, v157, v23
    v_lshlrev_b32 v154, 16, v157
    v_and_b32 v155, s74, v157
    v_dot2_f32_bf16 v19, v158, s73, v19
    v_dot2_f32_bf16 v23, v158, v158, v23
    v_lshlrev_b32 v156, 16, v158
    v_and_b32 v157, s74, v158
    v_dot2_f32_bf16 v19, v159, s73, v19
    v_dot2_f32_bf16 v23, v159, v159, v23
    v_lshlrev_b32 v158, 16, v159
    v_and_b32 v159, s74, v159
    v_permlane32_swap_b32 v16, v18
    v_permlane32_swap_b32 v20, v22
    v_permlane32_swap_b32 v17, v19
    v_permlane32_swap_b32 v21, v23
    v_add_f32 v16, v16, v18
    v_add_f32 v17, v17, v19
    v_add_f32 v20, v20, v22
    v_add_f32 v21, v21, v23
    v_permlane16_swap_b32 v16, v17
    s_nop 0
    v_permlane16_swap_b32 v20, v21
    v_add_f32 v16, v16, v17
    v_add_f32 v20, v20, v21
    s_nop 0
    v_add_f32_dpp v16, v16, v16 row_ror:8 row_mask:0xf bank_mask:0xf
    v_add_f32_dpp v20, v20, v20 row_ror:8 row_mask:0xf bank_mask:0xf
    s_nop 0
    v_add_f32_dpp v16, v16, v16 row_ror:4 row_mask:0xf bank_mask:0xf
    v_add_f32_dpp v20, v20, v20 row_ror:4 row_mask:0xf bank_mask:0xf
    s_nop 0
    v_add_f32_dpp v16, v16, v16 row_ror:2 row_mask:0xf bank_mask:0xf
    v_add_f32_dpp v20, v20, v20 row_ror:2 row_mask:0xf bank_mask:0xf
    s_nop 0
    v_add_f32_dpp v16, v16, v16 row_ror:1 row_mask:0xf bank_mask:0xf
    v_add_f32_dpp v20, v20, v20 row_ror:1 row_mask:0xf bank_mask:0xf
    v_mul_f32 v16, 0x3b124925, v16
    v_mul_f32 v20, 0x3b124925, v20
    v_fma_f32 v20, -v16, v16, v20
    v_max_f32 v20, 0, v20
    v_add_f32 v20, 0x3727c5ac, v20
    v_rsq_f32 v20, v20
    s_nop 0
    v_mul_f32 v16, -v16, v20
    v_readlane_b32 s76, v20, 0
    v_readlane_b32 s78, v20, 16
    v_readlane_b32 s80, v20, 32
    v_readlane_b32 s82, v20, 48
    v_readlane_b32 s77, v16, 0
    v_readlane_b32 s79, v16, 16
    v_readlane_b32 s81, v16, 32
    v_readlane_b32 s83, v16, 48
    v_pk_fma_f32 v[128:129], v[128:129], s[76:77], s[76:77] op_sel:[0,0,1] op_sel_hi:[1,0,1]
    v_pk_fma_f32 v[130:131], v[130:131], s[76:77], s[76:77] op_sel:[0,0,1] op_sel_hi:[1,0,1]
    v_pk_fma_f32 v[132:133], v[132:133], s[76:77], s[76:77] op_sel:[0,0,1] op_sel_hi:[1,0,1]
    v_pk_fma_f32 v[134:135], v[134:135], s[76:77], s[76:77] op_sel:[0,0,1] op_sel_hi:[1,0,1]
    v_pk_fma_f32 v[136:137], v[136:137], s[78:79], s[78:79] op_sel:[0,0,1] op_sel_hi:[1,0,1]
    v_pk_fma_f32 v[138:139], v[138:139], s[78:79], s[78:79] op_sel:[0,0,1] op_sel_hi:[1,0,1]
    v_pk_fma_f32 v[140:141], v[140:141], s[78:79], s[78:79] op_sel:[0,0,1] op_sel_hi:[1,0,1]
    v_pk_fma_f32 v[142:143], v[142:143], s[78:79], s[78:79] op_sel:[0,0,1] op_sel_hi:[1,0,1]
    v_pk_fma_f32 v[144:145], v[144:145], s[80:81], s[80:81] op_sel:[0,0,1] op_sel_hi:[1,0,1]
    v_pk_fma_f32 v[146:147], v[146:147], s[80:81], s[80:81] op_sel:[0,0,1] op_sel_hi:[1,0,1]
    v_pk_fma_f32 v[148:149], v[148:149], s[80:81], s[80:81] op_sel:[0,0,1] op_sel_hi:[1,0,1]
    v_pk_fma_f32 v[150:151], v[150:151], s[80:81], s[80:81] op_sel:[0,0,1] op_sel_hi:[1,0,1]
    v_pk_fma_f32 v[152:153], v[152:153], s[82:83], s[82:83] op_sel:[0,0,1] op_sel_hi:[1,0,1]
    v_pk_fma_f32 v[154:155], v[154:155], s[82:83], s[82:83] op_sel:[0,0,1] op_sel_hi:[1,0,1]
    v_pk_fma_f32 v[156:157], v[156:157], s[82:83], s[82:83] op_sel:[0,0,1] op_sel_hi:[1,0,1]
    v_pk_fma_f32 v[158:159], v[158:159], s[82:83], s[82:83] op_sel:[0,0,1] op_sel_hi:[1,0,1]
    s_waitcnt vmcnt(7)
    v_dot2_f32_bf16 v16, v164, s73, 0
    v_dot2_f32_bf16 v20, v164, v164, 0
    v_lshlrev_b32 v160, 16, v164
    v_and_b32 v161, s74, v164
    v_dot2_f32_bf16 v16, v165, s73, v16
    v_dot2_f32_bf16 v20, v165, v165, v20
    v_lshlrev_b32 v162, 16, v165
    v_and_b32 v163, s74, v165
    v_dot2_f32_bf16 v16, v166, s73, v16
    v_dot2_f32_bf16 v20, v166, v166, v20
    v_lshlrev_b32 v164, 16, v166
    v_and_b32 v165, s74, v166
    v_dot2_f32_bf16 v16, v167, s73, v16
    v_dot2_f32_bf16 v20, v167, v167, v20
    v_lshlrev_b32 v166, 16, v167
    v_and_b32 v167, s74, v167
    s_waitcnt vmcnt(6)
    v_dot2_f32_bf16 v17, v172, s73, 0
    v_dot2_f32_bf16 v21, v172, v172, 0
    v_lshlrev_b32 v168, 16, v172
    v_and_b32 v169, s74, v172
    v_dot2_f32_bf16 v17, v173, s73, v17
    v_dot2_f32_bf16 v21, v173, v173, v21
    v_lshlrev_b32 v170, 16, v173
    v_and_b32 v171, s74, v173
    v_dot2_f32_bf16 v17, v174, s73, v17
    v_dot2_f32_bf16 v21, v174, v174, v21
    v_lshlrev_b32 v172, 16, v174
    v_and_b32 v173, s74, v174
    v_dot2_f32_bf16 v17, v175, s73, v17
    v_dot2_f32_bf16 v21, v175, v175, v21
    v_lshlrev_b32 v174, 16, v175
    v_and_b32 v175, s74, v175
    s_waitcnt vmcnt(5)
    v_dot2_f32_bf16 v18, v180, s73, 0
    v_dot2_f32_bf16 v22, v180, v180, 0
    v_lshlrev_b32 v176, 16, v180
    v_and_b32 v177, s74, v180
    v_dot2_f32_bf16 v18, v181, s73, v18
    v_dot2_f32_bf16 v22, v181, v181, v22
    v_lshlrev_b32 v178, 16, v181
    v_and_b32 v179, s74, v181
    v_dot2_f32_bf16 v18, v182, s73, v18
    v_dot2_f32_bf16 v22, v182, v182, v22
    v_lshlrev_b32 v180, 16, v182
    v_and_b32 v181, s74, v182
    v_dot2_f32_bf16 v18, v183, s73, v18
    v_dot2_f32_bf16 v22, v183, v183, v22
    v_lshlrev_b32 v182, 16, v183
    v_and_b32 v183, s74, v183
    s_waitcnt vmcnt(4)
    v_dot2_f32_bf16 v19, v188, s73, 0
    v_dot2_f32_bf16 v23, v188, v188, 0
    v_lshlrev_b32 v184, 16, v188
    v_and_b32 v185, s74, v188
    v_dot2_f32_bf16 v19, v189, s73, v19
    v_dot2_f32_bf16 v23, v189, v189, v23
    v_lshlrev_b32 v186, 16, v189
    v_and_b32 v187, s74, v189
    v_dot2_f32_bf16 v19, v190, s73, v19
    v_dot2_f32_bf16 v23, v190, v190, v23
    v_lshlrev_b32 v188, 16, v190
    v_and_b32 v189, s74, v190
    v_dot2_f32_bf16 v19, v191, s73, v19
    v_dot2_f32_bf16 v23, v191, v191, v23
    v_lshlrev_b32 v190, 16, v191
    v_and_b32 v191, s74, v191
    v_permlane32_swap_b32 v16, v18
    v_permlane32_swap_b32 v20, v22
    v_permlane32_swap_b32 v17, v19
    v_permlane32_swap_b32 v21, v23
    v_add_f32 v16, v16, v18
    v_add_f32 v17, v17, v19
    v_add_f32 v20, v20, v22
    v_add_f32 v21, v21, v23
    v_permlane16_swap_b32 v16, v17
    s_nop 0
    v_permlane16_swap_b32 v20, v21
    v_add_f32 v16, v16, v17
    v_add_f32 v20, v20, v21
    s_nop 0
    v_add_f32_dpp v16, v16, v16 row_ror:8 row_mask:0xf bank_mask:0xf
    v_add_f32_dpp v20, v20, v20 row_ror:8 row_mask:0xf bank_mask:0xf
    s_nop 0
    v_add_f32_dpp v16, v16, v16 row_ror:4 row_mask:0xf bank_mask:0xf
    v_add_f32_dpp v20, v20, v20 row_ror:4 row_mask:0xf bank_mask:0xf
    s_nop 0
    v_add_f32_dpp v16, v16, v16 row_ror:2 row_mask:0xf bank_mask:0xf
    v_add_f32_dpp v20, v20, v20 row_ror:2 row_mask:0xf bank_mask:0xf
    s_nop 0
    v_add_f32_dpp v16, v16, v16 row_ror:1 row_mask:0xf bank_mask:0xf
    v_add_f32_dpp v20, v20, v20 row_ror:1 row_mask:0xf bank_mask:0xf
    v_mul_f32 v16, 0x3b124925, v16
    v_mul_f32 v20, 0x3b124925, v20
    v_fma_f32 v20, -v16, v16, v20
    v_max_f32 v20, 0, v20
    v_add_f32 v20, 0x3727c5ac, v20
    v_rsq_f32 v20, v20
    s_nop 0
    v_mul_f32 v16, -v16, v20
    v_readlane_b32 s76, v20, 0
    v_readlane_b32 s78, v20, 16
    v_readlane_b32 s80, v20, 32
    v_readlane_b32 s82, v20, 48
    v_readlane_b32 s77, v16, 0
    v_readlane_b32 s79, v16, 16
    v_readlane_b32 s81, v16, 32
    v_readlane_b32 s83, v16, 48
    v_pk_fma_f32 v[160:161], v[160:161], s[76:77], s[76:77] op_sel:[0,0,1] op_sel_hi:[1,0,1]
    v_pk_fma_f32 v[162:163], v[162:163], s[76:77], s[76:77] op_sel:[0,0,1] op_sel_hi:[1,0,1]
    v_pk_fma_f32 v[164:165], v[164:165], s[76:77], s[76:77] op_sel:[0,0,1] op_sel_hi:[1,0,1]
    v_pk_fma_f32 v[166:167], v[166:167], s[76:77], s[76:77] op_sel:[0,0,1] op_sel_hi:[1,0,1]
    v_pk_fma_f32 v[168:169], v[168:169], s[78:79], s[78:79] op_sel:[0,0,1] op_sel_hi:[1,0,1]
    v_pk_fma_f32 v[170:171], v[170:171], s[78:79], s[78:79] op_sel:[0,0,1] op_sel_hi:[1,0,1]
    v_pk_fma_f32 v[172:173], v[172:173], s[78:79], s[78:79] op_sel:[0,0,1] op_sel_hi:[1,0,1]
    v_pk_fma_f32 v[174:175], v[174:175], s[78:79], s[78:79] op_sel:[0,0,1] op_sel_hi:[1,0,1]
    v_pk_fma_f32 v[176:177], v[176:177], s[80:81], s[80:81] op_sel:[0,0,1] op_sel_hi:[1,0,1]
    v_pk_fma_f32 v[178:179], v[178:179], s[80:81], s[80:81] op_sel:[0,0,1] op_sel_hi:[1,0,1]
    v_pk_fma_f32 v[180:181], v[180:181], s[80:81], s[80:81] op_sel:[0,0,1] op_sel_hi:[1,0,1]
    v_pk_fma_f32 v[182:183], v[182:183], s[80:81], s[80:81] op_sel:[0,0,1] op_sel_hi:[1,0,1]
    v_pk_fma_f32 v[184:185], v[184:185], s[82:83], s[82:83] op_sel:[0,0,1] op_sel_hi:[1,0,1]
    v_pk_fma_f32 v[186:187], v[186:187], s[82:83], s[82:83] op_sel:[0,0,1] op_sel_hi:[1,0,1]
    v_pk_fma_f32 v[188:189], v[188:189], s[82:83], s[82:83] op_sel:[0,0,1] op_sel_hi:[1,0,1]
    v_pk_fma_f32 v[190:191], v[190:191], s[82:83], s[82:83] op_sel:[0,0,1] op_sel_hi:[1,0,1]
    s_waitcnt vmcnt(3)
    v_dot2_f32_bf16 v16, v196, s73, 0
    v_dot2_f32_bf16 v20, v196, v196, 0
    v_lshlrev_b32 v192, 16, v196
    v_and_b32 v193, s74, v196
    v_dot2_f32_bf16 v16, v197, s73, v16
    v_dot2_f32_bf16 v20, v197, v197, v20
    v_lshlrev_b32 v194, 16, v197
    v_and_b32 v195, s74, v197
    v_dot2_f32_bf16 v16, v198, s73, v16
    v_dot2_f32_bf16 v20, v198, v198, v20
    v_lshlrev_b32 v196, 16, v198
    v_and_b32 v197, s74, v198
    v_dot2_f32_bf16 v16, v199, s73, v16
    v_dot2_f32_bf16 v20, v199, v199, v20
    v_lshlrev_b32 v198, 16, v199
    v_and_b32 v199, s74, v199
    s_waitcnt vmcnt(2)
    v_dot2_f32_bf16 v17, v204, s73, 0
    v_dot2_f32_bf16 v21, v204, v204, 0
    v_lshlrev_b32 v200, 16, v204
    v_and_b32 v201, s74, v204
    v_dot2_f32_bf16 v17, v205, s73, v17
    v_dot2_f32_bf16 v21, v205, v205, v21
    v_lshlrev_b32 v202, 16, v205
    v_and_b32 v203, s74, v205
    v_dot2_f32_bf16 v17, v206, s73, v17
    v_dot2_f32_bf16 v21, v206, v206, v21
    v_lshlrev_b32 v204, 16, v206
    v_and_b32 v205, s74, v206
    v_dot2_f32_bf16 v17, v207, s73, v17
    v_dot2_f32_bf16 v21, v207, v207, v21
    v_lshlrev_b32 v206, 16, v207
    v_and_b32 v207, s74, v207
    s_waitcnt vmcnt(1)
    v_dot2_f32_bf16 v18, v212, s73, 0
    v_dot2_f32_bf16 v22, v212, v212, 0
    v_lshlrev_b32 v208, 16, v212
    v_and_b32 v209, s74, v212
    v_dot2_f32_bf16 v18, v213, s73, v18
    v_dot2_f32_bf16 v22, v213, v213, v22
    v_lshlrev_b32 v210, 16, v213
    v_and_b32 v211, s74, v213
    v_dot2_f32_bf16 v18, v214, s73, v18
    v_dot2_f32_bf16 v22, v214, v214, v22
    v_lshlrev_b32 v212, 16, v214
    v_and_b32 v213, s74, v214
    v_dot2_f32_bf16 v18, v215, s73, v18
    v_dot2_f32_bf16 v22, v215, v215, v22
    v_lshlrev_b32 v214, 16, v215
    v_and_b32 v215, s74, v215
    s_waitcnt vmcnt(0)
    v_dot2_f32_bf16 v19, v220, s73, 0
    v_dot2_f32_bf16 v23, v220, v220, 0
    v_lshlrev_b32 v216, 16, v220
    v_and_b32 v217, s74, v220
    v_dot2_f32_bf16 v19, v221, s73, v19
    v_dot2_f32_bf16 v23, v221, v221, v23
    v_lshlrev_b32 v218, 16, v221
    v_and_b32 v219, s74, v221
    v_dot2_f32_bf16 v19, v222, s73, v19
    v_dot2_f32_bf16 v23, v222, v222, v23
    v_lshlrev_b32 v220, 16, v222
    v_and_b32 v221, s74, v222
    v_dot2_f32_bf16 v19, v223, s73, v19
    v_dot2_f32_bf16 v23, v223, v223, v23
    v_lshlrev_b32 v222, 16, v223
    v_and_b32 v223, s74, v223
    v_permlane32_swap_b32 v16, v18
    v_permlane32_swap_b32 v20, v22
    v_permlane32_swap_b32 v17, v19
    v_permlane32_swap_b32 v21, v23
    v_add_f32 v16, v16, v18
    v_add_f32 v17, v17, v19
    v_add_f32 v20, v20, v22
    v_add_f32 v21, v21, v23
    v_permlane16_swap_b32 v16, v17
    s_nop 0
    v_permlane16_swap_b32 v20, v21
    v_add_f32 v16, v16, v17
    v_add_f32 v20, v20, v21
    s_nop 0
    v_add_f32_dpp v16, v16, v16 row_ror:8 row_mask:0xf bank_mask:0xf
    v_add_f32_dpp v20, v20, v20 row_ror:8 row_mask:0xf bank_mask:0xf
    s_nop 0
    v_add_f32_dpp v16, v16, v16 row_ror:4 row_mask:0xf bank_mask:0xf
    v_add_f32_dpp v20, v20, v20 row_ror:4 row_mask:0xf bank_mask:0xf
    s_nop 0
    v_add_f32_dpp v16, v16, v16 row_ror:2 row_mask:0xf bank_mask:0xf
    v_add_f32_dpp v20, v20, v20 row_ror:2 row_mask:0xf bank_mask:0xf
    s_nop 0
    v_add_f32_dpp v16, v16, v16 row_ror:1 row_mask:0xf bank_mask:0xf
    v_add_f32_dpp v20, v20, v20 row_ror:1 row_mask:0xf bank_mask:0xf
    v_mul_f32 v16, 0x3b124925, v16
    v_mul_f32 v20, 0x3b124925, v20
    v_fma_f32 v20, -v16, v16, v20
    v_max_f32 v20, 0, v20
    v_add_f32 v20, 0x3727c5ac, v20
    v_rsq_f32 v20, v20
    s_nop 0
    v_mul_f32 v16, -v16, v20
    v_readlane_b32 s76, v20, 0
    v_readlane_b32 s78, v20, 16
    v_readlane_b32 s80, v20, 32
    v_readlane_b32 s82, v20, 48
    v_readlane_b32 s77, v16, 0
    v_readlane_b32 s79, v16, 16
    v_readlane_b32 s81, v16, 32
    v_readlane_b32 s83, v16, 48
    v_pk_fma_f32 v[192:193], v[192:193], s[76:77], s[76:77] op_sel:[0,0,1] op_sel_hi:[1,0,1]
    v_pk_fma_f32 v[194:195], v[194:195], s[76:77], s[76:77] op_sel:[0,0,1] op_sel_hi:[1,0,1]
    v_pk_fma_f32 v[196:197], v[196:197], s[76:77], s[76:77] op_sel:[0,0,1] op_sel_hi:[1,0,1]
    v_pk_fma_f32 v[198:199], v[198:199], s[76:77], s[76:77] op_sel:[0,0,1] op_sel_hi:[1,0,1]
    v_pk_fma_f32 v[200:201], v[200:201], s[78:79], s[78:79] op_sel:[0,0,1] op_sel_hi:[1,0,1]
    v_pk_fma_f32 v[202:203], v[202:203], s[78:79], s[78:79] op_sel:[0,0,1] op_sel_hi:[1,0,1]
    v_pk_fma_f32 v[204:205], v[204:205], s[78:79], s[78:79] op_sel:[0,0,1] op_sel_hi:[1,0,1]
    v_pk_fma_f32 v[206:207], v[206:207], s[78:79], s[78:79] op_sel:[0,0,1] op_sel_hi:[1,0,1]
    v_pk_fma_f32 v[208:209], v[208:209], s[80:81], s[80:81] op_sel:[0,0,1] op_sel_hi:[1,0,1]
    v_pk_fma_f32 v[210:211], v[210:211], s[80:81], s[80:81] op_sel:[0,0,1] op_sel_hi:[1,0,1]
    v_pk_fma_f32 v[212:213], v[212:213], s[80:81], s[80:81] op_sel:[0,0,1] op_sel_hi:[1,0,1]
    v_pk_fma_f32 v[214:215], v[214:215], s[80:81], s[80:81] op_sel:[0,0,1] op_sel_hi:[1,0,1]
    v_pk_fma_f32 v[216:217], v[216:217], s[82:83], s[82:83] op_sel:[0,0,1] op_sel_hi:[1,0,1]
    v_pk_fma_f32 v[218:219], v[218:219], s[82:83], s[82:83] op_sel:[0,0,1] op_sel_hi:[1,0,1]
    v_pk_fma_f32 v[220:221], v[220:221], s[82:83], s[82:83] op_sel:[0,0,1] op_sel_hi:[1,0,1]
    v_pk_fma_f32 v[222:223], v[222:223], s[82:83], s[82:83] op_sel:[0,0,1] op_sel_hi:[1,0,1]
    v_and_b32 v2, 3, v0
    v_lshlrev_b32 v2, 2, v2
    v_add_u32 v2, 157856, v2
    s_setprio 0
    s_mov_b32 s95, 0x400000
L_67:
    ds_read_b32 v3, v2
    ds_read_b128 v[232:235], v243 offset:0
    ds_read_b128 v[236:239], v243 offset:1024
    ds_read_b128 v[224:227], v243 offset:2048
    ds_read_b128 v[228:231], v243 offset:3072
    s_waitcnt lgkmcnt(4)
    v_cmp_ne_u32 vcc, s6, v3
    s_cbranch_vccz L_68
    s_sub_u32 s95, s95, 1
    s_cbranch_scc0 L_67
L_68:
    s_setprio 2
    s_waitcnt lgkmcnt(0)
    v_pk_fma_f32 v[64:65], v[64:65], v[224:225], v[232:233]
    v_pk_fma_f32 v[66:67], v[66:67], v[226:227], v[234:235]
    v_pk_fma_f32 v[68:69], v[68:69], v[228:229], v[236:237]
    v_pk_fma_f32 v[70:71], v[70:71], v[230:231], v[238:239]
    v_cvt_pk_bf16_f32 v32, v64, v65
    v_cvt_pk_bf16_f32 v33, v66, v67
    v_cvt_pk_bf16_f32 v34, v68, v69
    v_cvt_pk_bf16_f32 v35, v70, v71
    ds_write_b128 v240, v[32:35] offset:14336
    v_pk_fma_f32 v[72:73], v[72:73], v[224:225], v[232:233]
    v_pk_fma_f32 v[74:75], v[74:75], v[226:227], v[234:235]
    v_pk_fma_f32 v[76:77], v[76:77], v[228:229], v[236:237]
    v_pk_fma_f32 v[78:79], v[78:79], v[230:231], v[238:239]
    v_cvt_pk_bf16_f32 v36, v72, v73
    v_cvt_pk_bf16_f32 v37, v74, v75
    v_cvt_pk_bf16_f32 v38, v76, v77
    v_cvt_pk_bf16_f32 v39, v78, v79
    ds_write_b128 v240, v[36:39] offset:15232
    v_pk_fma_f32 v[80:81], v[80:81], v[224:225], v[232:233]
    v_pk_fma_f32 v[82:83], v[82:83], v[226:227], v[234:235]
    v_pk_fma_f32 v[84:85], v[84:85], v[228:229], v[236:237]
    v_pk_fma_f32 v[86:87], v[86:87], v[230:231], v[238:239]
    v_cvt_pk_bf16_f32 v40, v80, v81
    v_cvt_pk_bf16_f32 v41, v82, v83
    v_cvt_pk_bf16_f32 v42, v84, v85
    v_cvt_pk_bf16_f32 v43, v86, v87
    ds_write_b128 v241, v[40:43] offset:16128
    v_pk_fma_f32 v[88:89], v[88:89], v[224:225], v[232:233]
    v_pk_fma_f32 v[90:91], v[90:91], v[226:227], v[234:235]
    v_pk_fma_f32 v[92:93], v[92:93], v[228:229], v[236:237]
    v_pk_fma_f32 v[94:95], v[94:95], v[230:231], v[238:239]
    v_cvt_pk_bf16_f32 v44, v88, v89
    v_cvt_pk_bf16_f32 v45, v90, v91
    v_cvt_pk_bf16_f32 v46, v92, v93
    v_cvt_pk_bf16_f32 v47, v94, v95
    ds_write_b128 v241, v[44:47] offset:17024
    v_pk_fma_f32 v[96:97], v[96:97], v[224:225], v[232:233]
    v_pk_fma_f32 v[98:99], v[98:99], v[226:227], v[234:235]
    v_pk_fma_f32 v[100:101], v[100:101], v[228:229], v[236:237]
    v_pk_fma_f32 v[102:103], v[102:103], v[230:231], v[238:239]
    v_cvt_pk_bf16_f32 v32, v96, v97
    v_cvt_pk_bf16_f32 v33, v98, v99
    v_cvt_pk_bf16_f32 v34, v100, v101
    v_cvt_pk_bf16_f32 v35, v102, v103
    ds_write_b128 v240, v[32:35] offset:28672
    v_pk_fma_f32 v[104:105], v[104:105], v[224:225], v[232:233]
    v_pk_fma_f32 v[106:107], v[106:107], v[226:227], v[234:235]
    v_pk_fma_f32 v[108:109], v[108:109], v[228:229], v[236:237]
    v_pk_fma_f32 v[110:111], v[110:111], v[230:231], v[238:239]
    v_cvt_pk_bf16_f32 v36, v104, v105
    v_cvt_pk_bf16_f32 v37, v106, v107
    v_cvt_pk_bf16_f32 v38, v108, v109
    v_cvt_pk_bf16_f32 v39, v110, v111
    ds_write_b128 v240, v[36:39] offset:29568
    v_pk_fma_f32 v[112:113], v[112:113], v[224:225], v[232:233]
    v_pk_fma_f32 v[114:115], v[114:115], v[226:227], v[234:235]
    v_pk_fma_f32 v[116:117], v[116:117], v[228:229], v[236:237]
    v_pk_fma_f32 v[118:119], v[118:119], v[230:231], v[238:239]
    v_cvt_pk_bf16_f32 v40, v112, v113
    v_cvt_pk_bf16_f32 v41, v114, v115
    v_cvt_pk_bf16_f32 v42, v116, v117
    v_cvt_pk_bf16_f32 v43, v118, v119
    ds_write_b128 v241, v[40:43] offset:30464
    v_pk_fma_f32 v[120:121], v[120:121], v[224:225], v[232:233]
    v_pk_fma_f32 v[122:123], v[122:123], v[226:227], v[234:235]
    v_pk_fma_f32 v[124:125], v[124:125], v[228:229], v[236:237]
    v_pk_fma_f32 v[126:127], v[126:127], v[230:231], v[238:239]
    v_cvt_pk_bf16_f32 v44, v120, v121
    v_cvt_pk_bf16_f32 v45, v122, v123
    v_cvt_pk_bf16_f32 v46, v124, v125
    v_cvt_pk_bf16_f32 v47, v126, v127
    ds_write_b128 v241, v[44:47] offset:31360
    s_waitcnt lgkmcnt(0)
    s_barrier
    s_setprio 0
    buffer_load_dword v250, v253, s[52:55], s66 offen offset:0
    v_fma_f32 v128, v128, v224, v232
    v_fma_f32 v129, v129, v225, v233
    v_fma_f32 v130, v130, v226, v234
    v_fma_f32 v131, v131, v227, v235
    v_fma_f32 v132, v132, v228, v236
    v_fma_f32 v133, v133, v229, v237
    v_fma_f32 v134, v134, v230, v238
    v_fma_f32 v135, v135, v231, v239
    v_cvt_pk_bf16_f32 v32, v128, v129
    v_cvt_pk_bf16_f32 v33, v130, v131
    v_cvt_pk_bf16_f32 v34, v132, v133
    v_cvt_pk_bf16_f32 v35, v134, v135
    ds_write_b128 v240, v[32:35] offset:43008
    v_fma_f32 v136, v136, v224, v232
    v_fma_f32 v137, v137, v225, v233
    v_fma_f32 v138, v138, v226, v234
    v_fma_f32 v139, v139, v227, v235
    v_fma_f32 v140, v140, v228, v236
    v_fma_f32 v141, v141, v229, v237
    v_fma_f32 v142, v142, v230, v238
    v_fma_f32 v143, v143, v231, v239
    v_cvt_pk_bf16_f32 v36, v136, v137
    v_cvt_pk_bf16_f32 v37, v138, v139
    v_cvt_pk_bf16_f32 v38, v140, v141
    v_cvt_pk_bf16_f32 v39, v142, v143
    ds_write_b128 v240, v[36:39] offset:43904
    v_fma_f32 v144, v144, v224, v232
    v_fma_f32 v145, v145, v225, v233
    v_fma_f32 v146, v146, v226, v234
    v_fma_f32 v147, v147, v227, v235
    v_fma_f32 v148, v148, v228, v236
    v_fma_f32 v149, v149, v229, v237
    v_fma_f32 v150, v150, v230, v238
    v_fma_f32 v151, v151, v231, v239
    v_cvt_pk_bf16_f32 v40, v144, v145
    v_cvt_pk_bf16_f32 v41, v146, v147
    v_cvt_pk_bf16_f32 v42, v148, v149
    v_cvt_pk_bf16_f32 v43, v150, v151
    ds_write_b128 v241, v[40:43] offset:44800
    v_fma_f32 v152, v152, v224, v232
    v_fma_f32 v153, v153, v225, v233
    v_fma_f32 v154, v154, v226, v234
    v_fma_f32 v155, v155, v227, v235
    v_fma_f32 v156, v156, v228, v236
    v_fma_f32 v157, v157, v229, v237
    v_fma_f32 v158, v158, v230, v238
    v_fma_f32 v159, v159, v231, v239
    v_cvt_pk_bf16_f32 v44, v152, v153
    v_cvt_pk_bf16_f32 v45, v154, v155
    v_cvt_pk_bf16_f32 v46, v156, v157
    v_cvt_pk_bf16_f32 v47, v158, v159
    ds_write_b128 v241, v[44:47] offset:45696
    v_fma_f32 v160, v160, v224, v232
    v_fma_f32 v161, v161, v225, v233
    v_fma_f32 v162, v162, v226, v234
    v_fma_f32 v163, v163, v227, v235
    v_fma_f32 v164, v164, v228, v236
    v_fma_f32 v165, v165, v229, v237
    v_fma_f32 v166, v166, v230, v238
    v_fma_f32 v167, v167, v231, v239
    v_cvt_pk_bf16_f32 v32, v160, v161
    v_cvt_pk_bf16_f32 v33, v162, v163
    v_cvt_pk_bf16_f32 v34, v164, v165
    v_cvt_pk_bf16_f32 v35, v166, v167
    ds_write_b128 v240, v[32:35] offset:57344
    v_fma_f32 v168, v168, v224, v232
    v_fma_f32 v169, v169, v225, v233
    v_fma_f32 v170, v170, v226, v234
    v_fma_f32 v171, v171, v227, v235
    v_fma_f32 v172, v172, v228, v236
    v_fma_f32 v173, v173, v229, v237
    v_fma_f32 v174, v174, v230, v238
    v_fma_f32 v175, v175, v231, v239
    v_cvt_pk_bf16_f32 v36, v168, v169
    v_cvt_pk_bf16_f32 v37, v170, v171
    v_cvt_pk_bf16_f32 v38, v172, v173
    v_cvt_pk_bf16_f32 v39, v174, v175
    ds_write_b128 v240, v[36:39] offset:58240
    v_fma_f32 v176, v176, v224, v232
    v_fma_f32 v177, v177, v225, v233
    v_fma_f32 v178, v178, v226, v234
    v_fma_f32 v179, v179, v227, v235
    v_fma_f32 v180, v180, v228, v236
    v_fma_f32 v181, v181, v229, v237
    v_fma_f32 v182, v182, v230, v238
    v_fma_f32 v183, v183, v231, v239
    v_cvt_pk_bf16_f32 v40, v176, v177
    v_cvt_pk_bf16_f32 v41, v178, v179
    v_cvt_pk_bf16_f32 v42, v180, v181
    v_cvt_pk_bf16_f32 v43, v182, v183
    ds_write_b128 v241, v[40:43] offset:59136
    v_fma_f32 v184, v184, v224, v232
    v_fma_f32 v185, v185, v225, v233
    v_fma_f32 v186, v186, v226, v234
    v_fma_f32 v187, v187, v227, v235
    v_fma_f32 v188, v188, v228, v236
    v_fma_f32 v189, v189, v229, v237
    v_fma_f32 v190, v190, v230, v238
    v_fma_f32 v191, v191, v231, v239
    v_cvt_pk_bf16_f32 v44, v184, v185
    v_cvt_pk_bf16_f32 v45, v186, v187
    v_cvt_pk_bf16_f32 v46, v188, v189
    v_cvt_pk_bf16_f32 v47, v190, v191
    ds_write_b128 v241, v[44:47] offset:60032
    s_waitcnt lgkmcnt(0)
    s_barrier
    v_fma_f32 v192, v192, v224, v232
    v_fma_f32 v193, v193, v225, v233
    v_fma_f32 v194, v194, v226, v234
    v_fma_f32 v195, v195, v227, v235
    v_fma_f32 v196, v196, v228, v236
    v_fma_f32 v197, v197, v229, v237
    v_fma_f32 v198, v198, v230, v238
    v_fma_f32 v199, v199, v231, v239
    v_cvt_pk_bf16_f32 v32, v192, v193
    v_cvt_pk_bf16_f32 v33, v194, v195
    v_cvt_pk_bf16_f32 v34, v196, v197
    v_cvt_pk_bf16_f32 v35, v198, v199
    ds_write_b128 v240, v[32:35] offset:0
    v_fma_f32 v200, v200, v224, v232
    v_fma_f32 v201, v201, v225, v233
    v_fma_f32 v202, v202, v226, v234
    v_fma_f32 v203, v203, v227, v235
    v_fma_f32 v204, v204, v228, v236
    v_fma_f32 v205, v205, v229, v237
    v_fma_f32 v206, v206, v230, v238
    v_fma_f32 v207, v207, v231, v239
    v_cvt_pk_bf16_f32 v36, v200, v201
    v_cvt_pk_bf16_f32 v37, v202, v203
    v_cvt_pk_bf16_f32 v38, v204, v205
    v_cvt_pk_bf16_f32 v39, v206, v207
    ds_write_b128 v240, v[36:39] offset:896
    v_fma_f32 v208, v208, v224, v232
    v_fma_f32 v209, v209, v225, v233
    v_fma_f32 v210, v210, v226, v234
    v_fma_f32 v211, v211, v227, v235
    v_fma_f32 v212, v212, v228, v236
    v_fma_f32 v213, v213, v229, v237
    v_fma_f32 v214, v214, v230, v238
    v_fma_f32 v215, v215, v231, v239
    v_cvt_pk_bf16_f32 v40, v208, v209
    v_cvt_pk_bf16_f32 v41, v210, v211
    v_cvt_pk_bf16_f32 v42, v212, v213
    v_cvt_pk_bf16_f32 v43, v214, v215
    ds_write_b128 v241, v[40:43] offset:1792
    v_fma_f32 v216, v216, v224, v232
    v_fma_f32 v217, v217, v225, v233
    v_fma_f32 v218, v218, v226, v234
    v_fma_f32 v219, v219, v227, v235
    v_fma_f32 v220, v220, v228, v236
    v_fma_f32 v221, v221, v229, v237
    v_fma_f32 v222, v222, v230, v238
    v_fma_f32 v223, v223, v231, v239
    v_cvt_pk_bf16_f32 v44, v216, v217
    v_cvt_pk_bf16_f32 v45, v218, v219
    v_cvt_pk_bf16_f32 v46, v220, v221
    v_cvt_pk_bf16_f32 v47, v222, v223
    ds_write_b128 v241, v[44:47] offset:2688
    s_waitcnt lgkmcnt(0)
    s_barrier
    s_mul_i32 s72, s69, 7168
    s_add_u32 s72, s72, 28672
    s_lshl3_add_u32 s73, s4, s3
    s_lshl_b32 s73, s73, 6
    s_cmp_lt_u32 s69, 2
    s_cbranch_scc1 L_69
    ds_read_b64_tr_b16 v[128:129], v242 offset:0
    ds_read_b64_tr_b16 v[130:131], v242 offset:512
    ds_read_b64_tr_b16 v[132:133], v242 offset:2048
    ds_read_b64_tr_b16 v[134:135], v242 offset:2560
    ds_read_b64_tr_b16 v[136:137], v242 offset:4096
    ds_read_b64_tr_b16 v[138:139], v242 offset:4608
    ds_read_b64_tr_b16 v[140:141], v242 offset:6144
    ds_read_b64_tr_b16 v[142:143], v242 offset:6656
    ds_read_b64_tr_b16 v[144:145], v242 offset:8192
    ds_read_b64_tr_b16 v[146:147], v242 offset:8704
    ds_read_b64_tr_b16 v[148:149], v242 offset:10240
    ds_read_b64_tr_b16 v[150:151], v242 offset:10752
    ds_read_b64_tr_b16 v[152:153], v242 offset:12288
    ds_read_b64_tr_b16 v[154:155], v242 offset:12800
    ds_read_b64_tr_b16 v[156:157], v242 offset:14336
    ds_read_b64_tr_b16 v[158:159], v242 offset:14848
    ds_read_b64_tr_b16 v[160:161], v242 offset:16384
    ds_read_b64_tr_b16 v[162:163], v242 offset:16896
    ds_read_b64_tr_b16 v[164:165], v242 offset:18432
    ds_read_b64_tr_b16 v[166:167], v242 offset:18944
    ds_read_b64_tr_b16 v[168:169], v242 offset:20480
    ds_read_b64_tr_b16 v[170:171], v242 offset:20992
    ds_read_b64_tr_b16 v[172:173], v242 offset:22528
    ds_read_b64_tr_b16 v[174:175], v242 offset:23040
    ds_read_b64_tr_b16 v[176:177], v242 offset:24576
    ds_read_b64_tr_b16 v[178:179], v242 offset:25088
    ds_read_b64_tr_b16 v[180:181], v242 offset:26624
    ds_read_b64_tr_b16 v[182:183], v242 offset:27136
    ds_read_b64_tr_b16 v[184:185], v242 offset:28672
    ds_read_b64_tr_b16 v[186:187], v242 offset:29184
    ds_read_b64_tr_b16 v[188:189], v242 offset:30720
    ds_read_b64_tr_b16 v[190:191], v242 offset:31232
    ds_read_b128 v[64:67], v4 offset:0
    ds_read_b128 v[68:71], v5 offset:0
    ds_read_b128 v[72:75], v6 offset:0
    ds_read_b128 v[76:79], v7 offset:0
    ds_read_b128 v[80:83], v4 offset:128
    s_waitcnt lgkmcnt(4)
    v_mfma_f32_32x32x16_bf16 v[84:99], v[64:67], v[128:131], 0
    ds_read_b64_tr_b16 v[192:193], v242 offset:32768
    ds_read_b64_tr_b16 v[194:195], v242 offset:33280
    ds_read_b128 v[64:67], v5 offset:128
    s_waitcnt lgkmcnt(6)
    v_mfma_f32_32x32x16_bf16 v[84:99], v[68:71], v[132:135], v[84:99]
    ds_read_b64_tr_b16 v[196:197], v242 offset:34816
    ds_read_b64_tr_b16 v[198:199], v242 offset:35328
    ds_read_b128 v[68:71], v6 offset:128
    s_waitcnt lgkmcnt(8)
    v_mfma_f32_32x32x16_bf16 v[84:99], v[72:75], v[136:139], v[84:99]
    ds_read_b64_tr_b16 v[200:201], v242 offset:36864
    ds_read_b64_tr_b16 v[202:203], v242 offset:37376
    ds_read_b128 v[72:75], v7 offset:128
    s_waitcnt lgkmcnt(10)
    v_mfma_f32_32x32x16_bf16 v[84:99], v[76:79], v[140:143], v[84:99]
    ds_read_b64_tr_b16 v[204:205], v242 offset:38912
    ds_read_b64_tr_b16 v[206:207], v242 offset:39424
    ds_read_b128 v[76:79], v4 offset:256
    s_waitcnt lgkmcnt(12)
    v_mfma_f32_32x32x16_bf16 v[84:99], v[80:83], v[144:147], v[84:99]
    ds_read_b64_tr_b16 v[208:209], v242 offset:40960
    ds_read_b64_tr_b16 v[210:211], v242 offset:41472
    ds_read_b128 v[80:83], v5 offset:256
    s_waitcnt lgkmcnt(12)
    v_mfma_f32_32x32x16_bf16 v[84:99], v[64:67], v[148:151], v[84:99]
    ds_read_b64_tr_b16 v[212:213], v242 offset:43008
    ds_read_b64_tr_b16 v[214:215], v242 offset:43520
    ds_read_b128 v[64:67], v6 offset:256
    s_waitcnt lgkmcnt(12)
    v_mfma_f32_32x32x16_bf16 v[84:99], v[68:71], v[152:155], v[84:99]
    ds_read_b64_tr_b16 v[216:217], v242 offset:45056
    ds_read_b64_tr_b16 v[218:219], v242 offset:45568
    ds_read_b128 v[68:71], v7 offset:256
    s_waitcnt lgkmcnt(12)
    v_mfma_f32_32x32x16_bf16 v[84:99], v[72:75], v[156:159], v[84:99]
    ds_read_b64_tr_b16 v[220:221], v242 offset:47104
    ds_read_b64_tr_b16 v[222:223], v242 offset:47616
    ds_read_b128 v[72:75], v4 offset:384
    s_waitcnt lgkmcnt(12)
    v_mfma_f32_32x32x16_bf16 v[84:99], v[76:79], v[160:163], v[84:99]
    ds_read_b64_tr_b16 v[224:225], v242 offset:49152
    ds_read_b64_tr_b16 v[226:227], v242 offset:49664
    ds_read_b128 v[76:79], v5 offset:384
    s_waitcnt lgkmcnt(12)
    v_mfma_f32_32x32x16_bf16 v[84:99], v[80:83], v[164:167], v[84:99]
    ds_read_b64_tr_b16 v[228:229], v242 offset:51200
    ds_read_b64_tr_b16 v[230:231], v242 offset:51712
    ds_read_b128 v[80:83], v6 offset:384
    s_waitcnt lgkmcnt(12)
    v_mfma_f32_32x32x16_bf16 v[84:99], v[64:67], v[168:171], v[84:99]
    ds_read_b64_tr_b16 v[232:233], v242 offset:53248
    ds_read_b64_tr_b16 v[234:235], v242 offset:53760
    buffer_load_dwordx4 v[120:123], v10, s[56:59], 0 offen sc1
    buffer_load_dword v248, v12, s[56:59], 0 offen sc1
    ds_read_b128 v[64:67], v7 offset:384
    s_waitcnt lgkmcnt(12)
    v_mfma_f32_32x32x16_bf16 v[84:99], v[68:71], v[172:175], v[84:99]
    ds_read_b64_tr_b16 v[236:237], v242 offset:55296
    ds_read_b64_tr_b16 v[238:239], v242 offset:55808
    ds_write_b32 v254, v251 offset:80
    ds_read_b128 v[68:71], v4 offset:512
    s_waitcnt lgkmcnt(13)
    v_mfma_f32_32x32x16_bf16 v[84:99], v[72:75], v[176:179], v[84:99]
    ds_read_b128 v[72:75], v5 offset:512
    s_waitcnt lgkmcnt(11)
    v_mfma_f32_32x32x16_bf16 v[84:99], v[76:79], v[180:183], v[84:99]
    ds_read_b128 v[76:79], v6 offset:512
    s_waitcnt lgkmcnt(9)
    v_mfma_f32_32x32x16_bf16 v[84:99], v[80:83], v[184:187], v[84:99]
    ds_read_b128 v[80:83], v7 offset:512
    s_waitcnt lgkmcnt(7)
    v_mfma_f32_32x32x16_bf16 v[84:99], v[64:67], v[188:191], v[84:99]
    ds_read_b128 v[64:67], v4 offset:640
    s_waitcnt lgkmcnt(4)
    v_mfma_f32_32x32x16_bf16 v[84:99], v[68:71], v[192:195], v[84:99]
    ds_read_b128 v[68:71], v5 offset:640
    s_waitcnt lgkmcnt(4)
    v_mfma_f32_32x32x16_bf16 v[84:99], v[72:75], v[196:199], v[84:99]
    ds_read_b128 v[72:75], v6 offset:640
    s_waitcnt lgkmcnt(4)
    v_mfma_f32_32x32x16_bf16 v[84:99], v[76:79], v[200:203], v[84:99]
    ds_read_b128 v[76:79], v7 offset:640
    s_waitcnt lgkmcnt(4)
    v_mfma_f32_32x32x16_bf16 v[84:99], v[80:83], v[204:207], v[84:99]
    ds_read_b128 v[80:83], v4 offset:768
    s_waitcnt lgkmcnt(4)
    v_mfma_f32_32x32x16_bf16 v[84:99], v[64:67], v[208:211], v[84:99]
    ds_read_b128 v[64:67], v5 offset:768
    s_waitcnt lgkmcnt(4)
    v_mfma_f32_32x32x16_bf16 v[84:99], v[68:71], v[212:215], v[84:99]
    ds_read_b128 v[68:71], v6 offset:768
    s_waitcnt lgkmcnt(4)
    v_mfma_f32_32x32x16_bf16 v[84:99], v[72:75], v[216:219], v[84:99]
    ds_read_b128 v[72:75], v7 offset:768
    s_waitcnt lgkmcnt(4)
    v_mfma_f32_32x32x16_bf16 v[84:99], v[76:79], v[220:223], v[84:99]
    ds_read_b128 v[76:79], v4 offset:28672
    s_waitcnt lgkmcnt(4)
    v_mfma_f32_32x32x16_bf16 v[84:99], v[80:83], v[224:227], v[84:99]
    ds_read_b128 v[80:83], v5 offset:28672
    s_waitcnt lgkmcnt(4)
    v_mfma_f32_32x32x16_bf16 v[84:99], v[64:67], v[228:231], v[84:99]
    ds_read_b128 v[64:67], v6 offset:28672
    s_waitcnt lgkmcnt(4)
    v_mfma_f32_32x32x16_bf16 v[84:99], v[68:71], v[232:235], v[84:99]
    ds_read_b128 v[68:71], v7 offset:28672
    s_waitcnt lgkmcnt(4)
    v_mfma_f32_32x32x16_bf16 v[84:99], v[72:75], v[236:239], v[84:99]
    s_barrier
    s_setprio 2
    ds_read_b128 v[72:75], v4 offset:28800
    s_waitcnt lgkmcnt(4)
    v_mfma_f32_32x32x16_bf16 v[100:115], v[76:79], v[128:131], 0
    ds_read_b128 v[76:79], v5 offset:28800
    s_waitcnt lgkmcnt(4)
    v_mfma_f32_32x32x16_bf16 v[100:115], v[80:83], v[132:135], v[100:115]
    ds_read_b128 v[80:83], v6 offset:28800
    s_waitcnt lgkmcnt(4)
    v_mfma_f32_32x32x16_bf16 v[100:115], v[64:67], v[136:139], v[100:115]
    ds_read_b128 v[64:67], v7 offset:28800
    s_waitcnt lgkmcnt(4)
    v_mfma_f32_32x32x16_bf16 v[100:115], v[68:71], v[140:143], v[100:115]
    ds_read_b128 v[68:71], v4 offset:28928
    s_waitcnt lgkmcnt(4)
    v_mfma_f32_32x32x16_bf16 v[100:115], v[72:75], v[144:147], v[100:115]
    ds_read_b128 v[72:75], v5 offset:28928
    s_waitcnt lgkmcnt(4)
    v_mfma_f32_32x32x16_bf16 v[100:115], v[76:79], v[148:151], v[100:115]
    v_cvt_pk_bf16_f32 v116, v84, v85
    v_cvt_pk_bf16_f32 v117, v86, v87
    ds_write_b64 v244, v[116:117] offset:0
    ds_read_b128 v[76:79], v6 offset:28928
    s_waitcnt lgkmcnt(5)
    v_mfma_f32_32x32x16_bf16 v[100:115], v[80:83], v[152:155], v[100:115]
    ds_read_b128 v[80:83], v7 offset:28928
    s_waitcnt lgkmcnt(5)
    v_mfma_f32_32x32x16_bf16 v[100:115], v[64:67], v[156:159], v[100:115]
    v_cvt_pk_bf16_f32 v118, v88, v89
    v_cvt_pk_bf16_f32 v119, v90, v91
    ds_write_b64 v244, v[118:119] offset:256
    ds_read_b128 v[64:67], v4 offset:29056
    s_waitcnt lgkmcnt(6)
    v_mfma_f32_32x32x16_bf16 v[100:115], v[68:71], v[160:163], v[100:115]
    ds_read_b128 v[68:71], v5 offset:29056
    s_waitcnt lgkmcnt(6)
    v_mfma_f32_32x32x16_bf16 v[100:115], v[72:75], v[164:167], v[100:115]
    v_cvt_pk_bf16_f32 v116, v92, v93
    v_cvt_pk_bf16_f32 v117, v94, v95
    ds_write_b64 v244, v[116:117] offset:512
    ds_read_b128 v[72:75], v6 offset:29056
    s_waitcnt lgkmcnt(6)
    v_mfma_f32_32x32x16_bf16 v[100:115], v[76:79], v[168:171], v[100:115]
    ds_read_b128 v[76:79], v7 offset:29056
    s_waitcnt lgkmcnt(6)
    v_mfma_f32_32x32x16_bf16 v[100:115], v[80:83], v[172:175], v[100:115]
    v_cvt_pk_bf16_f32 v118, v96, v97
    v_cvt_pk_bf16_f32 v119, v98, v99
    ds_write_b64 v244, v[118:119] offset:768
    ds_read_b128 v[80:83], v4 offset:29184
    s_waitcnt lgkmcnt(6)
    v_mfma_f32_32x32x16_bf16 v[100:115], v[64:67], v[176:179], v[100:115]
    ds_read_b128 v[64:67], v5 offset:29184
    s_waitcnt lgkmcnt(6)
    v_mfma_f32_32x32x16_bf16 v[100:115], v[68:71], v[180:183], v[100:115]
    ds_read_b128 v[68:71], v6 offset:29184
    s_waitcnt lgkmcnt(5)
    v_mfma_f32_32x32x16_bf16 v[100:115], v[72:75], v[184:187], v[100:115]
    ds_read_b128 v[72:75], v7 offset:29184
    s_waitcnt lgkmcnt(5)
    v_mfma_f32_32x32x16_bf16 v[100:115], v[76:79], v[188:191], v[100:115]
    ds_read_b128 v[76:79], v4 offset:29312
    s_waitcnt lgkmcnt(4)
    v_mfma_f32_32x32x16_bf16 v[100:115], v[80:83], v[192:195], v[100:115]
    ds_read_b128 v[80:83], v5 offset:29312
    s_waitcnt lgkmcnt(4)
    v_mfma_f32_32x32x16_bf16 v[100:115], v[64:67], v[196:199], v[100:115]
    ds_read_b128 v[64:67], v6 offset:29312
    s_waitcnt lgkmcnt(4)
    v_mfma_f32_32x32x16_bf16 v[100:115], v[68:71], v[200:203], v[100:115]
    ds_read_b128 v[68:71], v7 offset:29312
    s_waitcnt lgkmcnt(4)
    v_mfma_f32_32x32x16_bf16 v[100:115], v[72:75], v[204:207], v[100:115]
    ds_read_b128 v[72:75], v4 offset:29440
    s_waitcnt lgkmcnt(4)
    v_mfma_f32_32x32x16_bf16 v[100:115], v[76:79], v[208:211], v[100:115]
    ds_read_b128 v[76:79], v5 offset:29440
    s_waitcnt lgkmcnt(4)
    v_mfma_f32_32x32x16_bf16 v[100:115], v[80:83], v[212:215], v[100:115]
    ds_read_b128 v[80:83], v6 offset:29440
    s_waitcnt lgkmcnt(4)
    v_mfma_f32_32x32x16_bf16 v[100:115], v[64:67], v[216:219], v[100:115]
    ds_read_b128 v[64:67], v7 offset:29440
    s_waitcnt lgkmcnt(4)
    v_mfma_f32_32x32x16_bf16 v[100:115], v[68:71], v[220:223], v[100:115]
    s_waitcnt lgkmcnt(3)
    v_mfma_f32_32x32x16_bf16 v[100:115], v[72:75], v[224:227], v[100:115]
    s_waitcnt lgkmcnt(2)
    v_mfma_f32_32x32x16_bf16 v[100:115], v[76:79], v[228:231], v[100:115]
    s_waitcnt lgkmcnt(1)
    v_mfma_f32_32x32x16_bf16 v[100:115], v[80:83], v[232:235], v[100:115]
    s_waitcnt lgkmcnt(0)
    v_mfma_f32_32x32x16_bf16 v[100:115], v[64:67], v[236:239], v[100:115]
    s_nop 11
    v_cvt_pk_bf16_f32 v116, v100, v101
    v_cvt_pk_bf16_f32 v117, v102, v103
    ds_write_b64 v244, v[116:117] offset:1024
    v_cvt_pk_bf16_f32 v118, v104, v105
    v_cvt_pk_bf16_f32 v119, v106, v107
    ds_write_b64 v244, v[118:119] offset:1280
    s_branch L_70
L_69:
    buffer_load_dword v250, v247, s[44:47], 0 offen
    s_add_u32 s90, s67, 57344
    buffer_load_dword v250, v14, s[56:59], s90 offen
    s_add_u32 s90, s67, 61440
    buffer_load_dword v250, v14, s[56:59], s90 offen
    s_mul_i32 s90, s5, 577536
    s_lshl_b32 s91, s4, 11
    s_add_u32 s90, s90, s91
    s_add_u32 s90, s90, 4311040
    buffer_load_dword v250, v14, s[56:59], s90 offen
    v_and_b32 v2, 3, v0
    v_lshlrev_b32 v2, 2, v2
    v_add_u32 v2, 157760, v2
    ds_read_b64_tr_b16 v[128:129], v242 offset:0
    ds_read_b64_tr_b16 v[130:131], v242 offset:512
    ds_read_b64_tr_b16 v[132:133], v242 offset:2048
    ds_read_b64_tr_b16 v[134:135], v242 offset:2560
    ds_read_b64_tr_b16 v[136:137], v242 offset:4096
    ds_read_b64_tr_b16 v[138:139], v242 offset:4608
    ds_read_b64_tr_b16 v[140:141], v242 offset:6144
    ds_read_b64_tr_b16 v[142:143], v242 offset:6656
    ds_read_b64_tr_b16 v[144:145], v242 offset:8192
    ds_read_b64_tr_b16 v[146:147], v242 offset:8704
    ds_read_b64_tr_b16 v[148:149], v242 offset:10240
    ds_read_b64_tr_b16 v[150:151], v242 offset:10752
    ds_read_b64_tr_b16 v[152:153], v242 offset:12288
    ds_read_b64_tr_b16 v[154:155], v242 offset:12800
    ds_read_b64_tr_b16 v[156:157], v242 offset:14336
    ds_read_b64_tr_b16 v[158:159], v242 offset:14848
    ds_read_b64_tr_b16 v[160:161], v242 offset:16384
    ds_read_b64_tr_b16 v[162:163], v242 offset:16896
    ds_read_b64_tr_b16 v[164:165], v242 offset:18432
    ds_read_b64_tr_b16 v[166:167], v242 offset:18944
    ds_read_b64_tr_b16 v[168:169], v242 offset:20480
    ds_read_b64_tr_b16 v[170:171], v242 offset:20992
    ds_read_b64_tr_b16 v[172:173], v242 offset:22528
    ds_read_b64_tr_b16 v[174:175], v242 offset:23040
    ds_read_b64_tr_b16 v[176:177], v242 offset:24576
    ds_read_b64_tr_b16 v[178:179], v242 offset:25088
    ds_read_b64_tr_b16 v[180:181], v242 offset:26624
    ds_read_b64_tr_b16 v[182:183], v242 offset:27136
    ds_read_b64_tr_b16 v[184:185], v242 offset:28672
    ds_read_b64_tr_b16 v[186:187], v242 offset:29184
    ds_read_b64_tr_b16 v[188:189], v242 offset:30720
    ds_read_b64_tr_b16 v[190:191], v242 offset:31232
    ds_read_b64_tr_b16 v[192:193], v242 offset:32768
    ds_read_b64_tr_b16 v[194:195], v242 offset:33280
    ds_read_b64_tr_b16 v[196:197], v242 offset:34816
    ds_read_b64_tr_b16 v[198:199], v242 offset:35328
    ds_read_b64_tr_b16 v[200:201], v242 offset:36864
    ds_read_b64_tr_b16 v[202:203], v242 offset:37376
    ds_read_b64_tr_b16 v[204:205], v242 offset:38912
    ds_read_b64_tr_b16 v[206:207], v242 offset:39424
    ds_read_b64_tr_b16 v[208:209], v242 offset:40960
    ds_read_b64_tr_b16 v[210:211], v242 offset:41472
    ds_read_b64_tr_b16 v[212:213], v242 offset:43008
    ds_read_b64_tr_b16 v[214:215], v242 offset:43520
    ds_read_b64_tr_b16 v[216:217], v242 offset:45056
    ds_read_b64_tr_b16 v[218:219], v242 offset:45568
    ds_read_b64_tr_b16 v[220:221], v242 offset:47104
    ds_read_b64_tr_b16 v[222:223], v242 offset:47616
    ds_read_b64_tr_b16 v[224:225], v242 offset:49152
    ds_read_b64_tr_b16 v[226:227], v242 offset:49664
    ds_read_b64_tr_b16 v[228:229], v242 offset:51200
    ds_read_b64_tr_b16 v[230:231], v242 offset:51712
    ds_read_b64_tr_b16 v[232:233], v242 offset:53248
    ds_read_b64_tr_b16 v[234:235], v242 offset:53760
    ds_read_b64_tr_b16 v[236:237], v242 offset:55296
    ds_read_b64_tr_b16 v[238:239], v242 offset:55808
    ds_write_b32 v254, v251 offset:80
    s_mov_b32 s95, 0x400000
Lsp_71:
    ds_read_b32 v3, v2 offset:80
    s_waitcnt lgkmcnt(0)
    v_cmp_ne_u32 vcc, s6, v3
    s_cbranch_vccz Lspd_72
    s_sub_u32 s95, s95, 1
    s_cbranch_scc0 Lsp_71
Lspd_72:
    s_add_u32 m0, s87, 0
    s_add_u32 s90, s86, 0
    buffer_load_dwordx4 v246, s[44:47], s90 offen lds
    s_add_u32 m0, s87, 2048
    s_add_u32 s90, s86, 14336
    buffer_load_dwordx4 v246, s[44:47], s90 offen lds
    s_add_u32 m0, s87, 4096
    s_add_u32 s90, s86, 28672
    buffer_load_dwordx4 v246, s[44:47], s90 offen lds
    s_add_u32 m0, s87, 6144
    s_add_u32 s90, s86, 43008
    buffer_load_dwordx4 v246, s[44:47], s90 offen lds
    s_add_u32 m0, s87, 8192
    s_add_u32 s90, s86, 57344
    buffer_load_dwordx4 v246, s[44:47], s90 offen lds
    s_add_u32 m0, s87, 10240
    s_add_u32 s90, s86, 71680
    buffer_load_dwordx4 v246, s[44:47], s90 offen lds
    s_add_u32 m0, s87, 12288
    s_add_u32 s90, s86, 86016
    buffer_load_dwordx4 v246, s[44:47], s90 offen lds
    s_add_u32 m0, s87, 14336
    s_add_u32 s90, s86, 100352
    buffer_load_dwordx4 v246, s[44:47], s90 offen lds
    s_add_u32 m0, s87, 16384
    s_add_u32 s90, s86, 114688
    buffer_load_dwordx4 v246, s[44:47], s90 offen lds
    s_add_u32 m0, s87, 18432
    s_add_u32 s90, s86, 129024
    buffer_load_dwordx4 v246, s[44:47], s90 offen lds
    s_add_u32 m0, s87, 20480
    s_add_u32 s90, s86, 143360
    buffer_load_dwordx4 v246, s[44:47], s90 offen lds
    s_add_u32 m0, s87, 22528
    s_add_u32 s90, s86, 157696
    buffer_load_dwordx4 v246, s[44:47], s90 offen lds
    s_add_u32 m0, s87, 24576
    s_add_u32 s90, s86, 172032
    buffer_load_dwordx4 v246, s[44:47], s90 offen lds
    s_add_u32 m0, s87, 26624
    s_add_u32 s90, s86, 186368
    buffer_load_dwordx4 v246, s[44:47], s90 offen lds
    buffer_load_dwordx4 v[120:123], v10, s[56:59], 0 offen sc1
    buffer_load_dword v248, v12, s[56:59], 0 offen sc1
    s_barrier
    s_setprio 2
    ds_read_b128 v[64:67], v4 offset:43008
    ds_read_b128 v[68:71], v5 offset:43008
    ds_read_b128 v[72:75], v6 offset:43008
    ds_read_b128 v[76:79], v7 offset:43008
    ds_read_b128 v[80:83], v4 offset:43136
    s_waitcnt lgkmcnt(4)
    v_mfma_f32_32x32x16_bf16 v[84:99], v[64:67], v[128:131], 0
    ds_read_b128 v[64:67], v5 offset:43136
    s_waitcnt lgkmcnt(4)
    v_mfma_f32_32x32x16_bf16 v[84:99], v[68:71], v[132:135], v[84:99]
    ds_read_b128 v[68:71], v6 offset:43136
    s_waitcnt lgkmcnt(4)
    v_mfma_f32_32x32x16_bf16 v[84:99], v[72:75], v[136:139], v[84:99]
    ds_read_b128 v[72:75], v7 offset:43136
    s_waitcnt lgkmcnt(4)
    v_mfma_f32_32x32x16_bf16 v[84:99], v[76:79], v[140:143], v[84:99]
    ds_read_b128 v[76:79], v4 offset:43264
    s_waitcnt lgkmcnt(4)
    v_mfma_f32_32x32x16_bf16 v[84:99], v[80:83], v[144:147], v[84:99]
    ds_read_b128 v[80:83], v5 offset:43264
    s_waitcnt lgkmcnt(4)
    v_mfma_f32_32x32x16_bf16 v[84:99], v[64:67], v[148:151], v[84:99]
    ds_read_b128 v[64:67], v6 offset:43264
    s_waitcnt lgkmcnt(4)
    v_mfma_f32_32x32x16_bf16 v[84:99], v[68:71], v[152:155], v[84:99]
    ds_read_b128 v[68:71], v7 offset:43264
    s_waitcnt lgkmcnt(4)
    v_mfma_f32_32x32x16_bf16 v[84:99], v[72:75], v[156:159], v[84:99]
    ds_read_b128 v[72:75], v4 offset:43392
    s_waitcnt lgkmcnt(4)
    v_mfma_f32_32x32x16_bf16 v[84:99], v[76:79], v[160:163], v[84:99]
    ds_read_b128 v[76:79], v5 offset:43392
    s_waitcnt lgkmcnt(4)
    v_mfma_f32_32x32x16_bf16 v[84:99], v[80:83], v[164:167], v[84:99]
    ds_read_b128 v[80:83], v6 offset:43392
    s_waitcnt lgkmcnt(4)
    v_mfma_f32_32x32x16_bf16 v[84:99], v[64:67], v[168:171], v[84:99]
    ds_read_b128 v[64:67], v7 offset:43392
    s_waitcnt lgkmcnt(4)
    v_mfma_f32_32x32x16_bf16 v[84:99], v[68:71], v[172:175], v[84:99]
    ds_read_b128 v[68:71], v4 offset:43520
    s_waitcnt lgkmcnt(4)
    v_mfma_f32_32x32x16_bf16 v[84:99], v[72:75], v[176:179], v[84:99]
    ds_read_b128 v[72:75], v5 offset:43520
    s_waitcnt lgkmcnt(4)
    v_mfma_f32_32x32x16_bf16 v[84:99], v[76:79], v[180:183], v[84:99]
    ds_read_b128 v[76:79], v6 offset:43520
    s_waitcnt lgkmcnt(4)
    v_mfma_f32_32x32x16_bf16 v[84:99], v[80:83], v[184:187], v[84:99]
    ds_read_b128 v[80:83], v7 offset:43520
    s_waitcnt lgkmcnt(4)
    v_mfma_f32_32x32x16_bf16 v[84:99], v[64:67], v[188:191], v[84:99]
    ds_read_b128 v[64:67], v4 offset:43648
    s_waitcnt lgkmcnt(4)
    v_mfma_f32_32x32x16_bf16 v[84:99], v[68:71], v[192:195], v[84:99]
    ds_read_b128 v[68:71], v5 offset:43648
    s_waitcnt lgkmcnt(4)
    v_mfma_f32_32x32x16_bf16 v[84:99], v[72:75], v[196:199], v[84:99]
    ds_read_b128 v[72:75], v6 offset:43648
    s_waitcnt lgkmcnt(4)
    v_mfma_f32_32x32x16_bf16 v[84:99], v[76:79], v[200:203], v[84:99]
    ds_read_b128 v[76:79], v7 offset:43648
    s_waitcnt lgkmcnt(4)
    v_mfma_f32_32x32x16_bf16 v[84:99], v[80:83], v[204:207], v[84:99]
    ds_read_b128 v[80:83], v4 offset:43776
    s_waitcnt lgkmcnt(4)
    v_mfma_f32_32x32x16_bf16 v[84:99], v[64:67], v[208:211], v[84:99]
    ds_read_b128 v[64:67], v5 offset:43776
    s_waitcnt lgkmcnt(4)
    v_mfma_f32_32x32x16_bf16 v[84:99], v[68:71], v[212:215], v[84:99]
    ds_read_b128 v[68:71], v6 offset:43776
    s_waitcnt lgkmcnt(4)
    v_mfma_f32_32x32x16_bf16 v[84:99], v[72:75], v[216:219], v[84:99]
    ds_read_b128 v[72:75], v7 offset:43776
    s_waitcnt lgkmcnt(4)
    v_mfma_f32_32x32x16_bf16 v[84:99], v[76:79], v[220:223], v[84:99]
    s_waitcnt lgkmcnt(3)
    v_mfma_f32_32x32x16_bf16 v[84:99], v[80:83], v[224:227], v[84:99]
    s_waitcnt lgkmcnt(2)
    v_mfma_f32_32x32x16_bf16 v[84:99], v[64:67], v[228:231], v[84:99]
    s_waitcnt lgkmcnt(1)
    v_mfma_f32_32x32x16_bf16 v[84:99], v[68:71], v[232:235], v[84:99]
    s_waitcnt lgkmcnt(0)
    v_mfma_f32_32x32x16_bf16 v[84:99], v[72:75], v[236:239], v[84:99]
    s_nop 11
    v_cvt_pk_bf16_f32 v116, v84, v85
    v_cvt_pk_bf16_f32 v117, v86, v87
    ds_write_b64 v244, v[116:117] offset:1536
    v_cvt_pk_bf16_f32 v118, v88, v89
    v_cvt_pk_bf16_f32 v119, v90, v91
    ds_write_b64 v244, v[118:119] offset:1792
    v_cvt_pk_bf16_f32 v116, v92, v93
    v_cvt_pk_bf16_f32 v117, v94, v95
    ds_write_b64 v244, v[116:117] offset:2048
    v_cvt_pk_bf16_f32 v118, v96, v97
    v_cvt_pk_bf16_f32 v119, v98, v99
    ds_write_b64 v244, v[118:119] offset:2304
L_70:
    ds_write_b32 v254, v251 offset:32
    s_setprio 2
    s_waitcnt lgkmcnt(0)
    s_add_u32 m0, s87, 28672
    s_add_u32 s90, s86, 200704
    buffer_load_dwordx4 v246, s[44:47], s90 offen lds
    s_add_u32 m0, s87, 32768
    s_add_u32 s90, s86, 229376
    buffer_load_dwordx4 v246, s[44:47], s90 offen lds
    s_add_u32 m0, s87, 36864
    s_add_u32 s90, s86, 258048
    buffer_load_dwordx4 v246, s[44:47], s90 offen lds
    s_add_u32 m0, s87, 40960
    s_add_u32 s90, s86, 286720
    buffer_load_dwordx4 v246, s[44:47], s90 offen lds
    s_add_u32 m0, s87, 45056
    s_add_u32 s90, s86, 315392
    buffer_load_dwordx4 v246, s[44:47], s90 offen lds
    s_add_u32 m0, s87, 49152
    s_add_u32 s90, s86, 344064
    buffer_load_dwordx4 v246, s[44:47], s90 offen lds
    s_add_u32 m0, s87, 53248
    s_add_u32 s90, s86, 372736
    buffer_load_dwordx4 v246, s[44:47], s90 offen lds
    s_add_u32 m0, s72, 0
    s_nop 0
    buffer_load_dwordx4 v245, s[48:51], s73 offen  lds
    s_add_u32 m0, s72, 1024
    s_add_u32 s73, s73, 28672
    buffer_load_dwordx4 v245, s[48:51], s73 offen  lds
    s_add_u32 m0, s72, 2048
    s_add_u32 s73, s73, 86016
    buffer_load_dwordx4 v245, s[48:51], s73 offen  lds
    s_add_u32 m0, s72, 3072
    s_add_u32 s73, s73, 28672
    buffer_load_dwordx4 v245, s[48:51], s73 offen  lds
    s_add_u32 m0, s72, 4096
    s_add_u32 s73, s73, 86016
    buffer_load_dwordx4 v245, s[48:51], s73 offen  lds
    s_waitcnt vmcnt(5)
    ds_write_b32 v254, v251 offset:48
    s_mul_i32 s76, s69, 9216
    s_add_u32 s76, s76, 61440
    s_mul_i32 s77, s69, 7168
    s_lshl3_add_u32 s79, s4, s69
    s_lshl_b32 s79, s79, 6
    s_add_u32 m0, s72, 5120
    s_add_u32 s73, s73, 28672
    buffer_load_dwordx4 v245, s[48:51], s73 offen  lds
    s_waitcnt vmcnt(5)
    ds_read_b64_tr_b16 v[16:17], v9 offset:0
    ds_read_b64_tr_b16 v[18:19], v9 offset:256
    s_add_u32 m0, s72, 6144
    s_add_u32 s73, s73, 86016
    buffer_load_dwordx4 v245, s[48:51], s73 offen  lds
    s_waitcnt vmcnt(5)
    ds_read_b64_tr_b16 v[20:21], v9 offset:1024
    ds_read_b64_tr_b16 v[22:23], v9 offset:1280
    s_waitcnt lgkmcnt(2)
    s_add_u32 m0, s72, 0
    s_add_u32 s73, s73, 28672
    buffer_load_dwordx4 v245, s[48:51], s73 offen  lds
    s_waitcnt vmcnt(5)
    ds_read_b64_tr_b16 v[24:25], v9 offset:2048
    ds_read_b64_tr_b16 v[26:27], v9 offset:2304
    s_waitcnt lgkmcnt(2)
    s_add_u32 m0, s72, 1024
    s_add_u32 s73, s73, 86016
    buffer_load_dwordx4 v245, s[48:51], s73 offen  lds
    s_waitcnt vmcnt(5)
    ds_read_b64_tr_b16 v[28:29], v9 offset:3072
    ds_read_b64_tr_b16 v[30:31], v9 offset:3328
    s_waitcnt lgkmcnt(2)
    s_add_u32 m0, s72, 2048
    s_add_u32 s73, s73, 28672
    buffer_load_dwordx4 v245, s[48:51], s73 offen  lds
    s_waitcnt vmcnt(5)
    ds_read_b64_tr_b16 v[32:33], v9 offset:4096
    ds_read_b64_tr_b16 v[34:35], v9 offset:4352
    s_waitcnt lgkmcnt(2)
    s_add_u32 m0, s72, 3072
    s_add_u32 s73, s73, 86016
    buffer_load_dwordx4 v245, s[48:51], s73 offen  lds
    s_waitcnt vmcnt(5)
    ds_read_b64_tr_b16 v[36:37], v9 offset:5120
    ds_read_b64_tr_b16 v[38:39], v9 offset:5376
    s_waitcnt lgkmcnt(2)
    s_add_u32 m0, s72, 4096
    s_add_u32 s73, s73, 28672
    buffer_load_dwordx4 v245, s[48:51], s73 offen  lds
    s_waitcnt vmcnt(5)
    ds_read_b64_tr_b16 v[40:41], v9 offset:6144
    ds_read_b64_tr_b16 v[42:43], v9 offset:6400
    s_waitcnt lgkmcnt(2)
    s_add_u32 m0, s72, 5120
    s_add_u32 s73, s73, 86016
    buffer_load_dwordx4 v245, s[48:51], s73 offen  lds
    s_waitcnt vmcnt(5)
    ds_read_b64_tr_b16 v[44:45], v9 offset:0
    ds_read_b64_tr_b16 v[46:47], v9 offset:256
    s_waitcnt lgkmcnt(2)
    s_add_u32 m0, s72, 6144
    s_add_u32 s73, s73, 28672
    buffer_load_dwordx4 v245, s[48:51], s73 offen  lds
    v_subrev_u32 v2, s6, v248
    v_xor_b32 v3, s6, v122
    v_and_or_b32 v3, v2, -8, v3
    v_cmp_ne_u32 vcc, 0, v3
    s_cbranch_vccnz Lre_73
Lreb_74:
    s_getreg_b32 s91, hwreg(HW_REG_XCC_ID, 0, 3)
    s_mul_i32 s64, s5, 577536
    v_cmp_ne_u32 vcc, s91, v2
    s_cmp_lg_u64 vcc, 0
    s_cselect_b32 s7, 1, 0
    s_mul_i32 s90, s7, 29360128
    s_add_u32 s64, s64, s90
    s_add_u32 s64, s64, 4194304
    s_mul_i32 s90, s7, 473088
    s_add_u32 s65, s64, s90
    s_add_u32 s65, s65, 6144
    s_add_u32 s66, s64, 59392
    s_waitcnt vmcnt(5)
    ds_read_b64_tr_b16 v[48:49], v9 offset:1024
    ds_read_b64_tr_b16 v[50:51], v9 offset:1280
    s_waitcnt vmcnt(4)
    ds_read_b64_tr_b16 v[52:53], v9 offset:2048
    ds_read_b64_tr_b16 v[54:55], v9 offset:2304
    s_waitcnt vmcnt(3)
    ds_read_b64_tr_b16 v[56:57], v9 offset:3072
    ds_read_b64_tr_b16 v[58:59], v9 offset:3328
    s_waitcnt vmcnt(2)
    ds_read_b64_tr_b16 v[60:61], v9 offset:4096
    ds_read_b64_tr_b16 v[62:63], v9 offset:4352
    s_waitcnt lgkmcnt(8)
    s_add_u32 m0, s72, 0
    s_add_u32 s73, s73, 86016
    buffer_load_dwordx4 v245, s[48:51], s73 offen  lds
    v_lshlrev_b32 v128, 16, v120
    v_and_b32 v129, s74, v120
    v_lshlrev_b32 v130, 16, v121
    v_and_b32 v131, s74, v121
    v_and_b32 v2, 7, v0
    v_bfe_u32 v3, v0, 3, 1
    v_lshlrev_b32 v2, 5, v2
    v_lshl_add_u32 v2, v3, 4, v2
    s_lshl_b32 s90, s69, 8
    s_add_u32 s90, s90, 158720
    s_waitcnt vmcnt(2)
    ds_read_b64_tr_b16 v[64:65], v9 offset:5120
    ds_read_b64_tr_b16 v[66:67], v9 offset:5376
    s_waitcnt lgkmcnt(8)
    s_add_u32 m0, s72, 1024
    s_add_u32 s73, s73, 28672
    buffer_load_dwordx4 v245, s[48:51], s73 offen  lds
    v_add_u32 v2, s90, v2
    ds_write_b128 v2, v[128:131]
    v_lshlrev_b32 v3, 2, v0
    v_add_u32 v3, 159744, v3
    v_lshlrev_b32 v132, 16, v249
    ds_write_b32 v3, v132
    ds_write_b32 v254, v251 offset:144
    v_and_b32 v6, 3, v0
    v_lshlrev_b32 v6, 2, v6
    v_add_u32 v6, 157888, v6
    s_waitcnt vmcnt(2)
    ds_read_b64_tr_b16 v[68:69], v9 offset:6144
    ds_read_b64_tr_b16 v[70:71], v9 offset:6400
    s_waitcnt lgkmcnt(11)
    s_add_u32 m0, s72, 2048
    s_add_u32 s73, s73, 86016
    buffer_load_dwordx4 v245, s[48:51], s73 offen  lds
    v_add_u32 v224, 100352, v15
    s_lshl_b32 s90, s3, 11
    s_add_u32 s90, s90, 28672
    v_add_u32 v225, s90, v15
    v_add_u32 v226, 160256, v15
    v_and_b32 v227, 0x1f0, v15
    v_add_u32 v227, 162304, v227
    v_add_u32 v228, 28672, v15
    v_lshrrev_b32 v2, 2, v0
    v_mul_u32_u24 v233, 896, v2
    s_waitcnt vmcnt(2)
    ds_read_b64_tr_b16 v[72:73], v9 offset:0
    ds_read_b64_tr_b16 v[74:75], v9 offset:256
    s_waitcnt lgkmcnt(11)
    s_add_u32 m0, s72, 3072
    s_add_u32 s73, s73, 28672
    buffer_load_dwordx4 v245, s[48:51], s73 offen  lds
    v_and_b32 v2, 3, v0
    v_lshl_add_u32 v233, v2, 4, v233
    s_and_b32 s90, s3, 3
    s_lshr_b32 s91, s90, 1
    s_add_u32 s91, s91, 2
    s_and_b32 s90, s90, 1
    s_add_u32 s92, s4, s91
    s_add_u32 s92, s92, 1
    s_cmp_ge_u32 s92, 7
    s_cselect_b32 s93, 7, 0
    s_waitcnt vmcnt(2)
    ds_read_b64_tr_b16 v[76:77], v9 offset:1024
    ds_read_b64_tr_b16 v[78:79], v9 offset:1280
    s_waitcnt lgkmcnt(11)
    s_add_u32 m0, s72, 4096
    s_add_u32 s73, s73, 86016
    buffer_load_dwordx4 v245, s[48:51], s73 offen  lds
    s_sub_u32 s92, s92, s93
    s_mul_i32 s80, s4, 229376
    s_lshl_b32 s93, s92, 7
    s_add_u32 s80, s80, s93
    s_lshl_b32 s94, s90, 6
    s_add_u32 s80, s80, s94
    s_and_b32 s81, s3, 3
    s_lshl2_add_u32 s81, s92, s81
    s_lshl_b32 s81, s81, 12
    s_add_u32 s81, s81, s64
    s_waitcnt vmcnt(2)
    ds_read_b64_tr_b16 v[80:81], v9 offset:2048
    ds_read_b64_tr_b16 v[82:83], v9 offset:2304
    s_waitcnt lgkmcnt(11)
    s_add_u32 m0, s72, 5120
    s_add_u32 s73, s73, 28672
    buffer_load_dwordx4 v245, s[48:51], s73 offen  lds
    s_mul_i32 s94, s7, 0
    s_add_u32 s81, s81, s94
    s_add_u32 s81, s81, 245760
    s_lshl_b32 s82, s91, 1
    s_add_u32 s82, s82, s90
    s_lshl_b32 s82, s82, 2
    s_add_u32 s82, s82, s93
    s_add_u32 s82, s82, s64
    s_add_u32 s82, s82, 256
    s_mov_b32 s84, s80
    s_waitcnt vmcnt(2)
    ds_read_b64_tr_b16 v[84:85], v9 offset:3072
    ds_read_b64_tr_b16 v[86:87], v9 offset:3328
    s_waitcnt lgkmcnt(8)
    s_add_u32 m0, s72, 6144
    s_add_u32 s73, s73, 86016
    buffer_load_dwordx4 v245, s[48:51], s73 offen  lds
    s_mov_b32 s85, s81
    s_mov_b32 s86, s82
    s_lshl2_add_u32 s83, s4, s64
    s_and_b32 s90, s3, 3
    s_lshr_b32 s91, s90, 1
    s_add_u32 s91, s91, 0
    s_and_b32 s90, s90, 1
    s_add_u32 s92, s4, s91
    s_add_u32 s92, s92, 1
    s_cmp_ge_u32 s92, 7
    s_cselect_b32 s93, 7, 0
    s_waitcnt vmcnt(2)
    ds_read_b64_tr_b16 v[88:89], v9 offset:4096
    ds_read_b64_tr_b16 v[90:91], v9 offset:4352
    s_waitcnt lgkmcnt(8)
    s_add_u32 m0, s72, 0
    s_add_u32 s73, s73, 28672
    buffer_load_dwordx4 v245, s[48:51], s73 offen  lds
    s_sub_u32 s92, s92, s93
    s_mul_i32 s80, s4, 229376
    s_lshl_b32 s93, s92, 7
    s_add_u32 s80, s80, s93
    s_lshl_b32 s94, s90, 6
    s_add_u32 s80, s80, s94
    s_and_b32 s81, s3, 3
    s_lshl2_add_u32 s81, s92, s81
    s_lshl_b32 s81, s81, 12
    s_add_u32 s81, s81, s64
    s_mul_i32 s94, s7, 0
    s_add_u32 s81, s81, s94
    s_add_u32 s81, s81, 131072
    s_lshl_b32 s82, s91, 1
    s_add_u32 s82, s82, s90
    s_lshl_b32 s82, s82, 2
    s_add_u32 s82, s82, s93
    s_add_u32 s82, s82, s64
    s_add_u32 s82, s82, 256
    v_add_u32 v234, s76, v8
    v_add_u32 v235, s77, v8
    s_mul_i32 s75, s69, 14336
    s_add_u32 s75, s75, 100352
    s_add_u32 s78, s77, s64
    s_add_u32 s78, s78, 2048
    v_min_u32 v2, 27, v0
    v_lshlrev_b32 v236, 2, v2
    v_and_b32 v5, -3, v2
    v_and_b32 v3, 3, v0
    s_lshl_b32 s90, s4, 2
    v_add_u32 v3, s90, v3
    v_cmp_lt_u32 vcc, 31, v0
    s_nop 1
    v_cndmask_b32 v5, v5, v3, vcc
    v_lshlrev_b32 v5, 2, v5
    v_and_b32 v4, 1, v0
    v_lshl_add_u32 v4, v4, 1, s89
    v_lshlrev_b32 v4, 2, v4
    s_lshl_b32 s90, s4, 7
    s_add_u32 s67, s90, s64
    s_lshr_b32 s91, s69, 1
    s_lshl2_add_u32 s90, s4, s89
    s_lshl1_add_u32 s90, s90, s91
    s_lshl_b32 s90, s90, 11
    s_add_u32 s90, s90, s64
    s_add_u32 s66, s90, 131072
    s_waitcnt vmcnt(2)
    ds_read_b64_tr_b16 v[92:93], v9 offset:5120
    ds_read_b64_tr_b16 v[94:95], v9 offset:5376
    s_waitcnt vmcnt(1)
    ds_read_b64_tr_b16 v[96:97], v9 offset:6144
    ds_read_b64_tr_b16 v[98:99], v9 offset:6400
    s_waitcnt vmcnt(0)
    ds_read_b64_tr_b16 v[100:101], v9 offset:0
    ds_read_b64_tr_b16 v[102:103], v9 offset:256
    s_setprio 0
    s_mov_b32 s95, 0x400000
Lsp_76:
    ds_read_b32 v3, v6 offset:32
    s_waitcnt lgkmcnt(0)
    v_cmp_ne_u32 vcc, s6, v3
    s_cbranch_vccz Lspd_77
    s_sub_u32 s95, s95, 1
    s_cbranch_scc0 Lsp_76
Lspd_77:
    buffer_load_dwordx4 v[176:179], v11, s[56:59], 0 offen sc1
    s_add_u32 m0, s72, 1024
    s_add_u32 s73, s73, 86016
    buffer_load_dwordx4 v245, s[48:51], s73 offen  lds
    s_add_u32 m0, s72, 2048
    s_add_u32 s73, s73, 28672
    buffer_load_dwordx4 v245, s[48:51], s73 offen  lds
    s_add_u32 m0, s72, 3072
    s_add_u32 s73, s73, 86016
    buffer_load_dwordx4 v245, s[48:51], s73 offen  lds
    s_add_u32 m0, s72, 4096
    s_add_u32 s73, s73, 28672
    buffer_load_dwordx4 v245, s[48:51], s73 offen  lds
    s_add_u32 m0, s72, 5120
    s_add_u32 s73, s73, 86016
    buffer_load_dwordx4 v245, s[48:51], s73 offen  lds
    s_waitcnt vmcnt(4)
    ds_read_b64_tr_b16 v[104:105], v9 offset:1024
    ds_read_b64_tr_b16 v[106:107], v9 offset:1280
    s_add_u32 m0, s72, 6144
    s_add_u32 s73, s73, 28672
    buffer_load_dwordx4 v245, s[48:51], s73 offen  lds
    s_waitcnt vmcnt(4)
    ds_read_b64_tr_b16 v[108:109], v9 offset:2048
    ds_read_b64_tr_b16 v[110:111], v9 offset:2304
    s_mov_b32 s95, 0x400000
Lsp_78:
    ds_read_b32 v3, v6 offset:0
    s_waitcnt lgkmcnt(0)
    v_cmp_ne_u32 vcc, s6, v3
    s_cbranch_vccz Lspd_79
    s_sub_u32 s95, s95, 1
    s_cbranch_scc0 Lsp_78
Lspd_79:
    s_add_u32 m0, s76, 0
    s_nop 0
    buffer_load_dwordx4 v245, s[48:51], s79 offen  lds
    s_waitcnt vmcnt(4)
    ds_read_b64_tr_b16 v[112:113], v9 offset:3072
    ds_read_b64_tr_b16 v[114:115], v9 offset:3328
    s_add_u32 m0, s76, 1024
    s_add_u32 s79, s79, 28672
    buffer_load_dwordx4 v245, s[48:51], s79 offen  lds
    s_waitcnt vmcnt(4)
    ds_read_b64_tr_b16 v[116:117], v9 offset:4096
    ds_read_b64_tr_b16 v[118:119], v9 offset:4352
    s_add_u32 m0, s76, 2048
    s_add_u32 s79, s79, 86016
    buffer_load_dwordx4 v245, s[48:51], s79 offen  lds
    s_waitcnt vmcnt(4)
    ds_read_b64_tr_b16 v[120:121], v9 offset:5120
    ds_read_b64_tr_b16 v[122:123], v9 offset:5376
    s_add_u32 m0, s76, 3072
    s_add_u32 s79, s79, 28672
    buffer_load_dwordx4 v245, s[48:51], s79 offen  lds
    s_waitcnt vmcnt(4)
    ds_read_b64_tr_b16 v[124:125], v9 offset:6144
    ds_read_b64_tr_b16 v[126:127], v9 offset:6400
    s_add_u32 m0, s76, 4096
    s_add_u32 s79, s79, 86016
    buffer_load_dwordx4 v245, s[48:51], s79 offen  lds
    s_waitcnt vmcnt(4)
    s_add_u32 m0, s76, 5120
    s_add_u32 s79, s79, 28672
    buffer_load_dwordx4 v245, s[48:51], s79 offen  lds
    s_waitcnt vmcnt(4)
    s_add_u32 m0, s76, 6144
    s_add_u32 s79, s79, 86016
    buffer_load_dwordx4 v245, s[48:51], s79 offen  lds
    s_waitcnt vmcnt(4)
    s_add_u32 m0, s76, 7168
    s_add_u32 s79, s79, 28672
    buffer_load_dwordx4 v245, s[48:51], s79 offen  lds
    s_waitcnt vmcnt(4)
    s_add_u32 m0, s76, 8192
    s_add_u32 s79, s79, 86016
    buffer_load_dwordx4 v245, s[48:51], s79 offen  lds
    s_waitcnt vmcnt(4)
    s_add_u32 m0, s77, 4096
    s_add_u32 s79, s79, 28672
    buffer_load_dwordx4 v245, s[48:51], s79 offen  lds
    s_waitcnt vmcnt(4)
    s_add_u32 m0, s77, 5120
    s_add_u32 s79, s79, 86016
    buffer_load_dwordx4 v245, s[48:51], s79 offen  lds
    s_waitcnt vmcnt(4)
    s_add_u32 m0, s77, 6144
    s_add_u32 s79, s79, 28672
    buffer_load_dwordx4 v245, s[48:51], s79 offen  lds
    v_cmp_ne_u32 vcc, s6, v179
    s_cbranch_vccnz Lre_80
Lreb_81:
    v_mov_b32 v179, v252
    s_setprio 2
    s_mov_b32 s95, 0x40000
Lpoll_83:
    buffer_load_dword v3, v5, s[56:59], s64 offen offset:128 sc1
    s_waitcnt vmcnt(0)
    v_cmp_ne_u32 vcc, s6, v3
    s_cbranch_vccz Lgot_84
    s_sub_u32 s95, s95, 1
    s_cbranch_scc0 Lpoll_83
Lgot_84:
    s_add_u32 m0, s75, 0
    s_nop 0
    buffer_load_dwordx4 v15, s[56:59], s78 offen offset:0 sc1 lds
    buffer_load_dwordx4 v15, s[56:59], s78 offen offset:1024 sc1 lds
    buffer_load_dwordx4 v15, s[56:59], s78 offen offset:2048 sc1 lds
    buffer_load_dwordx4 v15, s[56:59], s78 offen offset:3072 sc1 lds
    s_add_u32 m0, s75, 4096
    s_add_u32 s78, s78, 4096
    buffer_load_dwordx4 v15, s[56:59], s78 offen offset:0 sc1 lds
    buffer_load_dwordx4 v15, s[56:59], s78 offen offset:1024 sc1 lds
    buffer_load_dwordx4 v15, s[56:59], s78 offen offset:2048 sc1 lds
    s_waitcnt vmcnt(0) lgkmcnt(0)
    s_barrier
    buffer_load_dword v3, v236, s[56:59], s64 offen offset:128 sc1
    ds_read_b128 v[128:131], v224 offset:0
    ds_read_b128 v[132:135], v224 offset:1024
    ds_read_b128 v[136:139], v224 offset:2048
    ds_read_b128 v[140:143], v224 offset:3072
    ds_read_b128 v[144:147], v224 offset:4096
    s_waitcnt lgkmcnt(4)
    v_mfma_f32_32x32x16_bf16 v[148:163], v[16:19], v[128:131], 0
    ds_read_b128 v[128:131], v224 offset:5120
    s_waitcnt lgkmcnt(4)
    v_mfma_f32_32x32x16_bf16 v[148:163], v[20:23], v[132:135], v[148:163]
    ds_read_b128 v[132:135], v224 offset:6144
    s_waitcnt lgkmcnt(4)
    v_mfma_f32_32x32x16_bf16 v[148:163], v[24:27], v[136:139], v[148:163]
    ds_read_b128 v[136:139], v224 offset:14336
    s_waitcnt lgkmcnt(4)
    v_mfma_f32_32x32x16_bf16 v[148:163], v[28:31], v[140:143], v[148:163]
    ds_read_b128 v[140:143], v224 offset:15360
    s_waitcnt lgkmcnt(4)
    v_mfma_f32_32x32x16_bf16 v[148:163], v[32:35], v[144:147], v[148:163]
    ds_read_b128 v[144:147], v224 offset:16384
    s_waitcnt lgkmcnt(4)
    v_mfma_f32_32x32x16_bf16 v[148:163], v[36:39], v[128:131], v[148:163]
    ds_read_b128 v[128:131], v224 offset:17408
    s_waitcnt lgkmcnt(4)
    v_mfma_f32_32x32x16_bf16 v[148:163], v[40:43], v[132:135], v[148:163]
    ds_read_b128 v[132:135], v224 offset:18432
    s_waitcnt lgkmcnt(4)
    v_mfma_f32_32x32x16_bf16 v[148:163], v[44:47], v[136:139], v[148:163]
    ds_read_b128 v[136:139], v224 offset:19456
    s_waitcnt lgkmcnt(4)
    v_mfma_f32_32x32x16_bf16 v[148:163], v[48:51], v[140:143], v[148:163]
    ds_read_b128 v[140:143], v224 offset:20480
    s_waitcnt lgkmcnt(4)
    v_mfma_f32_32x32x16_bf16 v[148:163], v[52:55], v[144:147], v[148:163]
    ds_read_b128 v[144:147], v224 offset:28672
    s_waitcnt lgkmcnt(4)
    v_mfma_f32_32x32x16_bf16 v[148:163], v[56:59], v[128:131], v[148:163]
    ds_read_b128 v[128:131], v224 offset:29696
    s_waitcnt lgkmcnt(4)
    v_mfma_f32_32x32x16_bf16 v[148:163], v[60:63], v[132:135], v[148:163]
    s_waitcnt vmcnt(0)
    v_cmp_ne_u32 vcc, s6, v3
    s_cbranch_vccnz Lre_85
Lreb_86:
    ds_read_b128 v[132:135], v224 offset:30720
    s_waitcnt lgkmcnt(4)
    v_mfma_f32_32x32x16_bf16 v[148:163], v[64:67], v[136:139], v[148:163]
    s_add_u32 m0, s75, 7168
    s_add_u32 s78, s78, 24576
    buffer_load_dwordx4 v15, s[56:59], s78 offen offset:0 sc1 lds
    ds_read_b128 v[136:139], v224 offset:31744
    s_waitcnt lgkmcnt(4)
    v_mfma_f32_32x32x16_bf16 v[148:163], v[68:71], v[140:143], v[148:163]
    ds_read_b128 v[140:143], v224 offset:32768
    s_waitcnt lgkmcnt(4)
    v_mfma_f32_32x32x16_bf16 v[148:163], v[72:75], v[144:147], v[148:163]
    buffer_load_dwordx4 v15, s[56:59], s78 offen offset:1024 sc1 lds
    ds_read_b128 v[144:147], v224 offset:33792
    s_waitcnt lgkmcnt(4)
    v_mfma_f32_32x32x16_bf16 v[148:163], v[76:79], v[128:131], v[148:163]
    ds_read_b128 v[128:131], v224 offset:34816
    s_waitcnt lgkmcnt(4)
    v_mfma_f32_32x32x16_bf16 v[148:163], v[80:83], v[132:135], v[148:163]
    buffer_load_dwordx4 v15, s[56:59], s78 offen offset:2048 sc1 lds
    ds_read_b128 v[132:135], v224 offset:43008
    s_waitcnt lgkmcnt(4)
    v_mfma_f32_32x32x16_bf16 v[148:163], v[84:87], v[136:139], v[148:163]
    ds_read_b128 v[136:139], v224 offset:44032
    s_waitcnt lgkmcnt(4)
    v_mfma_f32_32x32x16_bf16 v[148:163], v[88:91], v[140:143], v[148:163]
    buffer_load_dwordx4 v15, s[56:59], s78 offen offset:3072 sc1 lds
    ds_read_b128 v[140:143], v224 offset:45056
    s_waitcnt lgkmcnt(4)
    v_mfma_f32_32x32x16_bf16 v[148:163], v[92:95], v[144:147], v[148:163]
    ds_read_b128 v[144:147], v224 offset:46080
    s_waitcnt lgkmcnt(4)
    v_mfma_f32_32x32x16_bf16 v[148:163], v[96:99], v[128:131], v[148:163]
    s_add_u32 m0, s75, 11264
    s_add_u32 s78, s78, 4096
    buffer_load_dwordx4 v15, s[56:59], s78 offen offset:0 sc1 lds
    ds_read_b128 v[128:131], v224 offset:47104
    s_waitcnt lgkmcnt(4)
    v_mfma_f32_32x32x16_bf16 v[148:163], v[100:103], v[132:135], v[148:163]
    ds_read_b128 v[132:135], v224 offset:48128
    s_waitcnt lgkmcnt(4)
    v_mfma_f32_32x32x16_bf16 v[148:163], v[104:107], v[136:139], v[148:163]
    buffer_load_dwordx4 v15, s[56:59], s78 offen offset:1024 sc1 lds
    ds_read_b128 v[136:139], v224 offset:49152
    s_waitcnt lgkmcnt(4)
    v_mfma_f32_32x32x16_bf16 v[148:163], v[108:111], v[140:143], v[148:163]
    s_waitcnt lgkmcnt(3)
    v_mfma_f32_32x32x16_bf16 v[148:163], v[112:115], v[144:147], v[148:163]
    buffer_load_dwordx4 v15, s[56:59], s78 offen offset:2048 sc1 lds
    s_waitcnt lgkmcnt(2)
    v_mfma_f32_32x32x16_bf16 v[148:163], v[116:119], v[128:131], v[148:163]
    s_waitcnt lgkmcnt(1)
    v_mfma_f32_32x32x16_bf16 v[148:163], v[120:123], v[132:135], v[148:163]
    s_waitcnt lgkmcnt(0)
    v_mfma_f32_32x32x16_bf16 v[148:163], v[124:127], v[136:139], v[148:163]
    s_barrier
    ds_read_b128 v[180:183], v226
    ds_read_b128 v[164:167], v227
    s_waitcnt lgkmcnt(1)
    v_mfma_f32_32x32x16_bf16 v[148:163], v[176:179], v[180:183], v[148:163]
    ds_read_b128 v[184:187], v226 offset:1024
    ds_read_b128 v[168:171], v227 offset:512
    s_nop 8
    s_waitcnt lgkmcnt(2)
    v_mul_f32 v200, v148, v148
    v_mul_f32 v201, v149, v149
    v_mul_f32 v202, v150, v150
    v_mul_f32 v203, v151, v151
    v_mul_f32 v204, v152, v152
    v_mul_f32 v205, v153, v153
    v_mul_f32 v206, v154, v154
    v_mul_f32 v207, v155, v155
    v_mul_f32 v208, v156, v156
    v_mul_f32 v209, v157, v157
    v_mul_f32 v210, v158, v158
    v_mul_f32 v211, v159, v159
    v_mul_f32 v212, v160, v160
    v_mul_f32 v213, v161, v161
    v_mul_f32 v214, v162, v162
    v_mul_f32 v215, v163, v163
    v_fma_f32 v200, v200, v165, v164
    v_fma_f32 v201, v201, v165, v164
    v_fma_f32 v202, v202, v165, v164
    v_fma_f32 v203, v203, v165, v164
    v_fma_f32 v204, v204, v165, v164
    v_fma_f32 v205, v205, v165, v164
    v_fma_f32 v206, v206, v165, v164
    v_fma_f32 v207, v207, v165, v164
    v_fma_f32 v208, v208, v165, v164
    v_fma_f32 v209, v209, v165, v164
    v_fma_f32 v210, v210, v165, v164
    v_fma_f32 v211, v211, v165, v164
    v_fma_f32 v212, v212, v165, v164
    v_fma_f32 v213, v213, v165, v164
    v_fma_f32 v214, v214, v165, v164
    v_fma_f32 v215, v215, v165, v164
    v_mul_f32 v200, v200, v148
    v_mul_f32 v201, v201, v149
    v_mul_f32 v202, v202, v150
    v_mul_f32 v203, v203, v151
    v_mul_f32 v204, v204, v152
    v_mul_f32 v205, v205, v153
    v_mul_f32 v206, v206, v154
    v_mul_f32 v207, v207, v155
    v_mul_f32 v208, v208, v156
    v_mul_f32 v209, v209, v157
    v_mul_f32 v210, v210, v158
    v_mul_f32 v211, v211, v159
    v_mul_f32 v212, v212, v160
    v_mul_f32 v213, v213, v161
    v_mul_f32 v214, v214, v162
    v_mul_f32 v215, v215, v163
    v_exp_f32 v200, v200
    v_exp_f32 v201, v201
    v_exp_f32 v202, v202
    v_exp_f32 v203, v203
    v_exp_f32 v204, v204
    v_exp_f32 v205, v205
    v_exp_f32 v206, v206
    v_exp_f32 v207, v207
    v_exp_f32 v208, v208
    v_exp_f32 v209, v209
    v_exp_f32 v210, v210
    v_exp_f32 v211, v211
    v_exp_f32 v212, v212
    v_exp_f32 v213, v213
    v_exp_f32 v214, v214
    v_exp_f32 v215, v215
    v_fma_f32 v200, v200, v166, v166
    v_fma_f32 v201, v201, v166, v166
    v_fma_f32 v202, v202, v166, v166
    v_fma_f32 v203, v203, v166, v166
    v_fma_f32 v204, v204, v166, v166
    v_fma_f32 v205, v205, v166, v166
    v_fma_f32 v206, v206, v166, v166
    v_fma_f32 v207, v207, v166, v166
    v_fma_f32 v208, v208, v166, v166
    v_fma_f32 v209, v209, v166, v166
    v_fma_f32 v210, v210, v166, v166
    v_fma_f32 v211, v211, v166, v166
    v_fma_f32 v212, v212, v166, v166
    v_fma_f32 v213, v213, v166, v166
    v_fma_f32 v214, v214, v166, v166
    v_fma_f32 v215, v215, v166, v166
    v_rcp_f32 v200, v200
    v_rcp_f32 v201, v201
    v_rcp_f32 v202, v202
    v_rcp_f32 v203, v203
    v_rcp_f32 v204, v204
    v_rcp_f32 v205, v205
    v_rcp_f32 v206, v206
    v_rcp_f32 v207, v207
    v_rcp_f32 v208, v208
    v_rcp_f32 v209, v209
    v_rcp_f32 v210, v210
    v_rcp_f32 v211, v211
    v_rcp_f32 v212, v212
    v_rcp_f32 v213, v213
    v_rcp_f32 v214, v214
    v_rcp_f32 v215, v215
    v_mul_f32 v200, v200, v148
    v_mul_f32 v201, v201, v149
    v_mul_f32 v202, v202, v150
    v_mul_f32 v203, v203, v151
    v_mul_f32 v204, v204, v152
    v_mul_f32 v205, v205, v153
    v_mul_f32 v206, v206, v154
    v_mul_f32 v207, v207, v155
    v_mul_f32 v208, v208, v156
    v_mul_f32 v209, v209, v157
    v_mul_f32 v210, v210, v158
    v_mul_f32 v211, v211, v159
    v_mul_f32 v212, v212, v160
    v_mul_f32 v213, v213, v161
    v_mul_f32 v214, v214, v162
    v_mul_f32 v215, v215, v163
    v_cvt_pk_bf16_f32 v148, v200, v201
    v_cvt_pk_bf16_f32 v149, v202, v203
    v_cvt_pk_bf16_f32 v150, v204, v205
    v_cvt_pk_bf16_f32 v151, v206, v207
    ds_write_b128 v225, v[148:151] offset:0
    v_cvt_pk_bf16_f32 v152, v208, v209
    v_cvt_pk_bf16_f32 v153, v210, v211
    v_cvt_pk_bf16_f32 v154, v212, v213
    v_cvt_pk_bf16_f32 v155, v214, v215
    ds_write_b128 v225, v[152:155] offset:1024
    s_waitcnt vmcnt(0)
    s_barrier
    s_cmp_lg_u32 s7, 0
    s_cbranch_scc1 Lslow_88
    s_mov_b64 exec, 1
    buffer_store_dword v251, off, s[56:59], s83 offset:1152
    s_mov_b64 exec, -1
Lback_89:
    ds_read_b128 v[128:131], v224 offset:7168
    ds_read_b128 v[132:135], v224 offset:8192
    ds_read_b128 v[136:139], v224 offset:9216
    ds_read_b128 v[140:143], v224 offset:10240
    ds_read_b128 v[144:147], v224 offset:11264
    s_waitcnt lgkmcnt(4)
    v_mfma_f32_32x32x16_bf16 v[148:163], v[16:19], v[128:131], 0
    s_add_u32 m0, s76, 0
    s_nop 0
    buffer_load_dwordx4 v233, s[52:55], s80 offen  lds
    ds_read_b128 v[128:131], v224 offset:12288
    s_waitcnt lgkmcnt(4)
    v_mfma_f32_32x32x16_bf16 v[148:163], v[20:23], v[132:135], v[148:163]
    ds_read_b128 v[132:135], v224 offset:13312
    s_waitcnt lgkmcnt(4)
    v_mfma_f32_32x32x16_bf16 v[148:163], v[24:27], v[136:139], v[148:163]
    ds_read_b128 v[136:139], v224 offset:21504
    s_waitcnt lgkmcnt(4)
    v_mfma_f32_32x32x16_bf16 v[148:163], v[28:31], v[140:143], v[148:163]
    s_add_u32 m0, s76, 1024
    s_add_u32 s80, s80, 14336
    buffer_load_dwordx4 v233, s[52:55], s80 offen  lds
    ds_read_b128 v[140:143], v224 offset:22528
    s_waitcnt lgkmcnt(4)
    v_mfma_f32_32x32x16_bf16 v[148:163], v[32:35], v[144:147], v[148:163]
    ds_read_b128 v[144:147], v224 offset:23552
    s_waitcnt lgkmcnt(4)
    v_mfma_f32_32x32x16_bf16 v[148:163], v[36:39], v[128:131], v[148:163]
    ds_read_b128 v[128:131], v224 offset:24576
    s_waitcnt lgkmcnt(4)
    v_mfma_f32_32x32x16_bf16 v[148:163], v[40:43], v[132:135], v[148:163]
    s_add_u32 m0, s76, 2048
    s_add_u32 s80, s80, 14336
    buffer_load_dwordx4 v233, s[52:55], s80 offen  lds
    ds_read_b128 v[132:135], v224 offset:25600
    s_waitcnt lgkmcnt(4)
    v_mfma_f32_32x32x16_bf16 v[148:163], v[44:47], v[136:139], v[148:163]
    ds_read_b128 v[136:139], v224 offset:26624
    s_waitcnt lgkmcnt(4)
    v_mfma_f32_32x32x16_bf16 v[148:163], v[48:51], v[140:143], v[148:163]
    ds_read_b128 v[140:143], v224 offset:27648
    s_waitcnt lgkmcnt(4)
    v_mfma_f32_32x32x16_bf16 v[148:163], v[52:55], v[144:147], v[148:163]
    s_add_u32 m0, s76, 3072
    s_add_u32 s80, s80, 14336
    buffer_load_dwordx4 v233, s[52:55], s80 offen  lds
    ds_read_b128 v[144:147], v224 offset:35840
    s_waitcnt lgkmcnt(4)
    v_mfma_f32_32x32x16_bf16 v[148:163], v[56:59], v[128:131], v[148:163]
    ds_read_b128 v[128:131], v224 offset:36864
    s_waitcnt lgkmcnt(4)
    v_mfma_f32_32x32x16_bf16 v[148:163], v[60:63], v[132:135], v[148:163]
    ds_read_b128 v[132:135], v224 offset:37888
    s_waitcnt lgkmcnt(4)
    v_mfma_f32_32x32x16_bf16 v[148:163], v[64:67], v[136:139], v[148:163]
    s_add_u32 m0, s76, 4096
    s_add_u32 s80, s80, 14336
    buffer_load_dwordx4 v233, s[52:55], s80 offen  lds
    ds_read_b128 v[136:139], v224 offset:38912
    s_waitcnt lgkmcnt(4)
    v_mfma_f32_32x32x16_bf16 v[148:163], v[68:71], v[140:143], v[148:163]
    ds_read_b128 v[140:143], v224 offset:39936
    s_waitcnt lgkmcnt(4)
    v_mfma_f32_32x32x16_bf16 v[148:163], v[72:75], v[144:147], v[148:163]
    ds_read_b128 v[144:147], v224 offset:40960
    s_waitcnt lgkmcnt(4)
    v_mfma_f32_32x32x16_bf16 v[148:163], v[76:79], v[128:131], v[148:163]
    s_add_u32 m0, s76, 5120
    s_add_u32 s80, s80, 14336
    buffer_load_dwordx4 v233, s[52:55], s80 offen  lds
    ds_read_b128 v[128:131], v224 offset:41984
    s_waitcnt lgkmcnt(4)
    v_mfma_f32_32x32x16_bf16 v[148:163], v[80:83], v[132:135], v[148:163]
    ds_read_b128 v[132:135], v224 offset:50176
    s_waitcnt lgkmcnt(4)
    v_mfma_f32_32x32x16_bf16 v[148:163], v[84:87], v[136:139], v[148:163]
    ds_read_b128 v[136:139], v224 offset:51200
    s_waitcnt lgkmcnt(4)
    v_mfma_f32_32x32x16_bf16 v[148:163], v[88:91], v[140:143], v[148:163]
    s_add_u32 m0, s76, 6144
    s_add_u32 s80, s80, 14336
    buffer_load_dwordx4 v233, s[52:55], s80 offen  lds
    ds_read_b128 v[140:143], v224 offset:52224
    s_waitcnt lgkmcnt(4)
    v_mfma_f32_32x32x16_bf16 v[148:163], v[92:95], v[144:147], v[148:163]
    ds_read_b128 v[144:147], v224 offset:53248
    s_waitcnt lgkmcnt(4)
    v_mfma_f32_32x32x16_bf16 v[148:163], v[96:99], v[128:131], v[148:163]
    ds_read_b128 v[128:131], v224 offset:54272
    s_waitcnt lgkmcnt(4)
    v_mfma_f32_32x32x16_bf16 v[148:163], v[100:103], v[132:135], v[148:163]
    s_add_u32 m0, s76, 7168
    s_add_u32 s80, s80, 14336
    buffer_load_dwordx4 v233, s[52:55], s80 offen  lds
    ds_read_b128 v[132:135], v224 offset:55296
    s_waitcnt lgkmcnt(4)
    v_mfma_f32_32x32x16_bf16 v[148:163], v[104:107], v[136:139], v[148:163]
    ds_read_b128 v[136:139], v224 offset:56320
    s_waitcnt lgkmcnt(4)
    v_mfma_f32_32x32x16_bf16 v[148:163], v[108:111], v[140:143], v[148:163]
    s_waitcnt lgkmcnt(3)
    v_mfma_f32_32x32x16_bf16 v[148:163], v[112:115], v[144:147], v[148:163]
    s_add_u32 m0, s76, 8192
    s_add_u32 s80, s80, 14336
    buffer_load_dwordx4 v233, s[52:55], s80 offen  lds
    s_waitcnt lgkmcnt(2)
    v_mfma_f32_32x32x16_bf16 v[148:163], v[116:119], v[128:131], v[148:163]
    s_waitcnt lgkmcnt(1)
    v_mfma_f32_32x32x16_bf16 v[148:163], v[120:123], v[132:135], v[148:163]
    s_waitcnt lgkmcnt(0)
    v_mfma_f32_32x32x16_bf16 v[148:163], v[124:127], v[136:139], v[148:163]
    s_add_u32 m0, s77, 0
    s_add_u32 s80, s80, 14336
    buffer_load_dwordx4 v233, s[52:55], s80 offen  lds
    v_mfma_f32_32x32x16_bf16 v[148:163], v[176:179], v[184:187], v[148:163]
    s_nop 8
    s_add_u32 m0, s77, 1024
    s_add_u32 s80, s80, 14336
    buffer_load_dwordx4 v233, s[52:55], s80 offen  lds
    v_mul_f32 v200, v148, v148
    v_mul_f32 v201, v149, v149
    v_mul_f32 v202, v150, v150
    v_mul_f32 v203, v151, v151
    v_mul_f32 v204, v152, v152
    v_mul_f32 v205, v153, v153
    v_mul_f32 v206, v154, v154
    v_mul_f32 v207, v155, v155
    v_mul_f32 v208, v156, v156
    v_mul_f32 v209, v157, v157
    v_mul_f32 v210, v158, v158
    s_add_u32 m0, s77, 2048
    s_add_u32 s80, s80, 14336
    buffer_load_dwordx4 v233, s[52:55], s80 offen  lds
    v_mul_f32 v211, v159, v159
    v_mul_f32 v212, v160, v160
    v_mul_f32 v213, v161, v161
    v_mul_f32 v214, v162, v162
    v_mul_f32 v215, v163, v163
    v_fma_f32 v200, v200, v169, v168
    v_fma_f32 v201, v201, v169, v168
    v_fma_f32 v202, v202, v169, v168
    v_fma_f32 v203, v203, v169, v168
    v_fma_f32 v204, v204, v169, v168
    v_fma_f32 v205, v205, v169, v168
    s_add_u32 m0, s77, 3072
    s_add_u32 s80, s80, 14336
    buffer_load_dwordx4 v233, s[52:55], s80 offen  lds
    v_fma_f32 v206, v206, v169, v168
    v_fma_f32 v207, v207, v169, v168
    v_fma_f32 v208, v208, v169, v168
    v_fma_f32 v209, v209, v169, v168
    v_fma_f32 v210, v210, v169, v168
    v_fma_f32 v211, v211, v169, v168
    v_fma_f32 v212, v212, v169, v168
    v_fma_f32 v213, v213, v169, v168
    v_fma_f32 v214, v214, v169, v168
    v_fma_f32 v215, v215, v169, v168
    v_mul_f32 v200, v200, v148
    s_add_u32 m0, s77, 4096
    s_add_u32 s80, s80, 14336
    buffer_load_dwordx4 v233, s[52:55], s80 offen  lds
    v_mul_f32 v201, v201, v149
    v_mul_f32 v202, v202, v150
    v_mul_f32 v203, v203, v151
    v_mul_f32 v204, v204, v152
    v_mul_f32 v205, v205, v153
    v_mul_f32 v206, v206, v154
    v_mul_f32 v207, v207, v155
    v_mul_f32 v208, v208, v156
    v_mul_f32 v209, v209, v157
    v_mul_f32 v210, v210, v158
    v_mul_f32 v211, v211, v159
    s_add_u32 m0, s77, 5120
    s_add_u32 s80, s80, 14336
    buffer_load_dwordx4 v233, s[52:55], s80 offen  lds
    v_mul_f32 v212, v212, v160
    v_mul_f32 v213, v213, v161
    v_mul_f32 v214, v214, v162
    v_mul_f32 v215, v215, v163
    v_exp_f32 v200, v200
    v_exp_f32 v201, v201
    v_exp_f32 v202, v202
    v_exp_f32 v203, v203
    v_exp_f32 v204, v204
    v_exp_f32 v205, v205
    v_exp_f32 v206, v206
    s_add_u32 m0, s77, 6144
    s_add_u32 s80, s80, 14336
    buffer_load_dwordx4 v233, s[52:55], s80 offen  lds
    v_exp_f32 v207, v207
    v_exp_f32 v208, v208
    v_exp_f32 v209, v209
    v_exp_f32 v210, v210
    v_exp_f32 v211, v211
    v_exp_f32 v212, v212
    v_exp_f32 v213, v213
    v_exp_f32 v214, v214
    v_exp_f32 v215, v215
    v_fma_f32 v200, v200, v170, v170
    v_fma_f32 v201, v201, v170, v170
    s_waitcnt vmcnt(15)
    ds_read_b64_tr_b16 v[16:17], v234 offset:0
    ds_read_b64_tr_b16 v[18:19], v234 offset:256
    s_waitcnt vmcnt(14)
    ds_read_b64_tr_b16 v[20:21], v234 offset:1024
    ds_read_b64_tr_b16 v[22:23], v234 offset:1280
    v_fma_f32 v202, v202, v170, v170
    v_fma_f32 v203, v203, v170, v170
    v_fma_f32 v204, v204, v170, v170
    v_fma_f32 v205, v205, v170, v170
    v_fma_f32 v206, v206, v170, v170
    v_fma_f32 v207, v207, v170, v170
    v_fma_f32 v208, v208, v170, v170
    v_fma_f32 v209, v209, v170, v170
    v_fma_f32 v210, v210, v170, v170
    v_fma_f32 v211, v211, v170, v170
    v_fma_f32 v212, v212, v170, v170
    s_waitcnt vmcnt(13)
    ds_read_b64_tr_b16 v[24:25], v234 offset:2048
    ds_read_b64_tr_b16 v[26:27], v234 offset:2304
    s_waitcnt vmcnt(12)
    ds_read_b64_tr_b16 v[28:29], v234 offset:3072
    ds_read_b64_tr_b16 v[30:31], v234 offset:3328
    v_fma_f32 v213, v213, v170, v170
    v_fma_f32 v214, v214, v170, v170
    v_fma_f32 v215, v215, v170, v170
    v_rcp_f32 v200, v200
    v_rcp_f32 v201, v201
    v_rcp_f32 v202, v202
    v_rcp_f32 v203, v203
    v_rcp_f32 v204, v204
    v_rcp_f32 v205, v205
    v_rcp_f32 v206, v206
    v_rcp_f32 v207, v207
    s_waitcnt vmcnt(11)
    ds_read_b64_tr_b16 v[32:33], v234 offset:4096
    ds_read_b64_tr_b16 v[34:35], v234 offset:4352
    s_waitcnt vmcnt(10)
    ds_read_b64_tr_b16 v[36:37], v234 offset:5120
    ds_read_b64_tr_b16 v[38:39], v234 offset:5376
    v_rcp_f32 v208, v208
    v_rcp_f32 v209, v209
    v_rcp_f32 v210, v210
    v_rcp_f32 v211, v211
    v_rcp_f32 v212, v212
    v_rcp_f32 v213, v213
    v_rcp_f32 v214, v214
    v_rcp_f32 v215, v215
    v_mul_f32 v200, v200, v148
    v_mul_f32 v201, v201, v149
    v_mul_f32 v202, v202, v150
    s_waitcnt vmcnt(9)
    ds_read_b64_tr_b16 v[40:41], v234 offset:6144
    ds_read_b64_tr_b16 v[42:43], v234 offset:6400
    s_waitcnt vmcnt(8)
    ds_read_b64_tr_b16 v[44:45], v234 offset:7168
    ds_read_b64_tr_b16 v[46:47], v234 offset:7424
    v_mul_f32 v203, v203, v151
    v_mul_f32 v204, v204, v152
    v_mul_f32 v205, v205, v153
    v_mul_f32 v206, v206, v154
    v_mul_f32 v207, v207, v155
    v_mul_f32 v208, v208, v156
    v_mul_f32 v209, v209, v157
    v_mul_f32 v210, v210, v158
    v_mul_f32 v211, v211, v159
    v_mul_f32 v212, v212, v160
    v_mul_f32 v213, v213, v161
    v_mul_f32 v214, v214, v162
    v_mul_f32 v215, v215, v163
    v_cvt_pk_bf16_f32 v148, v200, v201
    v_cvt_pk_bf16_f32 v149, v202, v203
    v_cvt_pk_bf16_f32 v150, v204, v205
    v_cvt_pk_bf16_f32 v151, v206, v207
    ds_write_b128 v225, v[148:151] offset:16384
    v_cvt_pk_bf16_f32 v152, v208, v209
    v_cvt_pk_bf16_f32 v153, v210, v211
    v_cvt_pk_bf16_f32 v154, v212, v213
    v_cvt_pk_bf16_f32 v155, v214, v215
    ds_write_b128 v225, v[152:155] offset:17408
    s_waitcnt lgkmcnt(0)
    s_barrier
    ds_read_b128 v[128:131], v228 offset:0
    ds_read_b128 v[132:135], v228 offset:1024
    ds_read_b128 v[136:139], v228 offset:2048
    ds_read_b128 v[140:143], v228 offset:3072
    ds_read_b128 v[144:147], v228 offset:4096
    s_waitcnt lgkmcnt(4)
    v_mfma_f32_32x32x16_bf16 v[80:95], v[16:19], v[128:131], 0
    ds_read_b128 v[128:131], v228 offset:5120
    s_waitcnt lgkmcnt(4)
    v_mfma_f32_32x32x16_bf16 v[80:95], v[20:23], v[132:135], v[80:95]
    s_add_u32 m0, s76, 0
    s_nop 0
    buffer_load_dwordx4 v233, s[52:55], s84 offen  lds
    ds_read_b128 v[132:135], v228 offset:6144
    s_waitcnt lgkmcnt(4)
    v_mfma_f32_32x32x16_bf16 v[80:95], v[24:27], v[136:139], v[80:95]
    ds_read_b128 v[136:139], v228 offset:7168
    s_waitcnt lgkmcnt(4)
    v_mfma_f32_32x32x16_bf16 v[80:95], v[28:31], v[140:143], v[80:95]
    s_add_u32 m0, s76, 1024
    s_add_u32 s84, s84, 14336
    buffer_load_dwordx4 v233, s[52:55], s84 offen  lds
    s_waitcnt vmcnt(9)
    ds_read_b64_tr_b16 v[48:49], v234 offset:8192
    ds_read_b64_tr_b16 v[50:51], v234 offset:8448
    ds_read_b128 v[140:143], v228 offset:8192
    s_waitcnt lgkmcnt(6)
    v_mfma_f32_32x32x16_bf16 v[80:95], v[32:35], v[144:147], v[80:95]
    s_waitcnt vmcnt(8)
    ds_read_b64_tr_b16 v[52:53], v235 offset:0
    ds_read_b64_tr_b16 v[54:55], v235 offset:256
    ds_read_b128 v[144:147], v228 offset:9216
    s_waitcnt lgkmcnt(8)
    v_mfma_f32_32x32x16_bf16 v[80:95], v[36:39], v[128:131], v[80:95]
    s_add_u32 m0, s76, 2048
    s_add_u32 s84, s84, 14336
    buffer_load_dwordx4 v233, s[52:55], s84 offen  lds
    s_waitcnt vmcnt(8)
    ds_read_b64_tr_b16 v[56:57], v235 offset:1024
    ds_read_b64_tr_b16 v[58:59], v235 offset:1280
    ds_read_b128 v[128:131], v228 offset:10240
    s_waitcnt lgkmcnt(10)
    v_mfma_f32_32x32x16_bf16 v[80:95], v[40:43], v[132:135], v[80:95]
    s_waitcnt vmcnt(7)
    ds_read_b64_tr_b16 v[60:61], v235 offset:2048
    ds_read_b64_tr_b16 v[62:63], v235 offset:2304
    ds_read_b128 v[132:135], v228 offset:11264
    s_waitcnt lgkmcnt(12)
    v_mfma_f32_32x32x16_bf16 v[80:95], v[44:47], v[136:139], v[80:95]
    s_add_u32 m0, s76, 3072
    s_add_u32 s84, s84, 14336
    buffer_load_dwordx4 v233, s[52:55], s84 offen  lds
    s_waitcnt vmcnt(7)
    ds_read_b64_tr_b16 v[64:65], v235 offset:3072
    ds_read_b64_tr_b16 v[66:67], v235 offset:3328
    ds_read_b128 v[136:139], v228 offset:12288
    s_waitcnt lgkmcnt(12)
    v_mfma_f32_32x32x16_bf16 v[80:95], v[48:51], v[140:143], v[80:95]
    s_waitcnt vmcnt(6)
    ds_read_b64_tr_b16 v[68:69], v235 offset:4096
    ds_read_b64_tr_b16 v[70:71], v235 offset:4352
    ds_read_b128 v[140:143], v228 offset:13312
    s_waitcnt lgkmcnt(12)
    v_mfma_f32_32x32x16_bf16 v[80:95], v[52:55], v[144:147], v[80:95]
    s_add_u32 m0, s76, 4096
    s_add_u32 s84, s84, 14336
    buffer_load_dwordx4 v233, s[52:55], s84 offen  lds
    s_waitcnt vmcnt(6)
    ds_read_b64_tr_b16 v[72:73], v235 offset:5120
    ds_read_b64_tr_b16 v[74:75], v235 offset:5376
    ds_read_b128 v[144:147], v228 offset:14336
    s_waitcnt lgkmcnt(12)
    v_mfma_f32_32x32x16_bf16 v[80:95], v[56:59], v[128:131], v[80:95]
    s_waitcnt vmcnt(5)
    ds_read_b64_tr_b16 v[76:77], v235 offset:6144
    ds_read_b64_tr_b16 v[78:79], v235 offset:6400
    ds_read_b128 v[128:131], v228 offset:15360
    s_waitcnt lgkmcnt(12)
    v_mfma_f32_32x32x16_bf16 v[80:95], v[60:63], v[132:135], v[80:95]
    s_add_u32 m0, s76, 5120
    s_add_u32 s84, s84, 14336
    buffer_load_dwordx4 v233, s[52:55], s84 offen  lds
    ds_read_b128 v[132:135], v228 offset:24576
    s_waitcnt lgkmcnt(10)
    v_mfma_f32_32x32x16_bf16 v[80:95], v[64:67], v[136:139], v[80:95]
    ds_read_b128 v[136:139], v228 offset:25600
    s_waitcnt lgkmcnt(8)
    v_mfma_f32_32x32x16_bf16 v[80:95], v[68:71], v[140:143], v[80:95]
    s_add_u32 m0, s76, 6144
    s_add_u32 s84, s84, 14336
    buffer_load_dwordx4 v233, s[52:55], s84 offen  lds
    ds_read_b128 v[140:143], v228 offset:26624
    s_waitcnt lgkmcnt(6)
    v_mfma_f32_32x32x16_bf16 v[80:95], v[72:75], v[144:147], v[80:95]
    ds_read_b128 v[144:147], v228 offset:27648
    s_waitcnt lgkmcnt(4)
    v_mfma_f32_32x32x16_bf16 v[80:95], v[76:79], v[128:131], v[80:95]
    s_add_u32 m0, s76, 7168
    s_add_u32 s84, s84, 14336
    buffer_load_dwordx4 v233, s[52:55], s84 offen  lds
    ds_read_b128 v[128:131], v228 offset:28672
    s_waitcnt lgkmcnt(4)
    v_mfma_f32_32x32x16_bf16 v[96:111], v[48:51], v[132:135], 0
    ds_read_b128 v[132:135], v228 offset:29696
    s_waitcnt lgkmcnt(4)
    v_mfma_f32_32x32x16_bf16 v[96:111], v[52:55], v[136:139], v[96:111]
    s_add_u32 m0, s76, 8192
    s_add_u32 s84, s84, 14336
    buffer_load_dwordx4 v233, s[52:55], s84 offen  lds
    ds_read_b128 v[136:139], v228 offset:30720
    s_waitcnt lgkmcnt(4)
    v_mfma_f32_32x32x16_bf16 v[96:111], v[56:59], v[140:143], v[96:111]
    ds_read_b128 v[140:143], v228 offset:31744
    s_waitcnt lgkmcnt(4)
    v_mfma_f32_32x32x16_bf16 v[96:111], v[60:63], v[144:147], v[96:111]
    s_add_u32 m0, s77, 0
    s_add_u32 s84, s84, 14336
    buffer_load_dwordx4 v233, s[52:55], s84 offen  lds
    s_add_u32 m0, s77, 1024
    s_add_u32 s84, s84, 14336
    buffer_load_dwordx4 v233, s[52:55], s84 offen  lds
    s_add_u32 m0, s77, 2048
    s_add_u32 s84, s84, 14336
    buffer_load_dwordx4 v233, s[52:55], s84 offen  lds
    s_add_u32 m0, s77, 3072
    s_add_u32 s84, s84, 14336
    buffer_load_dwordx4 v233, s[52:55], s84 offen  lds
    s_add_u32 m0, s77, 4096
    s_add_u32 s84, s84, 14336
    buffer_load_dwordx4 v233, s[52:55], s84 offen  lds
    s_add_u32 m0, s77, 5120
    s_add_u32 s84, s84, 14336
    buffer_load_dwordx4 v233, s[52:55], s84 offen  lds
    s_add_u32 m0, s77, 6144
    s_add_u32 s84, s84, 14336
    buffer_load_dwordx4 v233, s[52:55], s84 offen  lds
    v_cvt_pk_bf16_f32 v112, v80, v81
    v_cvt_pk_bf16_f32 v113, v82, v83
    v_cvt_pk_bf16_f32 v114, v84, v85
    v_cvt_pk_bf16_f32 v115, v86, v87
    v_cvt_pk_bf16_f32 v116, v88, v89
    v_cvt_pk_bf16_f32 v117, v90, v91
    v_cvt_pk_bf16_f32 v118, v92, v93
    v_cvt_pk_bf16_f32 v119, v94, v95
    s_barrier
    ds_read_b128 v[144:147], v228 offset:16384
    s_waitcnt lgkmcnt(4)
    v_mfma_f32_32x32x16_bf16 v[96:111], v[64:67], v[128:131], v[96:111]
    ds_read_b128 v[128:131], v228 offset:17408
    s_waitcnt lgkmcnt(4)
    v_mfma_f32_32x32x16_bf16 v[96:111], v[68:71], v[132:135], v[96:111]
    ds_read_b128 v[132:135], v228 offset:18432
    s_waitcnt lgkmcnt(4)
    v_mfma_f32_32x32x16_bf16 v[96:111], v[72:75], v[136:139], v[96:111]
    ds_read_b128 v[136:139], v228 offset:19456
    s_waitcnt lgkmcnt(4)
    v_mfma_f32_32x32x16_bf16 v[96:111], v[76:79], v[140:143], v[96:111]
    ds_read_b128 v[140:143], v228 offset:20480
    s_waitcnt lgkmcnt(4)
    v_mfma_f32_32x32x16_bf16 v[96:111], v[16:19], v[144:147], v[96:111]
    ds_read_b128 v[144:147], v228 offset:21504
    s_waitcnt lgkmcnt(4)
    v_mfma_f32_32x32x16_bf16 v[96:111], v[20:23], v[128:131], v[96:111]
    ds_read_b128 v[128:131], v228 offset:22528
    s_waitcnt lgkmcnt(4)
    v_mfma_f32_32x32x16_bf16 v[96:111], v[24:27], v[132:135], v[96:111]
    ds_read_b128 v[132:135], v228 offset:23552
    s_waitcnt lgkmcnt(4)
    v_mfma_f32_32x32x16_bf16 v[96:111], v[28:31], v[136:139], v[96:111]
    ds_read_b128 v[136:139], v228 offset:0
    s_waitcnt lgkmcnt(4)
    v_mfma_f32_32x32x16_bf16 v[96:111], v[32:35], v[140:143], v[96:111]
    s_waitcnt vmcnt(15)
    ds_read_b64_tr_b16 v[148:149], v234 offset:0
    ds_read_b64_tr_b16 v[150:151], v234 offset:256
    ds_read_b128 v[140:143], v228 offset:1024
    s_waitcnt lgkmcnt(6)
    v_mfma_f32_32x32x16_bf16 v[96:111], v[36:39], v[144:147], v[96:111]
    s_waitcnt vmcnt(14)
    ds_read_b64_tr_b16 v[152:153], v234 offset:1024
    ds_read_b64_tr_b16 v[154:155], v234 offset:1280
    ds_read_b128 v[144:147], v228 offset:2048
    s_waitcnt lgkmcnt(8)
    v_mfma_f32_32x32x16_bf16 v[96:111], v[40:43], v[128:131], v[96:111]
    buffer_store_dwordx4 v[112:115], v15, s[56:59], s81 offen offset:0 sc1
    buffer_store_dwordx4 v[116:119], v15, s[56:59], s81 offen offset:1024 sc1
    s_waitcnt vmcnt(15)
    ds_read_b64_tr_b16 v[156:157], v234 offset:2048
    ds_read_b64_tr_b16 v[158:159], v234 offset:2304
    ds_read_b128 v[128:131], v228 offset:3072
    s_waitcnt lgkmcnt(10)
    v_mfma_f32_32x32x16_bf16 v[96:111], v[44:47], v[132:135], v[96:111]
    s_waitcnt vmcnt(14)
    ds_read_b64_tr_b16 v[160:161], v234 offset:3072
    ds_read_b64_tr_b16 v[162:163], v234 offset:3328
    ds_read_b128 v[132:135], v228 offset:4096
    s_waitcnt lgkmcnt(12)
    s_waitcnt lgkmcnt(10)
    v_mfma_f32_32x32x16_bf16 v[80:95], v[148:151], v[136:139], 0
    s_waitcnt vmcnt(13)
    ds_read_b64_tr_b16 v[164:165], v234 offset:4096
    ds_read_b64_tr_b16 v[166:167], v234 offset:4352
    ds_read_b128 v[136:139], v228 offset:5120
    s_waitcnt lgkmcnt(12)
    s_waitcnt lgkmcnt(10)
    v_mfma_f32_32x32x16_bf16 v[80:95], v[152:155], v[140:143], v[80:95]
    s_waitcnt vmcnt(12)
    ds_read_b64_tr_b16 v[168:169], v234 offset:5120
    ds_read_b64_tr_b16 v[170:171], v234 offset:5376
    ds_read_b128 v[140:143], v228 offset:6144
    s_waitcnt lgkmcnt(12)
    s_waitcnt lgkmcnt(10)
    v_mfma_f32_32x32x16_bf16 v[80:95], v[156:159], v[144:147], v[80:95]
    s_waitcnt vmcnt(11)
    ds_read_b64_tr_b16 v[172:173], v234 offset:6144
    ds_read_b64_tr_b16 v[174:175], v234 offset:6400
    v_cvt_pk_bf16_f32 v120, v96, v97
    v_cvt_pk_bf16_f32 v121, v98, v99
    v_cvt_pk_bf16_f32 v122, v100, v101
    v_cvt_pk_bf16_f32 v123, v102, v103
    v_cvt_pk_bf16_f32 v124, v104, v105
    v_cvt_pk_bf16_f32 v125, v106, v107
    v_cvt_pk_bf16_f32 v126, v108, v109
    v_cvt_pk_bf16_f32 v127, v110, v111
    buffer_store_dwordx4 v[120:123], v15, s[56:59], s81 offen offset:2048 sc1
    buffer_store_dwordx4 v[124:127], v15, s[56:59], s81 offen offset:3072 sc1
    ds_read_b128 v[144:147], v228 offset:7168
    s_waitcnt lgkmcnt(12)
    s_waitcnt lgkmcnt(10)
    v_mfma_f32_32x32x16_bf16 v[80:95], v[160:163], v[128:131], v[80:95]
    s_waitcnt vmcnt(12)
    ds_read_b64_tr_b16 v[176:177], v234 offset:7168
    ds_read_b64_tr_b16 v[178:179], v234 offset:7424
    ds_read_b128 v[128:131], v228 offset:8192
    s_waitcnt lgkmcnt(12)
    s_waitcnt lgkmcnt(10)
    v_mfma_f32_32x32x16_bf16 v[80:95], v[164:167], v[132:135], v[80:95]
    s_waitcnt vmcnt(11)
    ds_read_b64_tr_b16 v[180:181], v234 offset:8192
    ds_read_b64_tr_b16 v[182:183], v234 offset:8448
    ds_read_b128 v[132:135], v228 offset:9216
    s_waitcnt lgkmcnt(12)
    s_waitcnt lgkmcnt(10)
    v_mfma_f32_32x32x16_bf16 v[80:95], v[168:171], v[136:139], v[80:95]
    s_waitcnt vmcnt(10)
    ds_read_b64_tr_b16 v[184:185], v235 offset:0
    ds_read_b64_tr_b16 v[186:187], v235 offset:256
    ds_read_b128 v[136:139], v228 offset:10240
    s_waitcnt lgkmcnt(12)
    s_waitcnt lgkmcnt(10)
    v_mfma_f32_32x32x16_bf16 v[80:95], v[172:175], v[140:143], v[80:95]
    s_waitcnt vmcnt(9)
    ds_read_b64_tr_b16 v[188:189], v235 offset:1024
    ds_read_b64_tr_b16 v[190:191], v235 offset:1280
    ds_read_b128 v[140:143], v228 offset:11264
    s_waitcnt lgkmcnt(12)
    s_waitcnt lgkmcnt(10)
    v_mfma_f32_32x32x16_bf16 v[80:95], v[176:179], v[144:147], v[80:95]
    s_waitcnt vmcnt(8)
    ds_read_b64_tr_b16 v[192:193], v235 offset:2048
    ds_read_b64_tr_b16 v[194:195], v235 offset:2304
    ds_read_b128 v[144:147], v228 offset:12288
    s_waitcnt lgkmcnt(12)
    s_waitcnt lgkmcnt(10)
    v_mfma_f32_32x32x16_bf16 v[80:95], v[180:183], v[128:131], v[80:95]
    s_waitcnt vmcnt(7)
    ds_read_b64_tr_b16 v[196:197], v235 offset:3072
    ds_read_b64_tr_b16 v[198:199], v235 offset:3328
    ds_read_b128 v[128:131], v228 offset:13312
    s_waitcnt lgkmcnt(12)
    s_waitcnt lgkmcnt(10)
    v_mfma_f32_32x32x16_bf16 v[80:95], v[184:187], v[132:135], v[80:95]
    s_waitcnt vmcnt(6)
    ds_read_b64_tr_b16 v[200:201], v235 offset:4096
    ds_read_b64_tr_b16 v[202:203], v235 offset:4352
    ds_read_b128 v[132:135], v228 offset:14336
    s_waitcnt lgkmcnt(12)
    s_waitcnt lgkmcnt(10)
    v_mfma_f32_32x32x16_bf16 v[80:95], v[188:191], v[136:139], v[80:95]
    s_waitcnt vmcnt(5)
    ds_read_b64_tr_b16 v[204:205], v235 offset:5120
    ds_read_b64_tr_b16 v[206:207], v235 offset:5376
    ds_read_b128 v[136:139], v228 offset:15360
    s_waitcnt lgkmcnt(12)
    s_waitcnt lgkmcnt(10)
    v_mfma_f32_32x32x16_bf16 v[80:95], v[192:195], v[140:143], v[80:95]
    s_waitcnt vmcnt(4)
    ds_read_b64_tr_b16 v[208:209], v235 offset:6144
    ds_read_b64_tr_b16 v[210:211], v235 offset:6400
    ds_read_b128 v[140:143], v228 offset:16384
    s_waitcnt lgkmcnt(12)
    s_waitcnt lgkmcnt(10)
    v_mfma_f32_32x32x16_bf16 v[80:95], v[196:199], v[144:147], v[80:95]
    ds_read_b128 v[144:147], v228 offset:17408
    s_waitcnt lgkmcnt(10)
    s_waitcnt lgkmcnt(8)
    v_mfma_f32_32x32x16_bf16 v[80:95], v[200:203], v[128:131], v[80:95]
    ds_read_b128 v[128:131], v228 offset:18432
    s_waitcnt lgkmcnt(8)
    s_waitcnt lgkmcnt(6)
    v_mfma_f32_32x32x16_bf16 v[80:95], v[204:207], v[132:135], v[80:95]
    ds_read_b128 v[132:135], v228 offset:19456
    s_waitcnt lgkmcnt(6)
    s_waitcnt lgkmcnt(4)
    v_mfma_f32_32x32x16_bf16 v[80:95], v[208:211], v[136:139], v[80:95]
    ds_read_b128 v[136:139], v228 offset:20480
    s_waitcnt lgkmcnt(4)
    v_mfma_f32_32x32x16_bf16 v[96:111], v[148:151], v[140:143], 0
    ds_read_b128 v[140:143], v228 offset:21504
    s_waitcnt lgkmcnt(4)
    v_mfma_f32_32x32x16_bf16 v[96:111], v[152:155], v[144:147], v[96:111]
    ds_read_b128 v[144:147], v228 offset:22528
    s_waitcnt lgkmcnt(4)
    v_mfma_f32_32x32x16_bf16 v[96:111], v[156:159], v[128:131], v[96:111]
    ds_read_b128 v[128:131], v228 offset:23552
    s_waitcnt lgkmcnt(4)
    v_mfma_f32_32x32x16_bf16 v[96:111], v[160:163], v[132:135], v[96:111]
    v_cvt_pk_bf16_f32 v112, v80, v81
    v_cvt_pk_bf16_f32 v113, v82, v83
    v_cvt_pk_bf16_f32 v114, v84, v85
    v_cvt_pk_bf16_f32 v115, v86, v87
    v_cvt_pk_bf16_f32 v116, v88, v89
    v_cvt_pk_bf16_f32 v117, v90, v91
    v_cvt_pk_bf16_f32 v118, v92, v93
    v_cvt_pk_bf16_f32 v119, v94, v95
    buffer_store_dwordx4 v[112:115], v15, s[56:59], s85 offen offset:0 sc1
    buffer_store_dwordx4 v[116:119], v15, s[56:59], s85 offen offset:1024 sc1
    ds_read_b128 v[132:135], v228 offset:24576
    s_waitcnt lgkmcnt(4)
    v_mfma_f32_32x32x16_bf16 v[96:111], v[164:167], v[136:139], v[96:111]
    ds_read_b128 v[136:139], v228 offset:25600
    s_waitcnt lgkmcnt(4)
    v_mfma_f32_32x32x16_bf16 v[96:111], v[168:171], v[140:143], v[96:111]
    ds_read_b128 v[140:143], v228 offset:26624
    s_waitcnt lgkmcnt(4)
    v_mfma_f32_32x32x16_bf16 v[96:111], v[172:175], v[144:147], v[96:111]
    ds_read_b128 v[144:147], v228 offset:27648
    s_waitcnt lgkmcnt(4)
    v_mfma_f32_32x32x16_bf16 v[96:111], v[176:179], v[128:131], v[96:111]
    ds_read_b128 v[128:131], v228 offset:28672
    s_waitcnt lgkmcnt(4)
    v_mfma_f32_32x32x16_bf16 v[96:111], v[180:183], v[132:135], v[96:111]
    s_waitcnt vmcnt(2)
    s_cmp_lg_u32 s7, 0
    s_cbranch_scc1 Lslow_90
    s_mov_b64 exec, 1
    buffer_store_dword v251, off, s[56:59], s82 offset:0
    s_mov_b64 exec, -1
Lback_91:
    ds_read_b128 v[132:135], v228 offset:29696
    s_waitcnt lgkmcnt(4)
    v_mfma_f32_32x32x16_bf16 v[96:111], v[184:187], v[136:139], v[96:111]
    ds_read_b128 v[136:139], v228 offset:30720
    s_waitcnt lgkmcnt(4)
    v_mfma_f32_32x32x16_bf16 v[96:111], v[188:191], v[140:143], v[96:111]
    ds_read_b128 v[140:143], v228 offset:31744
    s_waitcnt lgkmcnt(4)
    v_mfma_f32_32x32x16_bf16 v[96:111], v[192:195], v[144:147], v[96:111]
    s_waitcnt lgkmcnt(3)
    v_mfma_f32_32x32x16_bf16 v[96:111], v[196:199], v[128:131], v[96:111]
    s_waitcnt lgkmcnt(2)
    v_mfma_f32_32x32x16_bf16 v[96:111], v[200:203], v[132:135], v[96:111]
    s_waitcnt lgkmcnt(1)
    v_mfma_f32_32x32x16_bf16 v[96:111], v[204:207], v[136:139], v[96:111]
    s_waitcnt lgkmcnt(0)
    v_mfma_f32_32x32x16_bf16 v[96:111], v[208:211], v[140:143], v[96:111]
    s_setprio 3
    s_nop 10
    v_cvt_pk_bf16_f32 v120, v96, v97
    v_cvt_pk_bf16_f32 v121, v98, v99
    v_cvt_pk_bf16_f32 v122, v100, v101
    v_cvt_pk_bf16_f32 v123, v102, v103
    v_cvt_pk_bf16_f32 v124, v104, v105
    v_cvt_pk_bf16_f32 v125, v106, v107
    v_cvt_pk_bf16_f32 v126, v108, v109
    v_cvt_pk_bf16_f32 v127, v110, v111
    buffer_store_dwordx4 v[120:123], v15, s[56:59], s85 offen offset:2048 sc1
    buffer_store_dwordx4 v[124:127], v15, s[56:59], s85 offen offset:3072 sc1
    buffer_load_dword v2, v4, s[56:59], s67 offen offset:256 sc1
    s_waitcnt vmcnt(1)
    s_cmp_lg_u32 s7, 0
    s_cbranch_scc1 Lslow_92
    s_mov_b64 exec, 1
    buffer_store_dword v251, off, s[56:59], s86 offset:0
    s_mov_b64 exec, -1
Lback_93:
    s_waitcnt vmcnt(1)
    v_cmp_ne_u32 vcc, s6, v2
    s_cbranch_vccnz Lre_94
Lreb_95:
    buffer_load_dword v3, v4, s[56:59], s67 offen offset:272 sc1
    s_add_u32 m0, s76, 0
    s_add_u32 s90, s66, 6144
    buffer_load_dwordx4 v15, s[56:59], s66 offen sc1 lds
    buffer_load_dwordx4 v15, s[56:59], s66 offen offset:1024 sc1 lds
    buffer_load_dwordx4 v15, s[56:59], s90 offen offset:2048 sc1 lds
    buffer_load_dwordx4 v15, s[56:59], s90 offen offset:3072 sc1 lds
    s_add_u32 s66, s66, 114688
    s_waitcnt vmcnt(4)
    v_cmp_ne_u32 vcc, s6, v3
    s_cbranch_vccnz Lre_97
Lreb_98:
    s_add_u32 m0, s76, 4096
    s_add_u32 s90, s66, 6144
    buffer_load_dwordx4 v15, s[56:59], s66 offen sc1 lds
    buffer_load_dwordx4 v15, s[56:59], s66 offen offset:1024 sc1 lds
    buffer_load_dwordx4 v15, s[56:59], s90 offen offset:2048 sc1 lds
    buffer_load_dwordx4 v15, s[56:59], s90 offen offset:3072 sc1 lds
    s_add_u32 s66, s66, 114688
    s_waitcnt vmcnt(0)
    ds_write_b32 v254, v251 offset:64
    s_waitcnt lgkmcnt(0)
    s_endpgm
L_H:
    s_load_dword s99, s[32:33], 0
    s_mov_b64 s[40:41], s[10:11]
    s_mov_b32 s42, 1204224
    s_mov_b32 s43, 0x20000
    s_mov_b64 s[44:45], s[12:13]
    s_mov_b32 s46, 401408
    s_mov_b32 s47, 0x20000
    s_mov_b64 s[48:49], s[16:17]
    s_mov_b32 s50, 1605632
    s_mov_b32 s51, 0x20000
    s_mov_b64 s[52:53], s[20:21]
    s_mov_b32 s54, 1605632
    s_mov_b32 s55, 0x20000
    s_mov_b64 s[56:57], s[32:33]
    s_mov_b32 s58, 268435456
    s_mov_b32 s59, 0x20000
    s_mov_b64 s[60:61], s[28:29]
    s_mov_b32 s62, 1835008
    s_mov_b32 s63, 0x20000
    s_cmp_lt_u32 s67, 28
    s_cbranch_scc1 L_H0
    s_waitcnt lgkmcnt(0)
    s_add_u32 s6, s99, 0x9e3779b9
    v_mov_b32 v206, s6
    s_branch L_100
L_H0:
    v_lshrrev_b32 v3, 2, v0
    v_lshlrev_b32 v202, 7, v3
    v_and_b32 v3, 1, v0
    v_lshl_add_u32 v202, v3, 3, v202
    v_bfe_u32 v3, v0, 1, 1
    v_lshl_add_u32 v3, s3, 1, v3
    v_bfe_u32 v5, v0, 3, 2
    v_lshlrev_b32 v5, 1, v5
    v_xor_b32 v3, v3, v5
    v_lshl_add_u32 v202, v3, 4, v202
    v_lshrrev_b32 v2, 4, v0
    v_lshlrev_b32 v204, 4, v2
    v_add_u32 v204, 114688, v204
    v_and_b32 v3, 15, v0
    v_min_u32 v3, 2, v3
    v_add_u32 v3, 1, v3
    v_mul_u32_u24 v3, 896, v3
    v_add_u32 v205, v3, v204
    v_and_b32 v3, 1, v2
    v_mul_u32_u24 v3, 896, v3
    v_lshrrev_b32 v5, 1, v2
    v_lshl_add_u32 v209, v5, 4, v3
    v_add_u32 v5, 114688, v203
    v_mov_b32 v12, 0x3f803f80
    v_mov_b32 v13, v12
    v_mov_b32 v14, v12
    v_mov_b32 v15, v12
    ds_write_b128 v5, v[12:15] offset:2688
    s_mul_i32 s79, s76, 37
    s_lshr_b32 s79, s79, 8
    s_mul_i32 s91, s79, 896
    s_lshl_b32 s92, s76, 7
    s_add_u32 s91, s91, s92
    s_lshl_b32 s92, s3, 5
    s_add_u32 s91, s91, s92
    s_add_u32 s78, s91, 8192
    s_lshr_b32 s79, 0x12, s79
    s_and_b32 s79, s79, 1
    s_mul_i32 s79, s79, 0x3f800000
    s_mul_i32 s90, s83, 3584
    s_add_u32 s84, s78, s90
    s_add_u32 s84, s84, 45056
    s_cmp_eq_u32 s83, 0
    s_cselect_b32 s85, s79, 0
    s_mul_i32 s90, s83, 448
    v_add_u32 v7, s90, v204
    s_add_u32 s76, s67, 14
    s_mul_i32 s79, s76, 37
    s_lshr_b32 s79, s79, 8
    s_mul_i32 s91, s79, 896
    s_lshl_b32 s92, s76, 7
    s_add_u32 s91, s91, s92
    s_lshl_b32 s92, s3, 5
    s_add_u32 s91, s91, s92
    s_add_u32 s78, s91, 8192
    s_lshr_b32 s79, 0x12, s79
    s_and_b32 s79, s79, 1
    s_mul_i32 s79, s79, 0x3f800000
    s_waitcnt vmcnt(0)
    v_lshlrev_b32 v16, 16, v8
    v_and_b32 v17, 0xffff0000, v8
    v_lshlrev_b32 v18, 16, v9
    v_and_b32 v19, 0xffff0000, v9
    v_lshlrev_b32 v20, 16, v10
    v_and_b32 v21, 0xffff0000, v10
    v_lshlrev_b32 v22, 16, v11
    v_and_b32 v23, 0xffff0000, v11
    v_mul_f32 v24, 0xbfb8aa3b, v16
    v_mul_f32 v25, 0xbfb8aa3b, v17
    v_mul_f32 v26, 0xbfb8aa3b, v18
    v_mul_f32 v27, 0xbfb8aa3b, v19
    v_mul_f32 v28, 0xbfb8aa3b, v20
    v_mul_f32 v29, 0xbfb8aa3b, v21
    v_mul_f32 v30, 0xbfb8aa3b, v22
    v_mul_f32 v31, 0xbfb8aa3b, v23
    v_exp_f32 v24, v24
    v_exp_f32 v25, v25
    v_exp_f32 v26, v26
    v_exp_f32 v27, v27
    v_exp_f32 v28, v28
    v_exp_f32 v29, v29
    v_exp_f32 v30, v30
    v_exp_f32 v31, v31
    v_add_f32 v24, 1.0, v24
    v_add_f32 v25, 1.0, v25
    v_add_f32 v26, 1.0, v26
    v_add_f32 v27, 1.0, v27
    v_add_f32 v28, 1.0, v28
    v_add_f32 v29, 1.0, v29
    v_add_f32 v30, 1.0, v30
    v_add_f32 v31, 1.0, v31
    v_rcp_f32 v24, v24
    v_rcp_f32 v25, v25
    v_rcp_f32 v26, v26
    v_rcp_f32 v27, v27
    v_rcp_f32 v28, v28
    v_rcp_f32 v29, v29
    v_rcp_f32 v30, v30
    v_rcp_f32 v31, v31
    v_mul_f32 v16, v16, v24
    v_mul_f32 v17, v17, v25
    v_mul_f32 v18, v18, v26
    v_mul_f32 v19, v19, v27
    v_mul_f32 v20, v20, v28
    v_mul_f32 v21, v21, v29
    v_mul_f32 v22, v22, v30
    v_mul_f32 v23, v23, v31
    v_cvt_pk_bf16_f32 v8, v16, v17
    v_cvt_pk_bf16_f32 v9, v18, v19
    v_cvt_pk_bf16_f32 v10, v20, v21
    v_cvt_pk_bf16_f32 v11, v22, v23
    ds_write_b128 v5, v[8:11]
    s_waitcnt lgkmcnt(0)
    s_add_u32 s6, s99, 0x9e3779b9
    v_mov_b32 v206, s6
    v_mov_b32 v22, s6
    v_mov_b32 v23, 0
    v_and_b32 v24, 0xff, v22
    v_bfe_u32 v25, v22, 8, 8
    s_mov_b32 s86, 0xffffff00
    v_not_b32 v26, v22
    v_lshlrev_b32 v27, 2, v0
    v_add_u32 v27, 118784, v27
    ds_write_b32 v27, v26
    ds_read_b128 v[96:99], v7 offset:0
    ds_read_b128 v[100:103], v7 offset:64
    ds_read_b128 v[104:107], v7 offset:128
    ds_read_b128 v[108:111], v7 offset:192
    ds_read_b128 v[112:115], v7 offset:256
    ds_read_b128 v[116:119], v7 offset:320
    ds_read_b128 v[120:123], v7 offset:384
    s_waitcnt lgkmcnt(7)
    s_barrier
    ds_read_b64_tr_b16 v[32:33], v202 offset:0
    ds_read_b64_tr_b16 v[34:35], v202 offset:2048
    ds_read_b64_tr_b16 v[36:37], v202 offset:4096
    ds_read_b64_tr_b16 v[38:39], v202 offset:6144
    ds_read_b64_tr_b16 v[40:41], v202 offset:8192
    ds_read_b64_tr_b16 v[42:43], v202 offset:10240
    ds_read_b64_tr_b16 v[44:45], v202 offset:12288
    ds_read_b64_tr_b16 v[46:47], v202 offset:14336
    ds_read_b64_tr_b16 v[48:49], v202 offset:16384
    ds_read_b64_tr_b16 v[50:51], v202 offset:18432
    ds_read_b64_tr_b16 v[52:53], v202 offset:20480
    ds_read_b64_tr_b16 v[54:55], v202 offset:22528
    s_waitcnt lgkmcnt(10)
    v_mfma_f32_16x16x32_bf16 v[16:19], v[32:35], v[96:99], 0
    ds_read_b64_tr_b16 v[56:57], v202 offset:24576
    ds_read_b64_tr_b16 v[58:59], v202 offset:26624
    s_waitcnt lgkmcnt(10)
    v_mfma_f32_16x16x32_bf16 v[16:19], v[36:39], v[100:103], v[16:19]
    s_waitcnt lgkmcnt(8)
    v_mfma_f32_16x16x32_bf16 v[16:19], v[40:43], v[104:107], v[16:19]
    s_waitcnt lgkmcnt(6)
    v_mfma_f32_16x16x32_bf16 v[16:19], v[44:47], v[108:111], v[16:19]
    s_waitcnt lgkmcnt(4)
    v_mfma_f32_16x16x32_bf16 v[16:19], v[48:51], v[112:115], v[16:19]
    s_waitcnt lgkmcnt(2)
    v_mfma_f32_16x16x32_bf16 v[16:19], v[52:55], v[116:119], v[16:19]
    s_waitcnt lgkmcnt(0)
    v_mfma_f32_16x16x32_bf16 v[16:19], v[56:59], v[120:123], v[16:19]
    s_mov_b32 exec_lo, 0x00010001
    s_mov_b32 exec_hi, 0x00010001
    s_nop 5
    v_add_f32 v16, s85, v16
    v_add_f32 v17, s85, v17
    v_add_f32 v18, s85, v18
    v_add_f32 v19, s85, v19
    v_and_or_b32 v16, v16, s86, v24
    v_and_or_b32 v17, v17, s86, v25
    buffer_store_dwordx4 v[16:19], v209, s[56:59], s84 offen sc1
    s_mov_b64 exec, -1
    s_barrier
    ds_read_b128 v[96:99], v204 offset:0
    ds_read_b128 v[100:103], v204 offset:64
    ds_read_b128 v[104:107], v204 offset:128
    ds_read_b128 v[108:111], v204 offset:192
    ds_read_b128 v[112:115], v204 offset:256
    ds_read_b128 v[116:119], v204 offset:320
    ds_read_b128 v[120:123], v204 offset:384
    ds_read_b128 v[124:127], v204 offset:448
    ds_read_b128 v[128:131], v204 offset:512
    ds_read_b128 v[132:135], v204 offset:576
    ds_read_b128 v[136:139], v204 offset:640
    ds_read_b128 v[140:143], v204 offset:704
    ds_read_b128 v[144:147], v204 offset:768
    ds_read_b128 v[148:151], v204 offset:832
    v_add_u32 v6, 57344, v202
    v_and_b32 v217, 3, v0
    v_lshlrev_b32 v217, 2, v217
    v_add_u32 v217, 118784, v217
    s_mov_b32 s95, 0x400000
Lsp_102:
    ds_read_b32 v3, v217 offset:0
    s_waitcnt lgkmcnt(0)
    v_cmp_ne_u32 vcc, s6, v3
    s_cbranch_vccz Lspd_103
    s_sub_u32 s95, s95, 1
    s_cbranch_scc0 Lsp_102
Lspd_103:
    ds_read_b64_tr_b16 v[32:33], v6 offset:0
    ds_read_b64_tr_b16 v[34:35], v6 offset:2048
    ds_read_b64_tr_b16 v[36:37], v6 offset:4096
    ds_read_b64_tr_b16 v[38:39], v6 offset:6144
    ds_read_b64_tr_b16 v[40:41], v6 offset:8192
    ds_read_b64_tr_b16 v[42:43], v6 offset:10240
    ds_read_b64_tr_b16 v[44:45], v6 offset:12288
    ds_read_b64_tr_b16 v[46:47], v6 offset:14336
    ds_read_b64_tr_b16 v[48:49], v6 offset:16384
    ds_read_b64_tr_b16 v[50:51], v6 offset:18432
    ds_read_b64_tr_b16 v[52:53], v6 offset:20480
    ds_read_b64_tr_b16 v[54:55], v6 offset:22528
    s_waitcnt lgkmcnt(10)
    v_mfma_f32_16x16x32_bf16 v[16:19], v[32:35], v[96:99], 0
    ds_read_b64_tr_b16 v[56:57], v6 offset:24576
    ds_read_b64_tr_b16 v[58:59], v6 offset:26624
    s_waitcnt lgkmcnt(10)
    v_mfma_f32_16x16x32_bf16 v[16:19], v[36:39], v[100:103], v[16:19]
    ds_read_b64_tr_b16 v[60:61], v6 offset:28672
    ds_read_b64_tr_b16 v[62:63], v6 offset:30720
    s_waitcnt lgkmcnt(10)
    v_mfma_f32_16x16x32_bf16 v[16:19], v[40:43], v[104:107], v[16:19]
    ds_read_b64_tr_b16 v[64:65], v6 offset:32768
    ds_read_b64_tr_b16 v[66:67], v6 offset:34816
    s_waitcnt lgkmcnt(10)
    v_mfma_f32_16x16x32_bf16 v[16:19], v[44:47], v[108:111], v[16:19]
    ds_read_b64_tr_b16 v[68:69], v6 offset:36864
    ds_read_b64_tr_b16 v[70:71], v6 offset:38912
    s_waitcnt lgkmcnt(10)
    v_mfma_f32_16x16x32_bf16 v[16:19], v[48:51], v[112:115], v[16:19]
    ds_read_b64_tr_b16 v[72:73], v6 offset:40960
    ds_read_b64_tr_b16 v[74:75], v6 offset:43008
    s_waitcnt lgkmcnt(10)
    v_mfma_f32_16x16x32_bf16 v[16:19], v[52:55], v[116:119], v[16:19]
    ds_read_b64_tr_b16 v[76:77], v6 offset:45056
    ds_read_b64_tr_b16 v[78:79], v6 offset:47104
    s_waitcnt lgkmcnt(10)
    v_mfma_f32_16x16x32_bf16 v[16:19], v[56:59], v[120:123], v[16:19]
    ds_read_b64_tr_b16 v[80:81], v6 offset:49152
    ds_read_b64_tr_b16 v[82:83], v6 offset:51200
    s_waitcnt lgkmcnt(10)
    v_mfma_f32_16x16x32_bf16 v[16:19], v[60:63], v[124:127], v[16:19]
    ds_read_b64_tr_b16 v[84:85], v6 offset:53248
    ds_read_b64_tr_b16 v[86:87], v6 offset:55296
    s_waitcnt lgkmcnt(10)
    v_mfma_f32_16x16x32_bf16 v[16:19], v[64:67], v[128:131], v[16:19]
    s_waitcnt lgkmcnt(8)
    v_mfma_f32_16x16x32_bf16 v[16:19], v[68:71], v[132:135], v[16:19]
    s_waitcnt lgkmcnt(6)
    v_mfma_f32_16x16x32_bf16 v[16:19], v[72:75], v[136:139], v[16:19]
    s_waitcnt lgkmcnt(4)
    v_mfma_f32_16x16x32_bf16 v[16:19], v[76:79], v[140:143], v[16:19]
    s_waitcnt lgkmcnt(2)
    v_mfma_f32_16x16x32_bf16 v[16:19], v[80:83], v[144:147], v[16:19]
    s_waitcnt lgkmcnt(0)
    v_mfma_f32_16x16x32_bf16 v[16:19], v[84:87], v[148:151], v[16:19]
    s_mov_b32 exec_lo, 0x00010001
    s_mov_b32 exec_hi, 0x00010001
    s_nop 5
    v_cvt_pk_bf16_f32 v20, v16, v17
    v_cvt_pk_bf16_f32 v21, v18, v19
    v_lshlrev_b32 v16, 16, v20
    v_and_b32 v17, 0xffff0000, v20
    v_lshlrev_b32 v18, 16, v21
    v_and_b32 v19, 0xffff0000, v21
    v_add_f32 v16, s79, v16
    v_add_f32 v17, s79, v17
    v_add_f32 v18, s79, v18
    v_add_f32 v19, s79, v19
    v_cvt_pk_bf16_f32 v20, v16, v17
    v_cvt_pk_bf16_f32 v21, v18, v19
    buffer_store_dwordx4 v[20:23], v209, s[56:59], s78 offen sc1
    s_mov_b64 exec, -1
    s_mov_b32 s95, 0x400000
Lsp_104:
    ds_read_b32 v3, v217 offset:16
    s_waitcnt lgkmcnt(0)
    v_cmp_ne_u32 vcc, s6, v3
    s_cbranch_vccz Lspd_105
    s_sub_u32 s95, s95, 1
    s_cbranch_scc0 Lsp_104
Lspd_105:
    v_mov_b32 v219, 118816
    s_cmp_eq_u32 s3, 0
    s_cbranch_scc0 L_106
    s_mov_b32 s74, 13568
    s_mov_b32 s95, 0x40000
Lpoll_107:
    buffer_load_dwordx4 v[32:35], v203, s[56:59], s74 offen offset:0 sc1
    buffer_load_dwordx4 v[36:39], v203, s[56:59], s74 offen offset:896 sc1
    buffer_load_dwordx4 v[40:43], v203, s[56:59], s74 offen offset:1792 sc1
    buffer_load_dwordx4 v[44:47], v203, s[56:59], s74 offen offset:2688 sc1
    s_waitcnt vmcnt(0)
    v_xor_b32 v3, s6, v34
    v_bitop3_b32 v3, v3, v38, s6 bitop3:0xf6
    v_bitop3_b32 v3, v3, v42, s6 bitop3:0xf6
    v_bitop3_b32 v3, v3, v46, s6 bitop3:0xf6
    v_cmp_ne_u32 vcc, 0, v3
    s_cbranch_vccz Lgot_108
    s_sub_u32 s95, s95, 1
    s_cbranch_scc0 Lpoll_107
Lgot_108:
    v_mov_b32 v34, v36
    v_mov_b32 v35, v37
    v_mov_b32 v42, v44
    v_mov_b32 v43, v45
    ds_write_b128 v5, v[32:35] offset:1792
    ds_write_b128 v5, v[40:43] offset:896
    ds_write_b32 v219, v206
L_106:
    s_mov_b32 s95, 0x400000
Lsp_109:
    ds_read_b32 v3, v219 offset:0
    s_waitcnt lgkmcnt(0)
    v_cmp_ne_u32 vcc, s6, v3
    s_cbranch_vccz Lspd_110
    s_sub_u32 s95, s95, 1
    s_cbranch_scc0 Lsp_109
Lspd_110:
    s_lshl2_add_u32 s90, s67, s3
    s_lshl_b32 s90, s90, 8
    s_add_u32 s78, s90, 20480
    s_lshl_b32 s90, s67, 7
    s_add_u32 s81, s90, 49152
    s_mov_b32 s80, 0x05040302
    v_mov_b32 v31, v206
    ds_read_b128 v[96:99], v205 offset:0
    ds_read_b128 v[100:103], v205 offset:64
    ds_read_b128 v[104:107], v205 offset:128
    ds_read_b128 v[108:111], v205 offset:192
    ds_read_b128 v[112:115], v205 offset:256
    ds_read_b128 v[116:119], v205 offset:320
    ds_read_b128 v[120:123], v205 offset:384
    ds_read_b128 v[124:127], v205 offset:448
    ds_read_b128 v[128:131], v205 offset:512
    ds_read_b128 v[132:135], v205 offset:576
    ds_read_b128 v[136:139], v205 offset:640
    ds_read_b128 v[140:143], v205 offset:704
    ds_read_b128 v[144:147], v205 offset:768
    ds_read_b128 v[148:151], v205 offset:832
    ds_read_b64_tr_b16 v[32:33], v202 offset:0
    ds_read_b64_tr_b16 v[34:35], v202 offset:2048
    ds_read_b64_tr_b16 v[36:37], v202 offset:4096
    ds_read_b64_tr_b16 v[38:39], v202 offset:6144
    ds_read_b64_tr_b16 v[40:41], v202 offset:8192
    ds_read_b64_tr_b16 v[42:43], v202 offset:10240
    ds_read_b64_tr_b16 v[44:45], v202 offset:12288
    ds_read_b64_tr_b16 v[46:47], v202 offset:14336
    ds_read_b64_tr_b16 v[48:49], v202 offset:16384
    ds_read_b64_tr_b16 v[50:51], v202 offset:18432
    ds_read_b64_tr_b16 v[52:53], v202 offset:20480
    ds_read_b64_tr_b16 v[54:55], v202 offset:22528
    s_waitcnt lgkmcnt(10)
    v_mfma_f32_16x16x32_bf16 v[16:19], v[96:99], v[32:35], 0
    ds_read_b64_tr_b16 v[56:57], v202 offset:24576
    ds_read_b64_tr_b16 v[58:59], v202 offset:26624
    s_waitcnt lgkmcnt(10)
    v_mfma_f32_16x16x32_bf16 v[16:19], v[100:103], v[36:39], v[16:19]
    ds_read_b64_tr_b16 v[60:61], v202 offset:28672
    ds_read_b64_tr_b16 v[62:63], v202 offset:30720
    s_waitcnt lgkmcnt(10)
    v_mfma_f32_16x16x32_bf16 v[16:19], v[104:107], v[40:43], v[16:19]
    ds_read_b64_tr_b16 v[64:65], v202 offset:32768
    ds_read_b64_tr_b16 v[66:67], v202 offset:34816
    s_waitcnt lgkmcnt(10)
    v_mfma_f32_16x16x32_bf16 v[16:19], v[108:111], v[44:47], v[16:19]
    ds_read_b64_tr_b16 v[68:69], v202 offset:36864
    ds_read_b64_tr_b16 v[70:71], v202 offset:38912
    s_waitcnt lgkmcnt(10)
    v_mfma_f32_16x16x32_bf16 v[16:19], v[112:115], v[48:51], v[16:19]
    ds_read_b64_tr_b16 v[72:73], v202 offset:40960
    ds_read_b64_tr_b16 v[74:75], v202 offset:43008
    s_waitcnt lgkmcnt(10)
    v_mfma_f32_16x16x32_bf16 v[16:19], v[116:119], v[52:55], v[16:19]
    ds_read_b64_tr_b16 v[76:77], v202 offset:45056
    ds_read_b64_tr_b16 v[78:79], v202 offset:47104
    s_waitcnt lgkmcnt(10)
    v_mfma_f32_16x16x32_bf16 v[16:19], v[120:123], v[56:59], v[16:19]
    ds_read_b64_tr_b16 v[80:81], v202 offset:49152
    ds_read_b64_tr_b16 v[82:83], v202 offset:51200
    s_waitcnt lgkmcnt(10)
    v_mfma_f32_16x16x32_bf16 v[16:19], v[124:127], v[60:63], v[16:19]
    ds_read_b64_tr_b16 v[84:85], v202 offset:53248
    ds_read_b64_tr_b16 v[86:87], v202 offset:55296
    s_waitcnt lgkmcnt(10)
    v_mfma_f32_16x16x32_bf16 v[16:19], v[128:131], v[64:67], v[16:19]
    s_waitcnt lgkmcnt(8)
    v_mfma_f32_16x16x32_bf16 v[16:19], v[132:135], v[68:71], v[16:19]
    s_waitcnt lgkmcnt(6)
    v_mfma_f32_16x16x32_bf16 v[16:19], v[136:139], v[72:75], v[16:19]
    s_waitcnt lgkmcnt(4)
    v_mfma_f32_16x16x32_bf16 v[16:19], v[140:143], v[76:79], v[16:19]
    s_waitcnt lgkmcnt(2)
    v_mfma_f32_16x16x32_bf16 v[16:19], v[144:147], v[80:83], v[16:19]
    s_waitcnt lgkmcnt(0)
    v_mfma_f32_16x16x32_bf16 v[16:19], v[148:151], v[84:87], v[16:19]
    v_mfma_f32_16x16x32_bf16 v[24:27], v[96:99], v[96:99], 0
    v_mfma_f32_16x16x32_bf16 v[24:27], v[100:103], v[100:103], v[24:27]
    v_mfma_f32_16x16x32_bf16 v[24:27], v[104:107], v[104:107], v[24:27]
    v_mfma_f32_16x16x32_bf16 v[24:27], v[108:111], v[108:111], v[24:27]
    v_mfma_f32_16x16x32_bf16 v[24:27], v[112:115], v[112:115], v[24:27]
    v_mfma_f32_16x16x32_bf16 v[24:27], v[116:119], v[116:119], v[24:27]
    v_mfma_f32_16x16x32_bf16 v[24:27], v[120:123], v[120:123], v[24:27]
    v_mfma_f32_16x16x32_bf16 v[24:27], v[124:127], v[124:127], v[24:27]
    v_mfma_f32_16x16x32_bf16 v[24:27], v[128:131], v[128:131], v[24:27]
    v_mfma_f32_16x16x32_bf16 v[24:27], v[132:135], v[132:135], v[24:27]
    v_mfma_f32_16x16x32_bf16 v[24:27], v[136:139], v[136:139], v[24:27]
    v_mfma_f32_16x16x32_bf16 v[24:27], v[140:143], v[140:143], v[24:27]
    v_mfma_f32_16x16x32_bf16 v[24:27], v[144:147], v[144:147], v[24:27]
    v_mfma_f32_16x16x32_bf16 v[24:27], v[148:151], v[148:151], v[24:27]
    v_cvt_pk_bf16_f32 v3, v16, v16
    v_and_b32 v3, 0xffff0000, v3
    v_sub_f32 v4, v16, v3
    v_cvt_pk_bf16_f32 v4, v4, v4
    v_perm_b32 v28, v4, v3, s80
    v_cvt_pk_bf16_f32 v3, v17, v17
    v_and_b32 v3, 0xffff0000, v3
    v_sub_f32 v4, v17, v3
    v_cvt_pk_bf16_f32 v4, v4, v4
    v_perm_b32 v29, v4, v3, s80
    v_cvt_pk_bf16_f32 v3, v18, v18
    v_and_b32 v3, 0xffff0000, v3
    v_sub_f32 v4, v18, v3
    v_cvt_pk_bf16_f32 v4, v4, v4
    v_perm_b32 v30, v4, v3, s80
    v_mov_b32 v27, v206
    s_mov_b64 exec, 0xffff
    buffer_store_dwordx4 v[28:31], v203, s[56:59], s78 offen sc1
    s_mov_b64 exec, 3
    buffer_store_dwordx4 v[24:27], v203, s[56:59], s81 offen sc1
    s_mov_b64 exec, -1
L_100:
    s_cmp_eq_u32 s3, 1
    s_cbranch_scc0 L_101
    s_getreg_b32 s91, hwreg(HW_REG_XCC_ID, 0, 3)
    s_add_u32 s91, s91, s6
    v_mov_b32 v7, s91
    s_and_b32 s90, s98, 7
    s_lshl_b32 s90, s90, 2
    s_lshl_b32 s91, s5, 7
    s_add_u32 s90, s90, s91
    s_add_u32 s90, s90, 4096
    s_mov_b64 exec, 1
    buffer_store_dword v7, off, s[56:59], s90 sc1
    s_mov_b64 exec, -1
    s_cmp_eq_u32 s67, 31
    s_cbranch_scc0 L_101
    v_lshrrev_b32 v3, 1, v0
    v_and_b32 v6, 1, v0
    v_lshlrev_b32 v3, 7, v3
    v_lshl_add_u32 v3, v6, 4, v3
    s_mov_b32 s90, 4096
    s_mov_b32 s95, 0x40000
L_111:
    buffer_load_dwordx4 v[8:11], v3, s[56:59], s90 offen sc1
    s_waitcnt vmcnt(0)
    v_subrev_u32 v8, s6, v8
    v_subrev_u32 v9, s6, v9
    v_subrev_u32 v10, s6, v10
    v_subrev_u32 v11, s6, v11
    v_or3_b32 v8, v8, v9, v10
    v_or_b32 v8, v8, v11
    v_cmp_le_u32 vcc, 8, v8
    s_cbranch_vccz L_112
    s_sub_u32 s95, s95, 1
    s_cbranch_scc0 L_111
L_112:
    s_mov_b64 exec, 1
    buffer_store_dword v206, off, s[56:59], 0 offset:0 sc1
    s_mov_b64 exec, -1
L_101:
    s_endpgm
L_HD:
L_HW:
    s_load_dword s99, s[32:33], 0
    s_mov_b64 s[40:41], s[10:11]
    s_mov_b32 s42, 1204224
    s_mov_b32 s43, 0x20000
    s_mov_b64 s[44:45], s[12:13]
    s_mov_b32 s46, 401408
    s_mov_b32 s47, 0x20000
    s_mov_b64 s[48:49], s[16:17]
    s_mov_b32 s50, 1605632
    s_mov_b32 s51, 0x20000
    s_mov_b64 s[52:53], s[20:21]
    s_mov_b32 s54, 1605632
    s_mov_b32 s55, 0x20000
    s_mov_b64 s[56:57], s[32:33]
    s_mov_b32 s58, 268435456
    s_mov_b32 s59, 0x20000
    s_mov_b64 s[60:61], s[28:29]
    s_mov_b32 s62, 1835008
    s_mov_b32 s63, 0x20000
    v_min_u32 v3, 55, v0
    v_lshlrev_b32 v207, 7, v3
    v_mul_u32_u24 v4, 4682, v3
    v_lshrrev_b32 v4, 16, v4
    v_mul_u32_u24 v6, 14, v4
    v_sub_u32 v3, v3, v6
    s_lshl_b32 s90, s73, 2
    v_add_u32 v4, s90, v4
    v_lshrrev_b32 v6, 1, v3
    v_and_b32 v3, 1, v3
    v_mul_u32_u24 v210, 3584, v4
    v_lshl_add_u32 v210, v6, 9, v210
    v_lshl_add_u32 v210, v3, 7, v210
    v_lshl_add_u32 v7, v6, 8, v4
    v_mul_u32_u24 v7, 896, v7
    v_add_u32 v8, v6, v3
    v_add_u32 v9, 1, v8
    v_subrev_u32 v10, 7, v9
    v_min_u32 v9, v9, v10
    v_lshl_add_u32 v211, v9, 7, v7
    v_add_u32 v9, 3, v8
    v_subrev_u32 v10, 7, v9
    v_min_u32 v9, v9, v10
    v_lshl_add_u32 v212, v9, 7, v7
    v_add_u32 v9, 5, v8
    v_subrev_u32 v10, 7, v9
    v_min_u32 v9, v9, v10
    v_lshl_add_u32 v213, v9, 7, v7
    v_mul_u32_u24 v9, 14336, v3
    v_lshl_add_u32 v9, v6, 7, v9
    v_add_u32 v214, v9, v7
    s_lshr_b32 s81, s2, 6
    s_lshl2_add_u32 s90, s81, s73
    s_mul_i32 s90, s90, 1792
    s_add_u32 s90, s90, 20480
    v_add_u32 v215, s90, v207
    s_lshl_b32 s90, s73, 1
    v_add_u32 v9, s90, v0
    v_subrev_u32 v9, 14, v9
    v_min_u32 v9, 6, v9
    v_lshlrev_b32 v9, 9, v9
    v_cmp_le_u32 vcc, 14, v0
    v_add_u32 v9, 49152, v9
    s_mul_i32 s82, s81, 14336
    v_cndmask_b32 v215, v215, v9, vcc
    s_mul_i32 s81, s81, 57344
    s_mul_i32 s77, s5, 577536
    s_mul_i32 s90, s73, 7168
    s_add_u32 s77, s77, s90
    s_add_u32 s77, s77, 4194304
    s_mov_b32 s84, 0x0fffffff
    s_mov_b32 s85, 0
    s_mov_b32 s86, 0xf0000000
    s_mov_b32 s87, 0x00ffffff
    s_sub_u32 s83, s77, s90
    s_lshl2_add_u32 s90, s73, 118784
    v_mov_b32 v217, s90
    s_waitcnt lgkmcnt(0)
    s_add_u32 s6, s99, 0x9e3779b9
    v_mov_b32 v218, s6
    s_cmp_ge_u32 s67, 28
    s_cbranch_scc1 L_HL
    v_lshrrev_b32 v3, 3, v0
    v_and_b32 v5, 4, v3
    v_add_u32 v3, v3, v5
    v_mul_u32_u24 v201, 3584, v3
    v_bfe_u32 v3, v0, 4, 2
    v_lshlrev_b32 v3, 1, v3
    v_and_b32 v5, 7, v0
    v_xor_b32 v3, v3, v5
    v_lshl_add_u32 v201, v3, 4, v201
    s_mul_i32 s74, s72, 21504
    s_lshl_b32 s90, s67, 7
    s_add_u32 s74, s74, s90
    s_add_u32 s74, s74, 1792
    s_mul_i32 s78, s72, 14336
    s_add_u32 s78, s78, s90
    s_waitcnt vmcnt(0)
    s_barrier
    s_barrier
    s_add_u32 m0, s75, 57344
    s_nop 0
    buffer_load_dwordx4 v200, s[36:39], s74 offen  lds
    s_add_u32 m0, s75, 61440
    s_add_u32 s74, s74, 172032
    buffer_load_dwordx4 v200, s[36:39], s74 offen  lds
    s_add_u32 m0, s75, 65536
    s_add_u32 s74, s74, 172032
    buffer_load_dwordx4 v200, s[36:39], s74 offen  lds
    s_add_u32 m0, s75, 69632
    s_add_u32 s74, s74, 172032
    buffer_load_dwordx4 v200, s[36:39], s74 offen  lds
    s_add_u32 m0, s75, 73728
    s_add_u32 s74, s74, 172032
    buffer_load_dwordx4 v200, s[36:39], s74 offen  lds
    s_add_u32 m0, s75, 77824
    s_add_u32 s74, s74, 172032
    buffer_load_dwordx4 v200, s[36:39], s74 offen  lds
    s_add_u32 m0, s75, 81920
    s_add_u32 s74, s74, 172032
    buffer_load_dwordx4 v200, s[36:39], s74 offen  lds
    s_add_u32 m0, s75, 86016
    s_add_u32 s74, s74, 172032
    buffer_load_dwordx4 v200, s[36:39], s74 offen  lds
    s_add_u32 m0, s75, 90112
    s_add_u32 s74, s74, 172032
    buffer_load_dwordx4 v200, s[36:39], s74 offen  lds
    s_add_u32 m0, s75, 94208
    s_add_u32 s74, s74, 172032
    buffer_load_dwordx4 v200, s[36:39], s74 offen  lds
    s_add_u32 m0, s75, 98304
    s_add_u32 s74, s74, 172032
    buffer_load_dwordx4 v200, s[36:39], s74 offen  lds
    s_add_u32 m0, s75, 102400
    s_add_u32 s74, s74, 172032
    buffer_load_dwordx4 v200, s[36:39], s74 offen  lds
    s_add_u32 m0, s75, 106496
    s_add_u32 s74, s74, 172032
    buffer_load_dwordx4 v200, s[36:39], s74 offen  lds
    s_add_u32 m0, s75, 110592
    s_add_u32 s74, s74, 172032
    buffer_load_dwordx4 v200, s[36:39], s74 offen  lds
    s_add_u32 m0, s75, 0
    s_nop 0
    buffer_load_dwordx4 v201, s[48:51], s78 offen  lds
    s_add_u32 m0, s75, 4096
    s_add_u32 s78, s78, 114688
    buffer_load_dwordx4 v201, s[48:51], s78 offen  lds
    s_add_u32 m0, s75, 8192
    s_add_u32 s78, s78, 114688
    buffer_load_dwordx4 v201, s[48:51], s78 offen  lds
    s_add_u32 m0, s75, 12288
    s_add_u32 s78, s78, 114688
    buffer_load_dwordx4 v201, s[48:51], s78 offen  lds
    s_add_u32 m0, s75, 16384
    s_add_u32 s78, s78, 114688
    buffer_load_dwordx4 v201, s[48:51], s78 offen  lds
    s_add_u32 m0, s75, 20480
    s_add_u32 s78, s78, 114688
    buffer_load_dwordx4 v201, s[48:51], s78 offen  lds
    s_add_u32 m0, s75, 24576
    s_add_u32 s78, s78, 114688
    buffer_load_dwordx4 v201, s[48:51], s78 offen  lds
    s_add_u32 m0, s75, 28672
    s_add_u32 s78, s78, 114688
    buffer_load_dwordx4 v201, s[48:51], s78 offen  lds
    s_waitcnt vmcnt(8)
    ds_write_b32 v217, v218
    s_add_u32 m0, s75, 32768
    s_add_u32 s78, s78, 114688
    buffer_load_dwordx4 v201, s[48:51], s78 offen  lds
    s_add_u32 m0, s75, 36864
    s_add_u32 s78, s78, 114688
    buffer_load_dwordx4 v201, s[48:51], s78 offen  lds
    s_add_u32 m0, s75, 40960
    s_add_u32 s78, s78, 114688
    buffer_load_dwordx4 v201, s[48:51], s78 offen  lds
    s_add_u32 m0, s75, 45056
    s_add_u32 s78, s78, 114688
    buffer_load_dwordx4 v201, s[48:51], s78 offen  lds
    s_add_u32 m0, s75, 49152
    s_add_u32 s78, s78, 114688
    buffer_load_dwordx4 v201, s[48:51], s78 offen  lds
    s_add_u32 m0, s75, 53248
    s_add_u32 s78, s78, 114688
    buffer_load_dwordx4 v201, s[48:51], s78 offen  lds
L_HL:
    s_mov_b64 exec, 0xffff
    buffer_load_dword v208, v207, s[56:59], s83 offen
    s_add_u32 s90, s77, 2048
    s_mov_b64 exec, s[84:85]
    buffer_load_dword v208, v207, s[56:59], s90 offen
    s_mov_b64 exec, s[86:87]
    buffer_load_dword v208, v207, s[56:59], s90 offen
    s_waitcnt vmcnt(2)
    ds_write_b32 v217, v218 offset:16
    s_add_u32 s90, s77, 30720
    s_mov_b64 exec, s[84:85]
    s_waitcnt vmcnt(2)
    buffer_load_dword v208, v207, s[56:59], s90 offen
    s_mov_b64 exec, s[86:87]
    s_waitcnt vmcnt(2)
    buffer_load_dword v208, v207, s[56:59], s90 offen
    s_add_u32 s90, s81, 256
    s_mov_b64 exec, s[84:85]
    s_waitcnt vmcnt(2)
    buffer_load_dword v208, v210, s[48:51], s90 offen
    s_mov_b64 exec, s[86:87]
    s_waitcnt vmcnt(2)
    buffer_load_dword v208, v210, s[48:51], s90 offen
    s_add_u32 s90, s81, 229632
    s_mov_b64 exec, s[84:85]
    s_waitcnt vmcnt(2)
    buffer_load_dword v208, v210, s[48:51], s90 offen
    s_mov_b64 exec, s[86:87]
    s_waitcnt vmcnt(2)
    buffer_load_dword v208, v210, s[48:51], s90 offen
    s_add_u32 s90, s81, 459008
    s_mov_b64 exec, s[84:85]
    s_waitcnt vmcnt(2)
    buffer_load_dword v208, v210, s[48:51], s90 offen
    s_mov_b64 exec, s[86:87]
    s_waitcnt vmcnt(2)
    buffer_load_dword v208, v210, s[48:51], s90 offen
    s_add_u32 s90, s81, 688384
    s_mov_b64 exec, s[84:85]
    s_waitcnt vmcnt(2)
    buffer_load_dword v208, v210, s[48:51], s90 offen
    s_mov_b64 exec, s[86:87]
    s_waitcnt vmcnt(2)
    buffer_load_dword v208, v210, s[48:51], s90 offen
    s_add_u32 s90, s81, 917760
    s_mov_b64 exec, s[84:85]
    s_waitcnt vmcnt(2)
    buffer_load_dword v208, v210, s[48:51], s90 offen
    s_mov_b64 exec, s[86:87]
    s_waitcnt vmcnt(2)
    buffer_load_dword v208, v210, s[48:51], s90 offen
    s_add_u32 s90, s81, 1147136
    s_mov_b64 exec, s[84:85]
    s_waitcnt vmcnt(2)
    buffer_load_dword v208, v210, s[48:51], s90 offen
    s_mov_b64 exec, s[86:87]
    s_waitcnt vmcnt(2)
    buffer_load_dword v208, v210, s[48:51], s90 offen
    s_add_u32 s90, s81, 1376512
    s_mov_b64 exec, s[84:85]
    s_waitcnt vmcnt(2)
    buffer_load_dword v208, v210, s[48:51], s90 offen
    s_mov_b64 exec, s[86:87]
    s_waitcnt vmcnt(2)
    buffer_load_dword v208, v210, s[48:51], s90 offen
    s_add_u32 s90, s81, 0
    s_mov_b64 exec, s[84:85]
    s_waitcnt vmcnt(2)
    buffer_load_dword v208, v210, s[48:51], s90 offen
    s_mov_b64 exec, s[86:87]
    s_waitcnt vmcnt(2)
    buffer_load_dword v208, v210, s[48:51], s90 offen
    s_mov_b64 exec, 0xffff
    buffer_load_dword v208, v215, s[56:59], 0 offen sc1
    s_add_u32 s90, s81, 229376
    s_mov_b64 exec, s[84:85]
    s_waitcnt vmcnt(2)
    buffer_load_dword v208, v210, s[48:51], s90 offen
    s_mov_b64 exec, s[86:87]
    s_waitcnt vmcnt(2)
    buffer_load_dword v208, v210, s[48:51], s90 offen
    s_add_u32 s90, s81, 458752
    s_mov_b64 exec, s[84:85]
    s_waitcnt vmcnt(2)
    buffer_load_dword v208, v210, s[48:51], s90 offen
    s_mov_b64 exec, s[86:87]
    s_waitcnt vmcnt(2)
    buffer_load_dword v208, v210, s[48:51], s90 offen
    s_add_u32 s90, s81, 688128
    s_mov_b64 exec, s[84:85]
    s_waitcnt vmcnt(2)
    buffer_load_dword v208, v210, s[48:51], s90 offen
    s_mov_b64 exec, s[86:87]
    s_waitcnt vmcnt(2)
    buffer_load_dword v208, v210, s[48:51], s90 offen
    s_add_u32 s90, s81, 917504
    s_mov_b64 exec, s[84:85]
    s_waitcnt vmcnt(2)
    buffer_load_dword v208, v210, s[48:51], s90 offen
    s_mov_b64 exec, s[86:87]
    s_waitcnt vmcnt(2)
    buffer_load_dword v208, v210, s[48:51], s90 offen
    s_add_u32 s90, s81, 1146880
    s_mov_b64 exec, s[84:85]
    s_waitcnt vmcnt(2)
    buffer_load_dword v208, v210, s[48:51], s90 offen
    s_mov_b64 exec, s[86:87]
    s_waitcnt vmcnt(2)
    buffer_load_dword v208, v210, s[48:51], s90 offen
    s_add_u32 s90, s81, 1376256
    s_mov_b64 exec, s[84:85]
    s_waitcnt vmcnt(2)
    buffer_load_dword v208, v210, s[48:51], s90 offen
    s_mov_b64 exec, s[86:87]
    s_waitcnt vmcnt(2)
    buffer_load_dword v208, v210, s[48:51], s90 offen
    s_endpgm
Lre_4:
    s_mov_b32 s95, 0x40000
Lrel_6:
    buffer_load_dwordx4 v[136:139], v133, s[56:59], 0 offen offset:0 sc1
    buffer_load_dwordx4 v[140:143], v133, s[56:59], 0 offen offset:3584 sc1
    s_waitcnt vmcnt(0)
    v_xor_b32 v3, s6, v136
    v_bitop3_b32 v3, v3, v137, s97 bitop3:0xf6
    v_bitop3_b32 v3, v3, v140, s6 bitop3:0xf6
    v_bitop3_b32 v3, v3, v141, s97 bitop3:0xf6
    v_and_b32 v3, 0xff, v3
    v_cmp_ne_u32 vcc, 0, v3
    s_cbranch_vccz Lreb_5
    s_sub_u32 s95, s95, 1
    s_cbranch_scc0 Lrel_6
    s_branch Lreb_5
Lre_7:
    s_mov_b32 s95, 0x40000
Lrel_9:
    buffer_load_dword v132, v131, s[56:59], 0 offen sc1
    s_waitcnt vmcnt(0)
    v_subrev_u32 v2, s6, v132
    v_cmp_le_u32 vcc, 8, v2
    s_cbranch_vccz Lreb_8
    s_sub_u32 s95, s95, 1
    s_cbranch_scc0 Lrel_9
    s_branch Lreb_8
L_10:
    s_nop 9
    v_cvt_pk_bf16_f32 v6, v164, v165
    v_cvt_pk_bf16_f32 v7, v166, v167
    ds_write_b64 v214, v[6:7] offset:6144
    v_cvt_pk_bf16_f32 v8, v168, v169
    v_cvt_pk_bf16_f32 v9, v170, v171
    ds_write_b64 v214, v[8:9] offset:6400
    v_cvt_pk_bf16_f32 v6, v172, v173
    v_cvt_pk_bf16_f32 v7, v174, v175
    ds_write_b64 v214, v[6:7] offset:6656
    v_cvt_pk_bf16_f32 v8, v176, v177
    v_cvt_pk_bf16_f32 v9, v178, v179
    ds_write_b64 v214, v[8:9] offset:6912
    s_branch L_11
Lslow_12:
    buffer_store_dwordx4 v[128:131], v216, s[56:59], s74 offen sc1
    buffer_store_dwordx4 v[132:135], v216, s[56:59], s67 offen sc1
    s_branch Lback_13
Lre_14:
    s_mov_b32 s95, 0x40000
Lrel_16:
    buffer_load_dwordx4 v[136:139], v216, s[56:59], s84 offen sc1
    buffer_load_dwordx4 v[140:143], v216, s[56:59], s85 offen sc1
    s_waitcnt vmcnt(0)
    v_xor_b32 v4, s6, v139
    v_bitop3_b32 v4, v4, v143, s6 bitop3:0xf6
    v_cmp_ne_u32 vcc, 0, v4
    s_cbranch_vccz Lreb_15
    s_sub_u32 s95, s95, 1
    s_cbranch_scc0 Lrel_16
    s_branch Lreb_15
Llr_17:
    s_mov_b32 s95, 0x400000
Llrl_19:
    ds_read_b32 v5, v215 offset:32
    ds_read_b64 v[16:17], v193
    ds_read_b64 v[18:19], v193 offset:512
    ds_read_b64 v[20:21], v194
    ds_read_b64 v[22:23], v194 offset:512
    ds_read_b64 v[24:25], v195
    ds_read_b64 v[26:27], v195 offset:512
    ds_read_b64 v[28:29], v196
    ds_read_b64 v[30:31], v196 offset:512
    ds_read_b64 v[32:33], v197
    ds_read_b64 v[34:35], v197 offset:512
    ds_read_b64 v[36:37], v198
    ds_read_b64 v[38:39], v198 offset:512
    ds_read_b64 v[40:41], v199
    ds_read_b64 v[42:43], v199 offset:512
    ds_read_b64 v[44:45], v200
    ds_read_b64 v[46:47], v200 offset:512
    ds_read_b64 v[48:49], v201
    ds_read_b64 v[50:51], v201 offset:512
    ds_read_b64 v[52:53], v202
    ds_read_b64 v[54:55], v202 offset:512
    ds_read_b64 v[56:57], v203
    ds_read_b64 v[58:59], v203 offset:512
    s_waitcnt lgkmcnt(0)
    v_cmp_ne_u32 vcc, s6, v5
    s_cbranch_vccz Llrb_18
    s_sub_u32 s95, s95, 1
    s_cbranch_scc0 Llrl_19
    s_branch Llrb_18
Lslow_20:
    buffer_store_dwordx4 v[200:203], v216, s[56:59], s86 offen sc1
    buffer_store_dwordx4 v[204:207], v216, s[56:59], s86 offen offset:1024 sc1
    s_branch Lback_21
Lslow_22:
    s_mov_b64 exec, 1
    buffer_store_dword v217, off, s[56:59], s87 offset:0 sc1
    s_mov_b64 exec, -1
    s_branch Lback_23
Llr_28:
    s_mov_b32 s95, 0x400000
Llrl_30:
    ds_read_b32 v7, v10
    s_waitcnt lgkmcnt(0)
    v_cmp_ne_u32 vcc, s6, v7
    s_cbranch_vccz Llrb_29
    s_sub_u32 s95, s95, 1
    s_cbranch_scc0 Llrl_30
    s_branch Llrb_29
Lre_31:
    s_mov_b32 s95, 0x40000
Lrel_33:
    buffer_load_dword v4, v227, s[56:59], s64 offen offset:0 sc1
    s_waitcnt vmcnt(0)
    v_cmp_ne_u32 vcc, s6, v4
    s_cbranch_vccz Lreb_32
    s_sub_u32 s95, s95, 1
    s_cbranch_scc0 Lrel_33
    s_branch Lreb_32
Llr_34:
    s_mov_b32 s95, 0x400000
Llrl_36:
    ds_read_b32 v7, v6
    ds_read_b128 v[128:131], v222 offset:0
    ds_read_b128 v[132:135], v222 offset:1024
    ds_read_b128 v[136:139], v222 offset:2048
    ds_read_b128 v[140:143], v222 offset:3072
    s_waitcnt lgkmcnt(0)
    v_cmp_ne_u32 vcc, s6, v7
    s_cbranch_vccz Llrb_35
    s_sub_u32 s95, s95, 1
    s_cbranch_scc0 Llrl_36
    s_branch Llrb_35
Lslow_37:
    buffer_store_dwordx4 v[128:131], v224, s[56:59], s64 offen sc1
    buffer_store_dwordx4 v[132:135], v224, s[56:59], s64 offen offset:2048 sc1
    s_branch Lback_38
Lslow_39:
    s_mov_b32 exec_hi, 0
    buffer_store_dwordx4 v[136:139], v225, s[56:59], s84 offen sc1
    s_mov_b32 exec_hi, -1
    s_branch Lback_40
Lslow_41:
    s_mov_b64 exec, 1
    buffer_store_dword v217, off, s[56:59], s87 offset:128 sc1
    s_mov_b64 exec, -1
    s_branch Lback_42
Lre_43:
    s_mov_b32 s95, 0x40000
Lrel_45:
    buffer_load_dwordx4 v[152:155], v232, s[56:59], 0 offen sc1
    buffer_load_dwordx4 v[144:147], off, s[56:59], s76 sc1
    buffer_load_dwordx4 v[148:151], off, s[56:59], s76 offset:16 sc1
    s_waitcnt vmcnt(0)
    v_xor_b32 v4, s6, v155
    v_bitop3_b32 v4, v4, v147, s6 bitop3:0xf6
    v_bitop3_b32 v4, v4, v151, s6 bitop3:0xf6
    v_cmp_ne_u32 vcc, 0, v4
    s_cbranch_vccz Lreb_44
    s_sub_u32 s95, s95, 1
    s_cbranch_scc0 Lrel_45
    s_branch Lreb_44
Lre_46:
    s_mov_b32 s95, 0x40000
Lrel_48:
    buffer_load_dwordx4 v[160:163], v225, s[56:59], s64 offen sc1
    buffer_load_dwordx4 v[164:167], v225, s[56:59], s74 offen sc1
    buffer_load_dwordx4 v[168:171], v225, s[56:59], s75 offen sc1
    buffer_load_dwordx4 v[172:175], v226, s[56:59], s64 offen sc1
    s_waitcnt vmcnt(0)
    v_xor_b32 v4, s6, v163
    v_bitop3_b32 v4, v4, v167, s6 bitop3:0xf6
    v_bitop3_b32 v4, v4, v171, s6 bitop3:0xf6
    v_bitop3_b32 v4, v4, v175, s6 bitop3:0xf6
    v_cmp_ne_u32 vcc, 0, v4
    s_cbranch_vccz Lreb_47
    s_sub_u32 s95, s95, 1
    s_cbranch_scc0 Lrel_48
    s_branch Lreb_47
Lre_49:
    s_mov_b32 s95, 0x40000
Lrel_51:
    buffer_load_dword v3, v14, s[56:59], s64 offen offset:1152 sc1
    s_waitcnt vmcnt(0)
    v_cmp_ne_u32 vcc, s6, v3
    s_cbranch_vccz Lreb_50
    s_sub_u32 s95, s95, 1
    s_cbranch_scc0 Lrel_51
    s_branch Lreb_50
Lslow_52:
    buffer_store_dwordx4 v[112:115], v216, s[56:59], s81 offen offset:0 sc1
    buffer_store_dwordx4 v[116:119], v216, s[56:59], s81 offen offset:1024 sc1
    s_branch Lback_53
Llr_54:
    s_mov_b32 s95, 0x400000
Llrl_56:
    ds_read_b32 v2, v6
    s_waitcnt lgkmcnt(0)
    v_cmp_ne_u32 vcc, s6, v2
    s_cbranch_vccz Llrb_55
    s_sub_u32 s95, s95, 1
    s_cbranch_scc0 Llrl_56
    s_branch Llrb_55
Lslow_57:
    buffer_store_dwordx4 v[120:123], v216, s[56:59], s81 offen offset:2048 sc1
    buffer_store_dwordx4 v[124:127], v216, s[56:59], s81 offen offset:3072 sc1
    s_branch Lback_58
Lslow_59:
    s_mov_b64 exec, 1
    buffer_store_dword v217, off, s[56:59], s82 offset:0 sc1
    s_mov_b64 exec, -1
    s_branch Lback_60
Llr_63:
    s_mov_b32 s95, 0x400000
Llrl_65:
    ds_read_b32 v7, v5 offset:64
    ds_read_b128 v[80:83], v13 offset:0
    ds_read_b128 v[84:87], v13 offset:1024
    ds_read_b128 v[88:91], v13 offset:2048
    ds_read_b128 v[92:95], v13 offset:3072
    ds_read_b128 v[96:99], v13 offset:4096
    ds_read_b128 v[100:103], v13 offset:5120
    ds_read_b128 v[104:107], v13 offset:6144
    ds_read_b128 v[108:111], v13 offset:7168
    s_waitcnt lgkmcnt(0)
    v_cmp_ne_u32 vcc, s6, v7
    s_cbranch_vccz Llrb_64
    s_sub_u32 s95, s95, 1
    s_cbranch_scc0 Llrl_65
    s_branch Llrb_64
Lre_73:
    s_mov_b32 s95, 0x40000
Lrel_75:
    buffer_load_dwordx4 v[120:123], v10, s[56:59], 0 offen sc1
    buffer_load_dword v248, v12, s[56:59], 0 offen sc1
    s_waitcnt vmcnt(0)
    v_subrev_u32 v2, s6, v248
    v_xor_b32 v3, s6, v122
    v_and_or_b32 v3, v2, -8, v3
    v_cmp_ne_u32 vcc, 0, v3
    s_cbranch_vccz Lreb_74
    s_sub_u32 s95, s95, 1
    s_cbranch_scc0 Lrel_75
    s_branch Lreb_74
Lre_80:
    s_mov_b32 s95, 0x40000
Lrel_82:
    buffer_load_dwordx4 v[176:179], v11, s[56:59], 0 offen sc1
    s_waitcnt vmcnt(0)
    v_cmp_ne_u32 vcc, s6, v179
    s_cbranch_vccz Lreb_81
    s_sub_u32 s95, s95, 1
    s_cbranch_scc0 Lrel_82
    s_branch Lreb_81
Lre_85:
    s_mov_b32 s95, 0x40000
Lrel_87:
    buffer_load_dword v3, v236, s[56:59], s64 offen offset:128 sc1
    s_waitcnt vmcnt(0)
    v_cmp_ne_u32 vcc, s6, v3
    s_cbranch_vccz Lreb_86
    s_sub_u32 s95, s95, 1
    s_cbranch_scc0 Lrel_87
    s_branch Lreb_86
Lslow_88:
    s_mov_b64 exec, 1
    buffer_store_dword v251, off, s[56:59], s83 offset:1152 sc1
    s_mov_b64 exec, -1
    s_branch Lback_89
Lslow_90:
    s_mov_b64 exec, 1
    buffer_store_dword v251, off, s[56:59], s82 offset:0 sc1
    s_mov_b64 exec, -1
    s_branch Lback_91
Lslow_92:
    s_mov_b64 exec, 1
    buffer_store_dword v251, off, s[56:59], s86 offset:0 sc1
    s_mov_b64 exec, -1
    s_branch Lback_93
Lre_94:
    s_mov_b32 s95, 0x40000
Lrel_96:
    buffer_load_dword v2, v4, s[56:59], s67 offen offset:256 sc1
    s_waitcnt vmcnt(0)
    v_cmp_ne_u32 vcc, s6, v2
    s_cbranch_vccz Lreb_95
    s_sub_u32 s95, s95, 1
    s_cbranch_scc0 Lrel_96
    s_branch Lreb_95
Lre_97:
    s_mov_b32 s95, 0x40000
Lrel_99:
    buffer_load_dword v3, v4, s[56:59], s67 offen offset:272 sc1
    s_waitcnt vmcnt(0)
    v_cmp_ne_u32 vcc, s6, v3
    s_cbranch_vccz Lreb_98
    s_sub_u32 s95, s95, 1
    s_cbranch_scc0 Lrel_99
    s_branch Lreb_98
L_code_end:
    s_endpgm
.section .rodata,"a"
.p2align 6
.amdhsa_kernel adaLN_cond__sliding_local_dilated__mixer_channel_mlp__prompt_kernel
  .amdhsa_next_free_vgpr 256
  .amdhsa_next_free_sgpr 102
  .amdhsa_accum_offset 256
  .amdhsa_group_segment_fixed_size 0
  .amdhsa_kernarg_size 104
  .amdhsa_user_sgpr_count 2
  .amdhsa_user_sgpr_kernarg_segment_ptr 1
  .amdhsa_system_sgpr_workgroup_id_x 1
  .amdhsa_float_denorm_mode_32 3
.end_amdhsa_kernel
```
